```python
import torch

def _softmax(x, axis=-1):
    return torch.softmax(x, dim=axis)
def _gelu(x):
    return torch.nn.functional.gelu(x, approximate="tanh")
def _silu(x):
    return torch.nn.functional.silu(x)
def _sigmoid(x):
    return torch.sigmoid(x)
def _layernorm(x, axis=-1, eps=1e-5):
    m = x.mean(dim=axis, keepdim=True)
    v = x.var(dim=axis, keepdim=True, unbiased=False)
    return (x - m) / torch.sqrt(v + eps)
def _scatter_add(tgt, idx, src, axis=0):
    return tgt.clone().index_add_(axis, idx, src)
def _segment_sum(src, seg, n):
    out = torch.zeros((n,) + src.shape[1:], dtype=src.dtype)
    return out.index_add_(0, seg, src)
def _pad(x, pw):
    flat = tuple(v for pair in reversed(pw) for v in pair)
    return torch.nn.functional.pad(x, flat)

kernel_name = 'gated_mix__softmax_full_mha__dense_activation_squared_relu__prompt'

def setup_inputs():

    _w = (lambda a: (lambda t: t.to(torch.bfloat16) if t.is_floating_point() else t)(torch.as_tensor(a)))
    def _A_setup():
        B, S, D = 1, 2048, 512
        return {
            "x": _w((lambda *s: torch.randn(*s, dtype=torch.bfloat16) * 0.05)(B, S, D)),
            "wqkv": _w((lambda *s: torch.randn(*s, dtype=torch.bfloat16) * 0.8)(D, 3 * D)),
            "wo": _w((lambda *s: torch.randn(*s, dtype=torch.bfloat16) * 0.1)(D, D)),
        }
    _A_in = _A_setup()

    def _B_setup():
        B, S, D, F = 1, 2048, 512, 1792
        return {
            "x": _w((lambda *s: torch.randn(*s, dtype=torch.bfloat16) * 0.05)(B, S, D)),
            "w1": _w((lambda *s: torch.randn(*s, dtype=torch.bfloat16) * 0.1)(D, F)),
            "b1": _w((lambda *s: torch.randn(*s, dtype=torch.bfloat16) * 0.05)(F)),
            "w2": _w((lambda *s: torch.randn(*s, dtype=torch.bfloat16) * 0.05)(F, D)),
            "b2": _w((lambda *s: torch.randn(*s, dtype=torch.bfloat16) * 0.05)(D)),
        }
    _B_in = _B_setup()

    return {
        "A_x": _A_in["x"],
        "A_wqkv": _A_in["wqkv"],
        "A_wo": _A_in["wo"],
        "B_x": _B_in["x"],
        "B_w1": _B_in["w1"],
        "B_b1": _B_in["b1"],
        "B_w2": _B_in["w2"],
        "B_b2": _B_in["b2"],
        "gate_w": _w((lambda *s: torch.randn(*s, dtype=torch.bfloat16) * 0.05)(512) * 16.0),
    }

def reference(A_x, A_wqkv, A_wo, B_x, B_w1, B_b1, B_w2, B_b2, gate_w):
    def _A_ref(x, wqkv, wo):
        B, S, D = x.shape
        H = 32; Dh = D // H
        qkv = (lambda x, *d: x.permute(*d))((x @ wqkv).reshape(B, S, 3, H, Dh), 2, 0, 3, 1, 4)
        q, k, v = qkv[0], qkv[1], qkv[2]
        scale = Dh ** -0.5
        scores = torch.einsum("bhqd,bhkd->bhqk", q, k) * scale
        p = _softmax(scores, axis=-1)
        o = torch.einsum("bhqk,bhkd->bhqd", p, v)
        return (lambda x, *d: x.permute(*d))(o, 0, 2, 1, 3).reshape(B, S, D) @ wo

    def _B_ref(x, w1, b1, w2, b2):
        h = torch.einsum("bsd,df->bsf", x, w1) + b1
        zero = torch.zeros_like(h)
        r = torch.where(h > zero, h, zero)
        h = r * r
        out = torch.einsum("bsf,fd->bsd", h, w2) + b2
        return out

    x = A_x
    g = _sigmoid((x * gate_w).sum(-1, keepdims=True))
    a = _A_ref(x, A_wqkv, A_wo)
    b = _B_ref(x, B_w1, B_b1, B_w2, B_b2)
    return g * a + (1 - g) * b
```

```asm
; @launch kernel=k1_proj_kernel grid=(240,1,1) block=(512,1,1) lds=147456
; @launch kernel=k2_mix_kernel grid=(512,1,1) block=(512,1,1) lds=81920
; @launch kernel=k4_out_kernel grid=(256,1,1) block=(512,1,1) lds=81920
.amdgcn_target "amdgcn-amd-amdhsa--gfx950"
.text
.globl k1_proj_kernel
.p2align 8
.type k1_proj_kernel,@function
k1_proj_kernel:
    s_cmp_ge_u32 s2, 240
    s_cbranch_scc1 k1_exit
    s_cmp_ge_u32 s2, 208
    s_cbranch_scc1 k1_role_G
    s_and_b32 s4, s2, 7
    s_lshr_b32 s5, s2, 3
    s_and_b32 s6, s4, 3
    s_lshl_b32 s6, s6, 1
    s_and_b32 s7, s5, 1
    s_add_u32 s6, s6, s7
    s_lshr_b32 s7, s4, 2
    s_mul_i32 s7, s7, 13
    s_lshr_b32 s5, s5, 1
    s_add_u32 s7, s7, s5
    s_cmp_lt_u32 s7, 8
    s_cbranch_scc1 k1_role_QK
    s_cmp_lt_u32 s7, 12
    s_cbranch_scc1 k1_role_V
    s_branch k1_role_F1
k1_exit:
    s_endpgm
k1_role_QK:
    s_sub_u32 s7, s7, 0
    s_lshl_b32 s7, s7, 3
    s_add_u32 s3, s7, s6
    s_load_dwordx2 s[4:5], s[0:1], 0
    s_load_dwordx2 s[6:7], s[0:1], 8
    s_load_dwordx2 s[8:9], s[0:1], 88
    v_lshrrev_b32 v114, 6, v0
    v_and_b32 v111, 63, v0
    s_nop 0
    v_readfirstlane_b32 s28, v114
    v_lshrrev_b32 v112, 5, v111
    v_and_b32 v113, 31, v111
    s_and_b32 s32, s3, 7
    s_lshr_b32 s33, s3, 3
    s_and_b32 s31, s28, 0
    s_lshr_b32 s50, s28, 0
    s_and_b32 s29, s50, 3
    s_lshr_b32 s30, s50, 2
    s_waitcnt lgkmcnt(0)
    s_mov_b32 s12, s4
    s_mov_b32 s13, s5
    s_mov_b32 s14, 2097152
    s_mov_b32 s15, 0x00020000
    s_mul_i32 s50, s33, 256
    s_add_u32 s50, s50, 0
    s_add_u32 s6, s6, s50
    s_addc_u32 s7, s7, 0
    s_sub_u32 s51, 1572864, s50
    s_mov_b32 s16, s6
    s_mov_b32 s17, s7
    s_mov_b32 s18, s51
    s_mov_b32 s19, 0x00020000
    s_add_u32 s50, s8, 0
    s_addc_u32 s51, s9, 0
    s_mov_b32 s20, s50
    s_mov_b32 s21, s51
    s_mov_b32 s22, 4194304
    s_mov_b32 s23, 0x00020000
    v_lshrrev_b32 v114, 3, v111
    v_and_b32 v115, 7, v111
    s_mul_i32 s50, s28, 32
    s_mov_b32 s51, 1024
    v_add_u32 v116, s50, v114
    v_lshrrev_b32 v116, 1, v116
    v_and_b32 v116, 7, v116
    v_xor_b32 v116, v116, v115
    v_lshlrev_b32 v116, 4, v116
    v_mul_lo_u32 v117, v114, s51
    v_add_u32 v106, v116, v117
    v_add_u32 v116, s50, v114
    v_add_u32 v116, 8, v116
    v_lshrrev_b32 v116, 1, v116
    v_and_b32 v116, 7, v116
    v_xor_b32 v116, v116, v115
    v_lshlrev_b32 v116, 4, v116
    v_mul_lo_u32 v117, v114, s51
    v_add_u32 v107, v116, v117
    v_add_u32 v116, s50, v114
    v_add_u32 v116, 16, v116
    v_lshrrev_b32 v116, 1, v116
    v_and_b32 v116, 7, v116
    v_xor_b32 v116, v116, v115
    v_lshlrev_b32 v116, 4, v116
    v_mul_lo_u32 v117, v114, s51
    v_add_u32 v108, v116, v117
    v_add_u32 v116, s50, v114
    v_add_u32 v116, 24, v116
    v_lshrrev_b32 v116, 1, v116
    v_and_b32 v116, 7, v116
    v_xor_b32 v116, v116, v115
    v_lshlrev_b32 v116, 4, v116
    v_mul_lo_u32 v117, v114, s51
    v_add_u32 v109, v116, v117
    s_mul_i32 s52, s32, 256
    s_add_u32 s52, s52, s50
    s_add_u32 s53, s52, 0
    s_mul_i32 s34, s53, 1024
    s_add_u32 s53, s52, 8
    s_mul_i32 s35, s53, 1024
    s_add_u32 s53, s52, 16
    s_mul_i32 s36, s53, 1024
    s_add_u32 s53, s52, 24
    s_mul_i32 s37, s53, 1024
    s_mul_i32 s40, s28, 4096
    v_lshrrev_b32 v114, 4, v111
    v_and_b32 v115, 15, v111
    v_and_b32 v116, 3, v114
    v_lshlrev_b32 v116, 2, v116
    v_xor_b32 v115, v115, v116
    v_lshlrev_b32 v115, 4, v115
    s_mov_b32 s51, 3072
    v_mul_lo_u32 v117, v114, s51
    v_add_u32 v110, v115, v117
    s_mul_i32 s52, s28, 8
    s_add_u32 s52, s52, 0
    s_mul_i32 s38, s52, 3072
    s_mul_i32 s52, s28, 8
    s_add_u32 s52, s52, 4
    s_mul_i32 s39, s52, 3072
    s_mul_i32 s41, s28, 2048
    s_add_u32 s41, s41, 32768
    s_mov_b32 s46, 128
    s_mov_b32 s47, 4294966400
    s_mov_b32 s48, 196608
    s_mov_b32 s49, 4293591040
    s_mul_i32 s50, s32, 3
    s_add_u32 s50, s50, s33
    s_lshl_b32 s50, s50, 0
    s_and_b32 s42, s50, 7
    s_mov_b32 s43, s42
    s_mul_i32 s51, s42, 128
    s_add_u32 s34, s34, s51
    s_add_u32 s35, s35, s51
    s_add_u32 s36, s36, s51
    s_add_u32 s37, s37, s51
    s_mul_i32 s51, s42, 196608
    s_add_u32 s38, s38, s51
    s_add_u32 s39, s39, s51
    s_add_u32 s42, s42, 1
    s_cmp_eq_u32 s42, 8
    s_cselect_b32 s44, s47, s46
    s_cselect_b32 s42, 0, s42
    s_add_u32 s43, s43, 1
    s_cmp_eq_u32 s43, 8
    s_cselect_b32 s45, s49, s48
    s_cselect_b32 s43, 0, s43
    s_add_u32 m0, s40, 0
    s_nop 0
    buffer_load_dwordx4 v106, s[12:15], s34 offen lds
    s_add_u32 s34, s34, s44
    s_add_u32 m0, s40, 1024
    s_nop 0
    buffer_load_dwordx4 v107, s[12:15], s35 offen lds
    s_add_u32 s35, s35, s44
    s_add_u32 m0, s40, 2048
    s_nop 0
    buffer_load_dwordx4 v108, s[12:15], s36 offen lds
    s_add_u32 s36, s36, s44
    s_add_u32 m0, s40, 3072
    s_nop 0
    buffer_load_dwordx4 v109, s[12:15], s37 offen lds
    s_add_u32 s37, s37, s44
    s_add_u32 m0, s41, 0
    s_nop 0
    buffer_load_dwordx4 v110, s[16:19], s38 offen lds
    s_add_u32 s38, s38, s45
    s_add_u32 m0, s41, 1024
    s_nop 0
    buffer_load_dwordx4 v110, s[16:19], s39 offen lds
    s_add_u32 s39, s39, s45
    s_add_u32 s42, s42, 1
    s_cmp_eq_u32 s42, 8
    s_cselect_b32 s44, s47, s46
    s_cselect_b32 s42, 0, s42
    s_add_u32 s43, s43, 1
    s_cmp_eq_u32 s43, 8
    s_cselect_b32 s45, s49, s48
    s_cselect_b32 s43, 0, s43
    s_add_u32 m0, s40, 49152
    s_nop 0
    buffer_load_dwordx4 v106, s[12:15], s34 offen lds
    s_add_u32 s34, s34, s44
    s_add_u32 m0, s40, 50176
    s_nop 0
    buffer_load_dwordx4 v107, s[12:15], s35 offen lds
    s_add_u32 s35, s35, s44
    s_add_u32 m0, s40, 51200
    s_nop 0
    buffer_load_dwordx4 v108, s[12:15], s36 offen lds
    s_add_u32 s36, s36, s44
    s_add_u32 m0, s40, 52224
    s_nop 0
    buffer_load_dwordx4 v109, s[12:15], s37 offen lds
    s_add_u32 s37, s37, s44
    s_add_u32 m0, s41, 49152
    s_nop 0
    buffer_load_dwordx4 v110, s[16:19], s38 offen lds
    s_add_u32 s38, s38, s45
    s_add_u32 m0, s41, 50176
    s_nop 0
    buffer_load_dwordx4 v110, s[16:19], s39 offen lds
    s_add_u32 s39, s39, s45
    s_mul_i32 s50, s29, 8192
    v_mul_u32_u24 v114, 128, v113
    v_add_u32 v114, s50, v114
    v_mov_b32 v115, v113
    v_lshrrev_b32 v115, 1, v115
    v_and_b32 v115, 7, v115
    s_lshl_b32 s51, s31, 1
    v_add_u32 v116, s51, v112
    v_add_u32 v117, 0, v116
    v_xor_b32 v117, v117, v115
    v_lshlrev_b32 v117, 4, v117
    v_add_u32 v100, v114, v117
    v_add_u32 v117, 2, v116
    v_xor_b32 v117, v117, v115
    v_lshlrev_b32 v117, 4, v117
    v_add_u32 v101, v114, v117
    v_add_u32 v117, 4, v116
    v_xor_b32 v117, v117, v115
    v_lshlrev_b32 v117, 4, v117
    v_add_u32 v102, v114, v117
    v_add_u32 v117, 6, v116
    v_xor_b32 v117, v117, v115
    v_lshlrev_b32 v117, 4, v117
    v_add_u32 v103, v114, v117
    v_and_b32 v114, 15, v111
    v_lshrrev_b32 v114, 2, v114
    v_mul_u32_u24 v115, 8, v112
    v_add_u32 v115, v115, v114
    v_mul_u32_u24 v115, 256, v115
    v_lshlrev_b32 v116, 2, v114
    v_lshrrev_b32 v117, 4, v111
    v_and_b32 v117, 1, v117
    v_lshlrev_b32 v117, 1, v117
    v_and_b32 v118, 3, v111
    v_lshrrev_b32 v119, 1, v118
    v_add_u32 v117, v117, v119
    s_mul_i32 s50, s30, 8
    v_add_u32 v117, s50, v117
    v_and_b32 v118, 1, v118
    v_lshlrev_b32 v118, 3, v118
    v_add_u32 v118, v118, v115
    v_add_u32 v118, 32768, v118
    v_add_u32 v119, 0, v117
    v_xor_b32 v119, v119, v116
    v_lshlrev_b32 v119, 4, v119
    v_add_u32 v104, v118, v119
    v_add_u32 v119, 4, v117
    v_xor_b32 v119, v119, v116
    v_lshlrev_b32 v119, 4, v119
    v_add_u32 v105, v118, v119
    v_mov_b32 v4, 0
    v_mov_b32 v5, 0
    v_mov_b32 v6, 0
    v_mov_b32 v7, 0
    v_mov_b32 v8, 0
    v_mov_b32 v9, 0
    v_mov_b32 v10, 0
    v_mov_b32 v11, 0
    v_mov_b32 v12, 0
    v_mov_b32 v13, 0
    v_mov_b32 v14, 0
    v_mov_b32 v15, 0
    v_mov_b32 v16, 0
    v_mov_b32 v17, 0
    v_mov_b32 v18, 0
    v_mov_b32 v19, 0
    v_mov_b32 v20, 0
    v_mov_b32 v21, 0
    v_mov_b32 v22, 0
    v_mov_b32 v23, 0
    v_mov_b32 v24, 0
    v_mov_b32 v25, 0
    v_mov_b32 v26, 0
    v_mov_b32 v27, 0
    v_mov_b32 v28, 0
    v_mov_b32 v29, 0
    v_mov_b32 v30, 0
    v_mov_b32 v31, 0
    v_mov_b32 v32, 0
    v_mov_b32 v33, 0
    v_mov_b32 v34, 0
    v_mov_b32 v35, 0
    v_mov_b32 v36, 0
    v_mov_b32 v37, 0
    v_mov_b32 v38, 0
    v_mov_b32 v39, 0
    v_mov_b32 v40, 0
    v_mov_b32 v41, 0
    v_mov_b32 v42, 0
    v_mov_b32 v43, 0
    v_mov_b32 v44, 0
    v_mov_b32 v45, 0
    v_mov_b32 v46, 0
    v_mov_b32 v47, 0
    v_mov_b32 v48, 0
    v_mov_b32 v49, 0
    v_mov_b32 v50, 0
    v_mov_b32 v51, 0
    v_mov_b32 v52, 0
    v_mov_b32 v53, 0
    v_mov_b32 v54, 0
    v_mov_b32 v55, 0
    v_mov_b32 v56, 0
    v_mov_b32 v57, 0
    v_mov_b32 v58, 0
    v_mov_b32 v59, 0
    v_mov_b32 v60, 0
    v_mov_b32 v61, 0
    v_mov_b32 v62, 0
    v_mov_b32 v63, 0
    v_mov_b32 v64, 0
    v_mov_b32 v65, 0
    v_mov_b32 v66, 0
    v_mov_b32 v67, 0
    s_waitcnt vmcnt(6)
    s_barrier
    ds_read_b128 v[68:71], v100 offset:0
    ds_read_b128 v[72:75], v100 offset:4096
    ds_read_b64_tr_b16 v[84:85], v104 offset:0
    ds_read_b64_tr_b16 v[86:87], v104 offset:1024
    ds_read_b64_tr_b16 v[88:89], v105 offset:0
    ds_read_b64_tr_b16 v[90:91], v105 offset:1024
    ds_read_b128 v[76:79], v101 offset:0
    ds_read_b128 v[80:83], v101 offset:4096
    ds_read_b64_tr_b16 v[92:93], v104 offset:4096
    ds_read_b64_tr_b16 v[94:95], v104 offset:5120
    ds_read_b64_tr_b16 v[96:97], v105 offset:4096
    ds_read_b64_tr_b16 v[98:99], v105 offset:5120
    s_waitcnt lgkmcnt(6)
    v_mfma_f32_32x32x16_bf16 v[4:19], v[84:87], v[68:71], v[4:19]
    v_mfma_f32_32x32x16_bf16 v[20:35], v[84:87], v[72:75], v[20:35]
    v_mfma_f32_32x32x16_bf16 v[36:51], v[88:91], v[68:71], v[36:51]
    v_mfma_f32_32x32x16_bf16 v[52:67], v[88:91], v[72:75], v[52:67]
    s_waitcnt vmcnt(0)
    s_barrier
    s_add_u32 s42, s42, 1
    s_cmp_eq_u32 s42, 8
    s_cselect_b32 s44, s47, s46
    s_cselect_b32 s42, 0, s42
    s_add_u32 s43, s43, 1
    s_cmp_eq_u32 s43, 8
    s_cselect_b32 s45, s49, s48
    s_cselect_b32 s43, 0, s43
    s_add_u32 m0, s40, 98304
    s_nop 0
    buffer_load_dwordx4 v106, s[12:15], s34 offen lds
    s_add_u32 s34, s34, s44
    s_add_u32 m0, s40, 99328
    s_nop 0
    buffer_load_dwordx4 v107, s[12:15], s35 offen lds
    s_add_u32 s35, s35, s44
    s_add_u32 m0, s40, 100352
    s_nop 0
    buffer_load_dwordx4 v108, s[12:15], s36 offen lds
    s_add_u32 s36, s36, s44
    s_add_u32 m0, s40, 101376
    s_nop 0
    buffer_load_dwordx4 v109, s[12:15], s37 offen lds
    s_add_u32 s37, s37, s44
    s_add_u32 m0, s41, 98304
    s_nop 0
    buffer_load_dwordx4 v110, s[16:19], s38 offen lds
    s_add_u32 s38, s38, s45
    s_add_u32 m0, s41, 99328
    s_nop 0
    buffer_load_dwordx4 v110, s[16:19], s39 offen lds
    s_add_u32 s39, s39, s45
    ds_read_b128 v[68:71], v102 offset:0
    ds_read_b128 v[72:75], v102 offset:4096
    ds_read_b64_tr_b16 v[84:85], v104 offset:8192
    ds_read_b64_tr_b16 v[86:87], v104 offset:9216
    ds_read_b64_tr_b16 v[88:89], v105 offset:8192
    ds_read_b64_tr_b16 v[90:91], v105 offset:9216
    s_waitcnt lgkmcnt(6)
    v_mfma_f32_32x32x16_bf16 v[4:19], v[92:95], v[76:79], v[4:19]
    v_mfma_f32_32x32x16_bf16 v[20:35], v[92:95], v[80:83], v[20:35]
    v_mfma_f32_32x32x16_bf16 v[36:51], v[96:99], v[76:79], v[36:51]
    v_mfma_f32_32x32x16_bf16 v[52:67], v[96:99], v[80:83], v[52:67]
    ds_read_b128 v[76:79], v103 offset:0
    ds_read_b128 v[80:83], v103 offset:4096
    ds_read_b64_tr_b16 v[92:93], v104 offset:12288
    ds_read_b64_tr_b16 v[94:95], v104 offset:13312
    ds_read_b64_tr_b16 v[96:97], v105 offset:12288
    ds_read_b64_tr_b16 v[98:99], v105 offset:13312
    s_waitcnt lgkmcnt(6)
    v_mfma_f32_32x32x16_bf16 v[4:19], v[84:87], v[68:71], v[4:19]
    v_mfma_f32_32x32x16_bf16 v[20:35], v[84:87], v[72:75], v[20:35]
    v_mfma_f32_32x32x16_bf16 v[36:51], v[88:91], v[68:71], v[36:51]
    v_mfma_f32_32x32x16_bf16 v[52:67], v[88:91], v[72:75], v[52:67]
    v_add_u32 v100, 49152, v100
    v_add_u32 v101, 49152, v101
    v_add_u32 v102, 49152, v102
    v_add_u32 v103, 49152, v103
    v_add_u32 v104, 49152, v104
    v_add_u32 v105, 49152, v105
    ds_read_b128 v[68:71], v100 offset:0
    ds_read_b128 v[72:75], v100 offset:4096
    ds_read_b64_tr_b16 v[84:85], v104 offset:0
    ds_read_b64_tr_b16 v[86:87], v104 offset:1024
    ds_read_b64_tr_b16 v[88:89], v105 offset:0
    ds_read_b64_tr_b16 v[90:91], v105 offset:1024
    s_waitcnt lgkmcnt(6)
    v_mfma_f32_32x32x16_bf16 v[4:19], v[92:95], v[76:79], v[4:19]
    v_mfma_f32_32x32x16_bf16 v[20:35], v[92:95], v[80:83], v[20:35]
    v_mfma_f32_32x32x16_bf16 v[36:51], v[96:99], v[76:79], v[36:51]
    v_mfma_f32_32x32x16_bf16 v[52:67], v[96:99], v[80:83], v[52:67]
    ds_read_b128 v[76:79], v101 offset:0
    ds_read_b128 v[80:83], v101 offset:4096
    ds_read_b64_tr_b16 v[92:93], v104 offset:4096
    ds_read_b64_tr_b16 v[94:95], v104 offset:5120
    ds_read_b64_tr_b16 v[96:97], v105 offset:4096
    ds_read_b64_tr_b16 v[98:99], v105 offset:5120
    s_waitcnt lgkmcnt(6)
    v_mfma_f32_32x32x16_bf16 v[4:19], v[84:87], v[68:71], v[4:19]
    v_mfma_f32_32x32x16_bf16 v[20:35], v[84:87], v[72:75], v[20:35]
    v_mfma_f32_32x32x16_bf16 v[36:51], v[88:91], v[68:71], v[36:51]
    v_mfma_f32_32x32x16_bf16 v[52:67], v[88:91], v[72:75], v[52:67]
    s_waitcnt vmcnt(0)
    s_barrier
    s_add_u32 s42, s42, 1
    s_cmp_eq_u32 s42, 8
    s_cselect_b32 s44, s47, s46
    s_cselect_b32 s42, 0, s42
    s_add_u32 s43, s43, 1
    s_cmp_eq_u32 s43, 8
    s_cselect_b32 s45, s49, s48
    s_cselect_b32 s43, 0, s43
    s_add_u32 m0, s40, 0
    s_nop 0
    buffer_load_dwordx4 v106, s[12:15], s34 offen lds
    s_add_u32 s34, s34, s44
    s_add_u32 m0, s40, 1024
    s_nop 0
    buffer_load_dwordx4 v107, s[12:15], s35 offen lds
    s_add_u32 s35, s35, s44
    s_add_u32 m0, s40, 2048
    s_nop 0
    buffer_load_dwordx4 v108, s[12:15], s36 offen lds
    s_add_u32 s36, s36, s44
    s_add_u32 m0, s40, 3072
    s_nop 0
    buffer_load_dwordx4 v109, s[12:15], s37 offen lds
    s_add_u32 s37, s37, s44
    s_add_u32 m0, s41, 0
    s_nop 0
    buffer_load_dwordx4 v110, s[16:19], s38 offen lds
    s_add_u32 s38, s38, s45
    s_add_u32 m0, s41, 1024
    s_nop 0
    buffer_load_dwordx4 v110, s[16:19], s39 offen lds
    s_add_u32 s39, s39, s45
    ds_read_b128 v[68:71], v102 offset:0
    ds_read_b128 v[72:75], v102 offset:4096
    ds_read_b64_tr_b16 v[84:85], v104 offset:8192
    ds_read_b64_tr_b16 v[86:87], v104 offset:9216
    ds_read_b64_tr_b16 v[88:89], v105 offset:8192
    ds_read_b64_tr_b16 v[90:91], v105 offset:9216
    s_waitcnt lgkmcnt(6)
    v_mfma_f32_32x32x16_bf16 v[4:19], v[92:95], v[76:79], v[4:19]
    v_mfma_f32_32x32x16_bf16 v[20:35], v[92:95], v[80:83], v[20:35]
    v_mfma_f32_32x32x16_bf16 v[36:51], v[96:99], v[76:79], v[36:51]
    v_mfma_f32_32x32x16_bf16 v[52:67], v[96:99], v[80:83], v[52:67]
    ds_read_b128 v[76:79], v103 offset:0
    ds_read_b128 v[80:83], v103 offset:4096
    ds_read_b64_tr_b16 v[92:93], v104 offset:12288
    ds_read_b64_tr_b16 v[94:95], v104 offset:13312
    ds_read_b64_tr_b16 v[96:97], v105 offset:12288
    ds_read_b64_tr_b16 v[98:99], v105 offset:13312
    s_waitcnt lgkmcnt(6)
    v_mfma_f32_32x32x16_bf16 v[4:19], v[84:87], v[68:71], v[4:19]
    v_mfma_f32_32x32x16_bf16 v[20:35], v[84:87], v[72:75], v[20:35]
    v_mfma_f32_32x32x16_bf16 v[36:51], v[88:91], v[68:71], v[36:51]
    v_mfma_f32_32x32x16_bf16 v[52:67], v[88:91], v[72:75], v[52:67]
    v_add_u32 v100, 49152, v100
    v_add_u32 v101, 49152, v101
    v_add_u32 v102, 49152, v102
    v_add_u32 v103, 49152, v103
    v_add_u32 v104, 49152, v104
    v_add_u32 v105, 49152, v105
    ds_read_b128 v[68:71], v100 offset:0
    ds_read_b128 v[72:75], v100 offset:4096
    ds_read_b64_tr_b16 v[84:85], v104 offset:0
    ds_read_b64_tr_b16 v[86:87], v104 offset:1024
    ds_read_b64_tr_b16 v[88:89], v105 offset:0
    ds_read_b64_tr_b16 v[90:91], v105 offset:1024
    s_waitcnt lgkmcnt(6)
    v_mfma_f32_32x32x16_bf16 v[4:19], v[92:95], v[76:79], v[4:19]
    v_mfma_f32_32x32x16_bf16 v[20:35], v[92:95], v[80:83], v[20:35]
    v_mfma_f32_32x32x16_bf16 v[36:51], v[96:99], v[76:79], v[36:51]
    v_mfma_f32_32x32x16_bf16 v[52:67], v[96:99], v[80:83], v[52:67]
    ds_read_b128 v[76:79], v101 offset:0
    ds_read_b128 v[80:83], v101 offset:4096
    ds_read_b64_tr_b16 v[92:93], v104 offset:4096
    ds_read_b64_tr_b16 v[94:95], v104 offset:5120
    ds_read_b64_tr_b16 v[96:97], v105 offset:4096
    ds_read_b64_tr_b16 v[98:99], v105 offset:5120
    s_waitcnt lgkmcnt(6)
    v_mfma_f32_32x32x16_bf16 v[4:19], v[84:87], v[68:71], v[4:19]
    v_mfma_f32_32x32x16_bf16 v[20:35], v[84:87], v[72:75], v[20:35]
    v_mfma_f32_32x32x16_bf16 v[36:51], v[88:91], v[68:71], v[36:51]
    v_mfma_f32_32x32x16_bf16 v[52:67], v[88:91], v[72:75], v[52:67]
    s_waitcnt vmcnt(0)
    s_barrier
    s_add_u32 s42, s42, 1
    s_cmp_eq_u32 s42, 8
    s_cselect_b32 s44, s47, s46
    s_cselect_b32 s42, 0, s42
    s_add_u32 s43, s43, 1
    s_cmp_eq_u32 s43, 8
    s_cselect_b32 s45, s49, s48
    s_cselect_b32 s43, 0, s43
    s_add_u32 m0, s40, 49152
    s_nop 0
    buffer_load_dwordx4 v106, s[12:15], s34 offen lds
    s_add_u32 s34, s34, s44
    s_add_u32 m0, s40, 50176
    s_nop 0
    buffer_load_dwordx4 v107, s[12:15], s35 offen lds
    s_add_u32 s35, s35, s44
    s_add_u32 m0, s40, 51200
    s_nop 0
    buffer_load_dwordx4 v108, s[12:15], s36 offen lds
    s_add_u32 s36, s36, s44
    s_add_u32 m0, s40, 52224
    s_nop 0
    buffer_load_dwordx4 v109, s[12:15], s37 offen lds
    s_add_u32 s37, s37, s44
    s_add_u32 m0, s41, 49152
    s_nop 0
    buffer_load_dwordx4 v110, s[16:19], s38 offen lds
    s_add_u32 s38, s38, s45
    s_add_u32 m0, s41, 50176
    s_nop 0
    buffer_load_dwordx4 v110, s[16:19], s39 offen lds
    s_add_u32 s39, s39, s45
    ds_read_b128 v[68:71], v102 offset:0
    ds_read_b128 v[72:75], v102 offset:4096
    ds_read_b64_tr_b16 v[84:85], v104 offset:8192
    ds_read_b64_tr_b16 v[86:87], v104 offset:9216
    ds_read_b64_tr_b16 v[88:89], v105 offset:8192
    ds_read_b64_tr_b16 v[90:91], v105 offset:9216
    s_waitcnt lgkmcnt(6)
    v_mfma_f32_32x32x16_bf16 v[4:19], v[92:95], v[76:79], v[4:19]
    v_mfma_f32_32x32x16_bf16 v[20:35], v[92:95], v[80:83], v[20:35]
    v_mfma_f32_32x32x16_bf16 v[36:51], v[96:99], v[76:79], v[36:51]
    v_mfma_f32_32x32x16_bf16 v[52:67], v[96:99], v[80:83], v[52:67]
    ds_read_b128 v[76:79], v103 offset:0
    ds_read_b128 v[80:83], v103 offset:4096
    ds_read_b64_tr_b16 v[92:93], v104 offset:12288
    ds_read_b64_tr_b16 v[94:95], v104 offset:13312
    ds_read_b64_tr_b16 v[96:97], v105 offset:12288
    ds_read_b64_tr_b16 v[98:99], v105 offset:13312
    s_waitcnt lgkmcnt(6)
    v_mfma_f32_32x32x16_bf16 v[4:19], v[84:87], v[68:71], v[4:19]
    v_mfma_f32_32x32x16_bf16 v[20:35], v[84:87], v[72:75], v[20:35]
    v_mfma_f32_32x32x16_bf16 v[36:51], v[88:91], v[68:71], v[36:51]
    v_mfma_f32_32x32x16_bf16 v[52:67], v[88:91], v[72:75], v[52:67]
    v_subrev_u32 v100, 98304, v100
    v_subrev_u32 v101, 98304, v101
    v_subrev_u32 v102, 98304, v102
    v_subrev_u32 v103, 98304, v103
    v_subrev_u32 v104, 98304, v104
    v_subrev_u32 v105, 98304, v105
    ds_read_b128 v[68:71], v100 offset:0
    ds_read_b128 v[72:75], v100 offset:4096
    ds_read_b64_tr_b16 v[84:85], v104 offset:0
    ds_read_b64_tr_b16 v[86:87], v104 offset:1024
    ds_read_b64_tr_b16 v[88:89], v105 offset:0
    ds_read_b64_tr_b16 v[90:91], v105 offset:1024
    s_waitcnt lgkmcnt(6)
    v_mfma_f32_32x32x16_bf16 v[4:19], v[92:95], v[76:79], v[4:19]
    v_mfma_f32_32x32x16_bf16 v[20:35], v[92:95], v[80:83], v[20:35]
    v_mfma_f32_32x32x16_bf16 v[36:51], v[96:99], v[76:79], v[36:51]
    v_mfma_f32_32x32x16_bf16 v[52:67], v[96:99], v[80:83], v[52:67]
    ds_read_b128 v[76:79], v101 offset:0
    ds_read_b128 v[80:83], v101 offset:4096
    ds_read_b64_tr_b16 v[92:93], v104 offset:4096
    ds_read_b64_tr_b16 v[94:95], v104 offset:5120
    ds_read_b64_tr_b16 v[96:97], v105 offset:4096
    ds_read_b64_tr_b16 v[98:99], v105 offset:5120
    s_waitcnt lgkmcnt(6)
    v_mfma_f32_32x32x16_bf16 v[4:19], v[84:87], v[68:71], v[4:19]
    v_mfma_f32_32x32x16_bf16 v[20:35], v[84:87], v[72:75], v[20:35]
    v_mfma_f32_32x32x16_bf16 v[36:51], v[88:91], v[68:71], v[36:51]
    v_mfma_f32_32x32x16_bf16 v[52:67], v[88:91], v[72:75], v[52:67]
    s_waitcnt vmcnt(0)
    s_barrier
    s_add_u32 s42, s42, 1
    s_cmp_eq_u32 s42, 8
    s_cselect_b32 s44, s47, s46
    s_cselect_b32 s42, 0, s42
    s_add_u32 s43, s43, 1
    s_cmp_eq_u32 s43, 8
    s_cselect_b32 s45, s49, s48
    s_cselect_b32 s43, 0, s43
    s_add_u32 m0, s40, 98304
    s_nop 0
    buffer_load_dwordx4 v106, s[12:15], s34 offen lds
    s_add_u32 s34, s34, s44
    s_add_u32 m0, s40, 99328
    s_nop 0
    buffer_load_dwordx4 v107, s[12:15], s35 offen lds
    s_add_u32 s35, s35, s44
    s_add_u32 m0, s40, 100352
    s_nop 0
    buffer_load_dwordx4 v108, s[12:15], s36 offen lds
    s_add_u32 s36, s36, s44
    s_add_u32 m0, s40, 101376
    s_nop 0
    buffer_load_dwordx4 v109, s[12:15], s37 offen lds
    s_add_u32 s37, s37, s44
    s_add_u32 m0, s41, 98304
    s_nop 0
    buffer_load_dwordx4 v110, s[16:19], s38 offen lds
    s_add_u32 s38, s38, s45
    s_add_u32 m0, s41, 99328
    s_nop 0
    buffer_load_dwordx4 v110, s[16:19], s39 offen lds
    s_add_u32 s39, s39, s45
    ds_read_b128 v[68:71], v102 offset:0
    ds_read_b128 v[72:75], v102 offset:4096
    ds_read_b64_tr_b16 v[84:85], v104 offset:8192
    ds_read_b64_tr_b16 v[86:87], v104 offset:9216
    ds_read_b64_tr_b16 v[88:89], v105 offset:8192
    ds_read_b64_tr_b16 v[90:91], v105 offset:9216
    s_waitcnt lgkmcnt(6)
    v_mfma_f32_32x32x16_bf16 v[4:19], v[92:95], v[76:79], v[4:19]
    v_mfma_f32_32x32x16_bf16 v[20:35], v[92:95], v[80:83], v[20:35]
    v_mfma_f32_32x32x16_bf16 v[36:51], v[96:99], v[76:79], v[36:51]
    v_mfma_f32_32x32x16_bf16 v[52:67], v[96:99], v[80:83], v[52:67]
    ds_read_b128 v[76:79], v103 offset:0
    ds_read_b128 v[80:83], v103 offset:4096
    ds_read_b64_tr_b16 v[92:93], v104 offset:12288
    ds_read_b64_tr_b16 v[94:95], v104 offset:13312
    ds_read_b64_tr_b16 v[96:97], v105 offset:12288
    ds_read_b64_tr_b16 v[98:99], v105 offset:13312
    s_waitcnt lgkmcnt(6)
    v_mfma_f32_32x32x16_bf16 v[4:19], v[84:87], v[68:71], v[4:19]
    v_mfma_f32_32x32x16_bf16 v[20:35], v[84:87], v[72:75], v[20:35]
    v_mfma_f32_32x32x16_bf16 v[36:51], v[88:91], v[68:71], v[36:51]
    v_mfma_f32_32x32x16_bf16 v[52:67], v[88:91], v[72:75], v[52:67]
    v_add_u32 v100, 49152, v100
    v_add_u32 v101, 49152, v101
    v_add_u32 v102, 49152, v102
    v_add_u32 v103, 49152, v103
    v_add_u32 v104, 49152, v104
    v_add_u32 v105, 49152, v105
    ds_read_b128 v[68:71], v100 offset:0
    ds_read_b128 v[72:75], v100 offset:4096
    ds_read_b64_tr_b16 v[84:85], v104 offset:0
    ds_read_b64_tr_b16 v[86:87], v104 offset:1024
    ds_read_b64_tr_b16 v[88:89], v105 offset:0
    ds_read_b64_tr_b16 v[90:91], v105 offset:1024
    s_waitcnt lgkmcnt(6)
    v_mfma_f32_32x32x16_bf16 v[4:19], v[92:95], v[76:79], v[4:19]
    v_mfma_f32_32x32x16_bf16 v[20:35], v[92:95], v[80:83], v[20:35]
    v_mfma_f32_32x32x16_bf16 v[36:51], v[96:99], v[76:79], v[36:51]
    v_mfma_f32_32x32x16_bf16 v[52:67], v[96:99], v[80:83], v[52:67]
    ds_read_b128 v[76:79], v101 offset:0
    ds_read_b128 v[80:83], v101 offset:4096
    ds_read_b64_tr_b16 v[92:93], v104 offset:4096
    ds_read_b64_tr_b16 v[94:95], v104 offset:5120
    ds_read_b64_tr_b16 v[96:97], v105 offset:4096
    ds_read_b64_tr_b16 v[98:99], v105 offset:5120
    s_waitcnt lgkmcnt(6)
    v_mfma_f32_32x32x16_bf16 v[4:19], v[84:87], v[68:71], v[4:19]
    v_mfma_f32_32x32x16_bf16 v[20:35], v[84:87], v[72:75], v[20:35]
    v_mfma_f32_32x32x16_bf16 v[36:51], v[88:91], v[68:71], v[36:51]
    v_mfma_f32_32x32x16_bf16 v[52:67], v[88:91], v[72:75], v[52:67]
    s_waitcnt vmcnt(0)
    s_barrier
    s_add_u32 s42, s42, 1
    s_cmp_eq_u32 s42, 8
    s_cselect_b32 s44, s47, s46
    s_cselect_b32 s42, 0, s42
    s_add_u32 s43, s43, 1
    s_cmp_eq_u32 s43, 8
    s_cselect_b32 s45, s49, s48
    s_cselect_b32 s43, 0, s43
    s_add_u32 m0, s40, 0
    s_nop 0
    buffer_load_dwordx4 v106, s[12:15], s34 offen lds
    s_add_u32 s34, s34, s44
    s_add_u32 m0, s40, 1024
    s_nop 0
    buffer_load_dwordx4 v107, s[12:15], s35 offen lds
    s_add_u32 s35, s35, s44
    s_add_u32 m0, s40, 2048
    s_nop 0
    buffer_load_dwordx4 v108, s[12:15], s36 offen lds
    s_add_u32 s36, s36, s44
    s_add_u32 m0, s40, 3072
    s_nop 0
    buffer_load_dwordx4 v109, s[12:15], s37 offen lds
    s_add_u32 s37, s37, s44
    s_add_u32 m0, s41, 0
    s_nop 0
    buffer_load_dwordx4 v110, s[16:19], s38 offen lds
    s_add_u32 s38, s38, s45
    s_add_u32 m0, s41, 1024
    s_nop 0
    buffer_load_dwordx4 v110, s[16:19], s39 offen lds
    s_add_u32 s39, s39, s45
    ds_read_b128 v[68:71], v102 offset:0
    ds_read_b128 v[72:75], v102 offset:4096
    ds_read_b64_tr_b16 v[84:85], v104 offset:8192
    ds_read_b64_tr_b16 v[86:87], v104 offset:9216
    ds_read_b64_tr_b16 v[88:89], v105 offset:8192
    ds_read_b64_tr_b16 v[90:91], v105 offset:9216
    s_waitcnt lgkmcnt(6)
    v_mfma_f32_32x32x16_bf16 v[4:19], v[92:95], v[76:79], v[4:19]
    v_mfma_f32_32x32x16_bf16 v[20:35], v[92:95], v[80:83], v[20:35]
    v_mfma_f32_32x32x16_bf16 v[36:51], v[96:99], v[76:79], v[36:51]
    v_mfma_f32_32x32x16_bf16 v[52:67], v[96:99], v[80:83], v[52:67]
    ds_read_b128 v[76:79], v103 offset:0
    ds_read_b128 v[80:83], v103 offset:4096
    ds_read_b64_tr_b16 v[92:93], v104 offset:12288
    ds_read_b64_tr_b16 v[94:95], v104 offset:13312
    ds_read_b64_tr_b16 v[96:97], v105 offset:12288
    ds_read_b64_tr_b16 v[98:99], v105 offset:13312
    s_waitcnt lgkmcnt(6)
    v_mfma_f32_32x32x16_bf16 v[4:19], v[84:87], v[68:71], v[4:19]
    v_mfma_f32_32x32x16_bf16 v[20:35], v[84:87], v[72:75], v[20:35]
    v_mfma_f32_32x32x16_bf16 v[36:51], v[88:91], v[68:71], v[36:51]
    v_mfma_f32_32x32x16_bf16 v[52:67], v[88:91], v[72:75], v[52:67]
    v_add_u32 v100, 49152, v100
    v_add_u32 v101, 49152, v101
    v_add_u32 v102, 49152, v102
    v_add_u32 v103, 49152, v103
    v_add_u32 v104, 49152, v104
    v_add_u32 v105, 49152, v105
    ds_read_b128 v[68:71], v100 offset:0
    ds_read_b128 v[72:75], v100 offset:4096
    ds_read_b64_tr_b16 v[84:85], v104 offset:0
    ds_read_b64_tr_b16 v[86:87], v104 offset:1024
    ds_read_b64_tr_b16 v[88:89], v105 offset:0
    ds_read_b64_tr_b16 v[90:91], v105 offset:1024
    s_waitcnt lgkmcnt(6)
    v_mfma_f32_32x32x16_bf16 v[4:19], v[92:95], v[76:79], v[4:19]
    v_mfma_f32_32x32x16_bf16 v[20:35], v[92:95], v[80:83], v[20:35]
    v_mfma_f32_32x32x16_bf16 v[36:51], v[96:99], v[76:79], v[36:51]
    v_mfma_f32_32x32x16_bf16 v[52:67], v[96:99], v[80:83], v[52:67]
    ds_read_b128 v[76:79], v101 offset:0
    ds_read_b128 v[80:83], v101 offset:4096
    ds_read_b64_tr_b16 v[92:93], v104 offset:4096
    ds_read_b64_tr_b16 v[94:95], v104 offset:5120
    ds_read_b64_tr_b16 v[96:97], v105 offset:4096
    ds_read_b64_tr_b16 v[98:99], v105 offset:5120
    s_waitcnt lgkmcnt(6)
    v_mfma_f32_32x32x16_bf16 v[4:19], v[84:87], v[68:71], v[4:19]
    v_mfma_f32_32x32x16_bf16 v[20:35], v[84:87], v[72:75], v[20:35]
    v_mfma_f32_32x32x16_bf16 v[36:51], v[88:91], v[68:71], v[36:51]
    v_mfma_f32_32x32x16_bf16 v[52:67], v[88:91], v[72:75], v[52:67]
    s_waitcnt vmcnt(0)
    s_barrier
    s_add_u32 s42, s42, 1
    s_cmp_eq_u32 s42, 8
    s_cselect_b32 s44, s47, s46
    s_cselect_b32 s42, 0, s42
    s_add_u32 s43, s43, 1
    s_cmp_eq_u32 s43, 8
    s_cselect_b32 s45, s49, s48
    s_cselect_b32 s43, 0, s43
    s_add_u32 m0, s40, 49152
    s_nop 0
    buffer_load_dwordx4 v106, s[12:15], s34 offen lds
    s_add_u32 s34, s34, s44
    s_add_u32 m0, s40, 50176
    s_nop 0
    buffer_load_dwordx4 v107, s[12:15], s35 offen lds
    s_add_u32 s35, s35, s44
    s_add_u32 m0, s40, 51200
    s_nop 0
    buffer_load_dwordx4 v108, s[12:15], s36 offen lds
    s_add_u32 s36, s36, s44
    s_add_u32 m0, s40, 52224
    s_nop 0
    buffer_load_dwordx4 v109, s[12:15], s37 offen lds
    s_add_u32 s37, s37, s44
    s_add_u32 m0, s41, 49152
    s_nop 0
    buffer_load_dwordx4 v110, s[16:19], s38 offen lds
    s_add_u32 s38, s38, s45
    s_add_u32 m0, s41, 50176
    s_nop 0
    buffer_load_dwordx4 v110, s[16:19], s39 offen lds
    s_add_u32 s39, s39, s45
    ds_read_b128 v[68:71], v102 offset:0
    ds_read_b128 v[72:75], v102 offset:4096
    ds_read_b64_tr_b16 v[84:85], v104 offset:8192
    ds_read_b64_tr_b16 v[86:87], v104 offset:9216
    ds_read_b64_tr_b16 v[88:89], v105 offset:8192
    ds_read_b64_tr_b16 v[90:91], v105 offset:9216
    s_waitcnt lgkmcnt(6)
    v_mfma_f32_32x32x16_bf16 v[4:19], v[92:95], v[76:79], v[4:19]
    v_mfma_f32_32x32x16_bf16 v[20:35], v[92:95], v[80:83], v[20:35]
    v_mfma_f32_32x32x16_bf16 v[36:51], v[96:99], v[76:79], v[36:51]
    v_mfma_f32_32x32x16_bf16 v[52:67], v[96:99], v[80:83], v[52:67]
    ds_read_b128 v[76:79], v103 offset:0
    ds_read_b128 v[80:83], v103 offset:4096
    ds_read_b64_tr_b16 v[92:93], v104 offset:12288
    ds_read_b64_tr_b16 v[94:95], v104 offset:13312
    ds_read_b64_tr_b16 v[96:97], v105 offset:12288
    ds_read_b64_tr_b16 v[98:99], v105 offset:13312
    s_waitcnt lgkmcnt(6)
    v_mfma_f32_32x32x16_bf16 v[4:19], v[84:87], v[68:71], v[4:19]
    v_mfma_f32_32x32x16_bf16 v[20:35], v[84:87], v[72:75], v[20:35]
    v_mfma_f32_32x32x16_bf16 v[36:51], v[88:91], v[68:71], v[36:51]
    v_mfma_f32_32x32x16_bf16 v[52:67], v[88:91], v[72:75], v[52:67]
    v_subrev_u32 v100, 98304, v100
    v_subrev_u32 v101, 98304, v101
    v_subrev_u32 v102, 98304, v102
    v_subrev_u32 v103, 98304, v103
    v_subrev_u32 v104, 98304, v104
    v_subrev_u32 v105, 98304, v105
    ds_read_b128 v[68:71], v100 offset:0
    ds_read_b128 v[72:75], v100 offset:4096
    ds_read_b64_tr_b16 v[84:85], v104 offset:0
    ds_read_b64_tr_b16 v[86:87], v104 offset:1024
    ds_read_b64_tr_b16 v[88:89], v105 offset:0
    ds_read_b64_tr_b16 v[90:91], v105 offset:1024
    s_waitcnt lgkmcnt(6)
    v_mfma_f32_32x32x16_bf16 v[4:19], v[92:95], v[76:79], v[4:19]
    v_mfma_f32_32x32x16_bf16 v[20:35], v[92:95], v[80:83], v[20:35]
    v_mfma_f32_32x32x16_bf16 v[36:51], v[96:99], v[76:79], v[36:51]
    v_mfma_f32_32x32x16_bf16 v[52:67], v[96:99], v[80:83], v[52:67]
    ds_read_b128 v[76:79], v101 offset:0
    ds_read_b128 v[80:83], v101 offset:4096
    ds_read_b64_tr_b16 v[92:93], v104 offset:4096
    ds_read_b64_tr_b16 v[94:95], v104 offset:5120
    ds_read_b64_tr_b16 v[96:97], v105 offset:4096
    ds_read_b64_tr_b16 v[98:99], v105 offset:5120
    s_waitcnt lgkmcnt(6)
    v_mfma_f32_32x32x16_bf16 v[4:19], v[84:87], v[68:71], v[4:19]
    v_mfma_f32_32x32x16_bf16 v[20:35], v[84:87], v[72:75], v[20:35]
    v_mfma_f32_32x32x16_bf16 v[36:51], v[88:91], v[68:71], v[36:51]
    v_mfma_f32_32x32x16_bf16 v[52:67], v[88:91], v[72:75], v[52:67]
    s_waitcnt vmcnt(0)
    s_barrier
    ds_read_b128 v[68:71], v102 offset:0
    ds_read_b128 v[72:75], v102 offset:4096
    ds_read_b64_tr_b16 v[84:85], v104 offset:8192
    ds_read_b64_tr_b16 v[86:87], v104 offset:9216
    ds_read_b64_tr_b16 v[88:89], v105 offset:8192
    ds_read_b64_tr_b16 v[90:91], v105 offset:9216
    s_waitcnt lgkmcnt(6)
    v_mfma_f32_32x32x16_bf16 v[4:19], v[92:95], v[76:79], v[4:19]
    v_mfma_f32_32x32x16_bf16 v[20:35], v[92:95], v[80:83], v[20:35]
    v_mfma_f32_32x32x16_bf16 v[36:51], v[96:99], v[76:79], v[36:51]
    v_mfma_f32_32x32x16_bf16 v[52:67], v[96:99], v[80:83], v[52:67]
    ds_read_b128 v[76:79], v103 offset:0
    ds_read_b128 v[80:83], v103 offset:4096
    ds_read_b64_tr_b16 v[92:93], v104 offset:12288
    ds_read_b64_tr_b16 v[94:95], v104 offset:13312
    ds_read_b64_tr_b16 v[96:97], v105 offset:12288
    ds_read_b64_tr_b16 v[98:99], v105 offset:13312
    s_waitcnt lgkmcnt(6)
    v_mfma_f32_32x32x16_bf16 v[4:19], v[84:87], v[68:71], v[4:19]
    v_mfma_f32_32x32x16_bf16 v[20:35], v[84:87], v[72:75], v[20:35]
    v_mfma_f32_32x32x16_bf16 v[36:51], v[88:91], v[68:71], v[36:51]
    v_mfma_f32_32x32x16_bf16 v[52:67], v[88:91], v[72:75], v[52:67]
    v_add_u32 v100, 49152, v100
    v_add_u32 v101, 49152, v101
    v_add_u32 v102, 49152, v102
    v_add_u32 v103, 49152, v103
    v_add_u32 v104, 49152, v104
    v_add_u32 v105, 49152, v105
    ds_read_b128 v[68:71], v100 offset:0
    ds_read_b128 v[72:75], v100 offset:4096
    ds_read_b64_tr_b16 v[84:85], v104 offset:0
    ds_read_b64_tr_b16 v[86:87], v104 offset:1024
    ds_read_b64_tr_b16 v[88:89], v105 offset:0
    ds_read_b64_tr_b16 v[90:91], v105 offset:1024
    s_waitcnt lgkmcnt(6)
    v_mfma_f32_32x32x16_bf16 v[4:19], v[92:95], v[76:79], v[4:19]
    v_mfma_f32_32x32x16_bf16 v[20:35], v[92:95], v[80:83], v[20:35]
    v_mfma_f32_32x32x16_bf16 v[36:51], v[96:99], v[76:79], v[36:51]
    v_mfma_f32_32x32x16_bf16 v[52:67], v[96:99], v[80:83], v[52:67]
    ds_read_b128 v[76:79], v101 offset:0
    ds_read_b128 v[80:83], v101 offset:4096
    ds_read_b64_tr_b16 v[92:93], v104 offset:4096
    ds_read_b64_tr_b16 v[94:95], v104 offset:5120
    ds_read_b64_tr_b16 v[96:97], v105 offset:4096
    ds_read_b64_tr_b16 v[98:99], v105 offset:5120
    s_waitcnt lgkmcnt(6)
    v_mfma_f32_32x32x16_bf16 v[4:19], v[84:87], v[68:71], v[4:19]
    v_mfma_f32_32x32x16_bf16 v[20:35], v[84:87], v[72:75], v[20:35]
    v_mfma_f32_32x32x16_bf16 v[36:51], v[88:91], v[68:71], v[36:51]
    v_mfma_f32_32x32x16_bf16 v[52:67], v[88:91], v[72:75], v[52:67]
    ds_read_b128 v[68:71], v102 offset:0
    ds_read_b128 v[72:75], v102 offset:4096
    ds_read_b64_tr_b16 v[84:85], v104 offset:8192
    ds_read_b64_tr_b16 v[86:87], v104 offset:9216
    ds_read_b64_tr_b16 v[88:89], v105 offset:8192
    ds_read_b64_tr_b16 v[90:91], v105 offset:9216
    s_waitcnt lgkmcnt(6)
    v_mfma_f32_32x32x16_bf16 v[4:19], v[92:95], v[76:79], v[4:19]
    v_mfma_f32_32x32x16_bf16 v[20:35], v[92:95], v[80:83], v[20:35]
    v_mfma_f32_32x32x16_bf16 v[36:51], v[96:99], v[76:79], v[36:51]
    v_mfma_f32_32x32x16_bf16 v[52:67], v[96:99], v[80:83], v[52:67]
    ds_read_b128 v[76:79], v103 offset:0
    ds_read_b128 v[80:83], v103 offset:4096
    ds_read_b64_tr_b16 v[92:93], v104 offset:12288
    ds_read_b64_tr_b16 v[94:95], v104 offset:13312
    ds_read_b64_tr_b16 v[96:97], v105 offset:12288
    ds_read_b64_tr_b16 v[98:99], v105 offset:13312
    s_waitcnt lgkmcnt(6)
    v_mfma_f32_32x32x16_bf16 v[4:19], v[84:87], v[68:71], v[4:19]
    v_mfma_f32_32x32x16_bf16 v[20:35], v[84:87], v[72:75], v[20:35]
    v_mfma_f32_32x32x16_bf16 v[36:51], v[88:91], v[68:71], v[36:51]
    v_mfma_f32_32x32x16_bf16 v[52:67], v[88:91], v[72:75], v[52:67]
    s_waitcnt lgkmcnt(0)
    v_mfma_f32_32x32x16_bf16 v[4:19], v[92:95], v[76:79], v[4:19]
    v_mfma_f32_32x32x16_bf16 v[20:35], v[92:95], v[80:83], v[20:35]
    v_mfma_f32_32x32x16_bf16 v[36:51], v[96:99], v[76:79], v[36:51]
    v_mfma_f32_32x32x16_bf16 v[52:67], v[96:99], v[80:83], v[52:67]
    s_nop 15
    s_cmp_lt_u32 s33, 4
    s_cselect_b32 s55, 0x3eb8aa3b, 1.0
    s_lshr_b32 s50, s33, 2
    s_lshl_b32 s50, s50, 21
    s_and_b32 s51, s33, 3
    s_lshl_b32 s51, s51, 3
    s_mul_i32 s52, s30, 4
    s_add_u32 s51, s51, s52
    s_lshl_b32 s51, s51, 16
    s_add_u32 s50, s50, s51
    s_mul_i32 s51, s32, 8
    s_mul_i32 s52, s29, 2
    s_add_u32 s51, s51, s52
    s_lshl_b32 s51, s51, 10
    s_add_u32 s50, s50, s51
    v_lshlrev_b32 v114, 4, v111
    v_mul_f32 v4, s55, v4
    v_mul_f32 v5, s55, v5
    v_mul_f32 v6, s55, v6
    v_mul_f32 v7, s55, v7
    v_mul_f32 v8, s55, v8
    v_mul_f32 v9, s55, v9
    v_mul_f32 v10, s55, v10
    v_mul_f32 v11, s55, v11
    v_cvt_pk_bf16_f32 v68, v4, v5
    v_cvt_pk_bf16_f32 v69, v6, v7
    v_cvt_pk_bf16_f32 v70, v8, v9
    v_cvt_pk_bf16_f32 v71, v10, v11
    s_add_u32 s51, s50, 0
    buffer_store_dwordx4 v[68:71], v114, s[20:23], s51 offen
    v_mul_f32 v12, s55, v12
    v_mul_f32 v13, s55, v13
    v_mul_f32 v14, s55, v14
    v_mul_f32 v15, s55, v15
    v_mul_f32 v16, s55, v16
    v_mul_f32 v17, s55, v17
    v_mul_f32 v18, s55, v18
    v_mul_f32 v19, s55, v19
    v_cvt_pk_bf16_f32 v76, v12, v13
    v_cvt_pk_bf16_f32 v77, v14, v15
    v_cvt_pk_bf16_f32 v78, v16, v17
    v_cvt_pk_bf16_f32 v79, v18, v19
    s_add_u32 s51, s50, 65536
    buffer_store_dwordx4 v[76:79], v114, s[20:23], s51 offen
    v_mul_f32 v20, s55, v20
    v_mul_f32 v21, s55, v21
    v_mul_f32 v22, s55, v22
    v_mul_f32 v23, s55, v23
    v_mul_f32 v24, s55, v24
    v_mul_f32 v25, s55, v25
    v_mul_f32 v26, s55, v26
    v_mul_f32 v27, s55, v27
    v_cvt_pk_bf16_f32 v84, v20, v21
    v_cvt_pk_bf16_f32 v85, v22, v23
    v_cvt_pk_bf16_f32 v86, v24, v25
    v_cvt_pk_bf16_f32 v87, v26, v27
    s_add_u32 s51, s50, 1024
    buffer_store_dwordx4 v[84:87], v114, s[20:23], s51 offen
    v_mul_f32 v28, s55, v28
    v_mul_f32 v29, s55, v29
    v_mul_f32 v30, s55, v30
    v_mul_f32 v31, s55, v31
    v_mul_f32 v32, s55, v32
    v_mul_f32 v33, s55, v33
    v_mul_f32 v34, s55, v34
    v_mul_f32 v35, s55, v35
    v_cvt_pk_bf16_f32 v92, v28, v29
    v_cvt_pk_bf16_f32 v93, v30, v31
    v_cvt_pk_bf16_f32 v94, v32, v33
    v_cvt_pk_bf16_f32 v95, v34, v35
    s_add_u32 s51, s50, 66560
    buffer_store_dwordx4 v[92:95], v114, s[20:23], s51 offen
    v_mul_f32 v36, s55, v36
    v_mul_f32 v37, s55, v37
    v_mul_f32 v38, s55, v38
    v_mul_f32 v39, s55, v39
    v_mul_f32 v40, s55, v40
    v_mul_f32 v41, s55, v41
    v_mul_f32 v42, s55, v42
    v_mul_f32 v43, s55, v43
    v_cvt_pk_bf16_f32 v68, v36, v37
    v_cvt_pk_bf16_f32 v69, v38, v39
    v_cvt_pk_bf16_f32 v70, v40, v41
    v_cvt_pk_bf16_f32 v71, v42, v43
    s_add_u32 s51, s50, 131072
    buffer_store_dwordx4 v[68:71], v114, s[20:23], s51 offen
    v_mul_f32 v44, s55, v44
    v_mul_f32 v45, s55, v45
    v_mul_f32 v46, s55, v46
    v_mul_f32 v47, s55, v47
    v_mul_f32 v48, s55, v48
    v_mul_f32 v49, s55, v49
    v_mul_f32 v50, s55, v50
    v_mul_f32 v51, s55, v51
    v_cvt_pk_bf16_f32 v76, v44, v45
    v_cvt_pk_bf16_f32 v77, v46, v47
    v_cvt_pk_bf16_f32 v78, v48, v49
    v_cvt_pk_bf16_f32 v79, v50, v51
    s_add_u32 s51, s50, 196608
    buffer_store_dwordx4 v[76:79], v114, s[20:23], s51 offen
    v_mul_f32 v52, s55, v52
    v_mul_f32 v53, s55, v53
    v_mul_f32 v54, s55, v54
    v_mul_f32 v55, s55, v55
    v_mul_f32 v56, s55, v56
    v_mul_f32 v57, s55, v57
    v_mul_f32 v58, s55, v58
    v_mul_f32 v59, s55, v59
    v_cvt_pk_bf16_f32 v84, v52, v53
    v_cvt_pk_bf16_f32 v85, v54, v55
    v_cvt_pk_bf16_f32 v86, v56, v57
    v_cvt_pk_bf16_f32 v87, v58, v59
    s_add_u32 s51, s50, 132096
    buffer_store_dwordx4 v[84:87], v114, s[20:23], s51 offen
    v_mul_f32 v60, s55, v60
    v_mul_f32 v61, s55, v61
    v_mul_f32 v62, s55, v62
    v_mul_f32 v63, s55, v63
    v_mul_f32 v64, s55, v64
    v_mul_f32 v65, s55, v65
    v_mul_f32 v66, s55, v66
    v_mul_f32 v67, s55, v67
    v_cvt_pk_bf16_f32 v92, v60, v61
    v_cvt_pk_bf16_f32 v93, v62, v63
    v_cvt_pk_bf16_f32 v94, v64, v65
    v_cvt_pk_bf16_f32 v95, v66, v67
    s_add_u32 s51, s50, 197632
    buffer_store_dwordx4 v[92:95], v114, s[20:23], s51 offen
    s_endpgm
k1_role_V:
    s_sub_u32 s7, s7, 8
    s_lshl_b32 s7, s7, 3
    s_add_u32 s3, s7, s6
    s_load_dwordx2 s[4:5], s[0:1], 0
    s_load_dwordx2 s[6:7], s[0:1], 8
    s_load_dwordx2 s[8:9], s[0:1], 88
    v_lshrrev_b32 v114, 6, v0
    v_and_b32 v111, 63, v0
    s_nop 0
    v_readfirstlane_b32 s28, v114
    v_lshrrev_b32 v112, 5, v111
    v_and_b32 v113, 31, v111
    s_and_b32 s32, s3, 7
    s_lshr_b32 s33, s3, 3
    s_and_b32 s31, s28, 0
    s_lshr_b32 s50, s28, 0
    s_and_b32 s29, s50, 3
    s_lshr_b32 s30, s50, 2
    s_waitcnt lgkmcnt(0)
    s_mov_b32 s12, s4
    s_mov_b32 s13, s5
    s_mov_b32 s14, 2097152
    s_mov_b32 s15, 0x00020000
    s_mul_i32 s50, s33, 256
    s_add_u32 s50, s50, 2048
    s_add_u32 s6, s6, s50
    s_addc_u32 s7, s7, 0
    s_sub_u32 s51, 1572864, s50
    s_mov_b32 s16, s6
    s_mov_b32 s17, s7
    s_mov_b32 s18, s51
    s_mov_b32 s19, 0x00020000
    s_add_u32 s50, s8, 4194304
    s_addc_u32 s51, s9, 0
    s_mov_b32 s20, s50
    s_mov_b32 s21, s51
    s_mov_b32 s22, 2097152
    s_mov_b32 s23, 0x00020000
    v_lshrrev_b32 v114, 3, v111
    v_and_b32 v115, 7, v111
    s_mul_i32 s50, s28, 32
    s_mov_b32 s51, 1024
    v_add_u32 v116, s50, v114
    v_lshrrev_b32 v116, 1, v116
    v_and_b32 v116, 7, v116
    v_xor_b32 v116, v116, v115
    v_lshlrev_b32 v116, 4, v116
    v_mul_lo_u32 v117, v114, s51
    v_add_u32 v106, v116, v117
    v_add_u32 v116, s50, v114
    v_add_u32 v116, 8, v116
    v_lshrrev_b32 v116, 1, v116
    v_and_b32 v116, 7, v116
    v_xor_b32 v116, v116, v115
    v_lshlrev_b32 v116, 4, v116
    v_mul_lo_u32 v117, v114, s51
    v_add_u32 v107, v116, v117
    v_add_u32 v116, s50, v114
    v_add_u32 v116, 16, v116
    v_lshrrev_b32 v116, 1, v116
    v_and_b32 v116, 7, v116
    v_xor_b32 v116, v116, v115
    v_lshlrev_b32 v116, 4, v116
    v_mul_lo_u32 v117, v114, s51
    v_add_u32 v108, v116, v117
    v_add_u32 v116, s50, v114
    v_add_u32 v116, 24, v116
    v_lshrrev_b32 v116, 1, v116
    v_and_b32 v116, 7, v116
    v_xor_b32 v116, v116, v115
    v_lshlrev_b32 v116, 4, v116
    v_mul_lo_u32 v117, v114, s51
    v_add_u32 v109, v116, v117
    s_mul_i32 s52, s32, 256
    s_add_u32 s52, s52, s50
    s_add_u32 s53, s52, 0
    s_mul_i32 s34, s53, 1024
    s_add_u32 s53, s52, 8
    s_mul_i32 s35, s53, 1024
    s_add_u32 s53, s52, 16
    s_mul_i32 s36, s53, 1024
    s_add_u32 s53, s52, 24
    s_mul_i32 s37, s53, 1024
    s_mul_i32 s40, s28, 4096
    v_lshrrev_b32 v114, 4, v111
    v_and_b32 v115, 15, v111
    v_and_b32 v116, 3, v114
    v_lshlrev_b32 v116, 2, v116
    v_xor_b32 v115, v115, v116
    v_lshlrev_b32 v115, 4, v115
    s_mov_b32 s51, 3072
    v_mul_lo_u32 v117, v114, s51
    v_add_u32 v110, v115, v117
    s_mul_i32 s52, s28, 8
    s_add_u32 s52, s52, 0
    s_mul_i32 s38, s52, 3072
    s_mul_i32 s52, s28, 8
    s_add_u32 s52, s52, 4
    s_mul_i32 s39, s52, 3072
    s_mul_i32 s41, s28, 2048
    s_add_u32 s41, s41, 32768
    s_mov_b32 s46, 128
    s_mov_b32 s47, 4294966400
    s_mov_b32 s48, 196608
    s_mov_b32 s49, 4293591040
    s_mul_i32 s50, s32, 3
    s_add_u32 s50, s50, s33
    s_lshl_b32 s50, s50, 0
    s_and_b32 s42, s50, 7
    s_mov_b32 s43, s42
    s_mul_i32 s51, s42, 128
    s_add_u32 s34, s34, s51
    s_add_u32 s35, s35, s51
    s_add_u32 s36, s36, s51
    s_add_u32 s37, s37, s51
    s_mul_i32 s51, s42, 196608
    s_add_u32 s38, s38, s51
    s_add_u32 s39, s39, s51
    s_add_u32 s42, s42, 1
    s_cmp_eq_u32 s42, 8
    s_cselect_b32 s44, s47, s46
    s_cselect_b32 s42, 0, s42
    s_add_u32 s43, s43, 1
    s_cmp_eq_u32 s43, 8
    s_cselect_b32 s45, s49, s48
    s_cselect_b32 s43, 0, s43
    s_add_u32 m0, s40, 0
    s_nop 0
    buffer_load_dwordx4 v106, s[12:15], s34 offen lds
    s_add_u32 s34, s34, s44
    s_add_u32 m0, s40, 1024
    s_nop 0
    buffer_load_dwordx4 v107, s[12:15], s35 offen lds
    s_add_u32 s35, s35, s44
    s_add_u32 m0, s40, 2048
    s_nop 0
    buffer_load_dwordx4 v108, s[12:15], s36 offen lds
    s_add_u32 s36, s36, s44
    s_add_u32 m0, s40, 3072
    s_nop 0
    buffer_load_dwordx4 v109, s[12:15], s37 offen lds
    s_add_u32 s37, s37, s44
    s_add_u32 m0, s41, 0
    s_nop 0
    buffer_load_dwordx4 v110, s[16:19], s38 offen lds
    s_add_u32 s38, s38, s45
    s_add_u32 m0, s41, 1024
    s_nop 0
    buffer_load_dwordx4 v110, s[16:19], s39 offen lds
    s_add_u32 s39, s39, s45
    s_add_u32 s42, s42, 1
    s_cmp_eq_u32 s42, 8
    s_cselect_b32 s44, s47, s46
    s_cselect_b32 s42, 0, s42
    s_add_u32 s43, s43, 1
    s_cmp_eq_u32 s43, 8
    s_cselect_b32 s45, s49, s48
    s_cselect_b32 s43, 0, s43
    s_add_u32 m0, s40, 49152
    s_nop 0
    buffer_load_dwordx4 v106, s[12:15], s34 offen lds
    s_add_u32 s34, s34, s44
    s_add_u32 m0, s40, 50176
    s_nop 0
    buffer_load_dwordx4 v107, s[12:15], s35 offen lds
    s_add_u32 s35, s35, s44
    s_add_u32 m0, s40, 51200
    s_nop 0
    buffer_load_dwordx4 v108, s[12:15], s36 offen lds
    s_add_u32 s36, s36, s44
    s_add_u32 m0, s40, 52224
    s_nop 0
    buffer_load_dwordx4 v109, s[12:15], s37 offen lds
    s_add_u32 s37, s37, s44
    s_add_u32 m0, s41, 49152
    s_nop 0
    buffer_load_dwordx4 v110, s[16:19], s38 offen lds
    s_add_u32 s38, s38, s45
    s_add_u32 m0, s41, 50176
    s_nop 0
    buffer_load_dwordx4 v110, s[16:19], s39 offen lds
    s_add_u32 s39, s39, s45
    s_mul_i32 s50, s29, 8192
    v_mul_u32_u24 v114, 128, v113
    v_add_u32 v114, s50, v114
    v_mov_b32 v115, v113
    v_lshrrev_b32 v115, 1, v115
    v_and_b32 v115, 7, v115
    s_lshl_b32 s51, s31, 1
    v_add_u32 v116, s51, v112
    v_add_u32 v117, 0, v116
    v_xor_b32 v117, v117, v115
    v_lshlrev_b32 v117, 4, v117
    v_add_u32 v100, v114, v117
    v_add_u32 v117, 2, v116
    v_xor_b32 v117, v117, v115
    v_lshlrev_b32 v117, 4, v117
    v_add_u32 v101, v114, v117
    v_add_u32 v117, 4, v116
    v_xor_b32 v117, v117, v115
    v_lshlrev_b32 v117, 4, v117
    v_add_u32 v102, v114, v117
    v_add_u32 v117, 6, v116
    v_xor_b32 v117, v117, v115
    v_lshlrev_b32 v117, 4, v117
    v_add_u32 v103, v114, v117
    v_and_b32 v114, 15, v111
    v_lshrrev_b32 v114, 2, v114
    v_mul_u32_u24 v115, 8, v112
    v_add_u32 v115, v115, v114
    v_mul_u32_u24 v115, 256, v115
    v_lshlrev_b32 v116, 2, v114
    v_lshrrev_b32 v117, 4, v111
    v_and_b32 v117, 1, v117
    v_lshlrev_b32 v117, 1, v117
    v_and_b32 v118, 3, v111
    v_lshrrev_b32 v119, 1, v118
    v_add_u32 v117, v117, v119
    s_mul_i32 s50, s30, 8
    v_add_u32 v117, s50, v117
    v_and_b32 v118, 1, v118
    v_lshlrev_b32 v118, 3, v118
    v_add_u32 v118, v118, v115
    v_add_u32 v118, 32768, v118
    v_add_u32 v119, 0, v117
    v_xor_b32 v119, v119, v116
    v_lshlrev_b32 v119, 4, v119
    v_add_u32 v104, v118, v119
    v_add_u32 v119, 4, v117
    v_xor_b32 v119, v119, v116
    v_lshlrev_b32 v119, 4, v119
    v_add_u32 v105, v118, v119
    v_mov_b32 v4, 0
    v_mov_b32 v5, 0
    v_mov_b32 v6, 0
    v_mov_b32 v7, 0
    v_mov_b32 v8, 0
    v_mov_b32 v9, 0
    v_mov_b32 v10, 0
    v_mov_b32 v11, 0
    v_mov_b32 v12, 0
    v_mov_b32 v13, 0
    v_mov_b32 v14, 0
    v_mov_b32 v15, 0
    v_mov_b32 v16, 0
    v_mov_b32 v17, 0
    v_mov_b32 v18, 0
    v_mov_b32 v19, 0
    v_mov_b32 v20, 0
    v_mov_b32 v21, 0
    v_mov_b32 v22, 0
    v_mov_b32 v23, 0
    v_mov_b32 v24, 0
    v_mov_b32 v25, 0
    v_mov_b32 v26, 0
    v_mov_b32 v27, 0
    v_mov_b32 v28, 0
    v_mov_b32 v29, 0
    v_mov_b32 v30, 0
    v_mov_b32 v31, 0
    v_mov_b32 v32, 0
    v_mov_b32 v33, 0
    v_mov_b32 v34, 0
    v_mov_b32 v35, 0
    v_mov_b32 v36, 0
    v_mov_b32 v37, 0
    v_mov_b32 v38, 0
    v_mov_b32 v39, 0
    v_mov_b32 v40, 0
    v_mov_b32 v41, 0
    v_mov_b32 v42, 0
    v_mov_b32 v43, 0
    v_mov_b32 v44, 0
    v_mov_b32 v45, 0
    v_mov_b32 v46, 0
    v_mov_b32 v47, 0
    v_mov_b32 v48, 0
    v_mov_b32 v49, 0
    v_mov_b32 v50, 0
    v_mov_b32 v51, 0
    v_mov_b32 v52, 0
    v_mov_b32 v53, 0
    v_mov_b32 v54, 0
    v_mov_b32 v55, 0
    v_mov_b32 v56, 0
    v_mov_b32 v57, 0
    v_mov_b32 v58, 0
    v_mov_b32 v59, 0
    v_mov_b32 v60, 0
    v_mov_b32 v61, 0
    v_mov_b32 v62, 0
    v_mov_b32 v63, 0
    v_mov_b32 v64, 0
    v_mov_b32 v65, 0
    v_mov_b32 v66, 0
    v_mov_b32 v67, 0
    s_waitcnt vmcnt(6)
    s_barrier
    ds_read_b128 v[68:71], v100 offset:0
    ds_read_b128 v[72:75], v100 offset:4096
    ds_read_b64_tr_b16 v[84:85], v104 offset:0
    ds_read_b64_tr_b16 v[86:87], v104 offset:1024
    ds_read_b64_tr_b16 v[88:89], v105 offset:0
    ds_read_b64_tr_b16 v[90:91], v105 offset:1024
    ds_read_b128 v[76:79], v101 offset:0
    ds_read_b128 v[80:83], v101 offset:4096
    ds_read_b64_tr_b16 v[92:93], v104 offset:4096
    ds_read_b64_tr_b16 v[94:95], v104 offset:5120
    ds_read_b64_tr_b16 v[96:97], v105 offset:4096
    ds_read_b64_tr_b16 v[98:99], v105 offset:5120
    s_waitcnt lgkmcnt(6)
    v_mfma_f32_32x32x16_bf16 v[4:19], v[68:71], v[84:87], v[4:19]
    v_mfma_f32_32x32x16_bf16 v[20:35], v[72:75], v[84:87], v[20:35]
    v_mfma_f32_32x32x16_bf16 v[36:51], v[68:71], v[88:91], v[36:51]
    v_mfma_f32_32x32x16_bf16 v[52:67], v[72:75], v[88:91], v[52:67]
    s_waitcnt vmcnt(0)
    s_barrier
    s_add_u32 s42, s42, 1
    s_cmp_eq_u32 s42, 8
    s_cselect_b32 s44, s47, s46
    s_cselect_b32 s42, 0, s42
    s_add_u32 s43, s43, 1
    s_cmp_eq_u32 s43, 8
    s_cselect_b32 s45, s49, s48
    s_cselect_b32 s43, 0, s43
    s_add_u32 m0, s40, 98304
    s_nop 0
    buffer_load_dwordx4 v106, s[12:15], s34 offen lds
    s_add_u32 s34, s34, s44
    s_add_u32 m0, s40, 99328
    s_nop 0
    buffer_load_dwordx4 v107, s[12:15], s35 offen lds
    s_add_u32 s35, s35, s44
    s_add_u32 m0, s40, 100352
    s_nop 0
    buffer_load_dwordx4 v108, s[12:15], s36 offen lds
    s_add_u32 s36, s36, s44
    s_add_u32 m0, s40, 101376
    s_nop 0
    buffer_load_dwordx4 v109, s[12:15], s37 offen lds
    s_add_u32 s37, s37, s44
    s_add_u32 m0, s41, 98304
    s_nop 0
    buffer_load_dwordx4 v110, s[16:19], s38 offen lds
    s_add_u32 s38, s38, s45
    s_add_u32 m0, s41, 99328
    s_nop 0
    buffer_load_dwordx4 v110, s[16:19], s39 offen lds
    s_add_u32 s39, s39, s45
    ds_read_b128 v[68:71], v102 offset:0
    ds_read_b128 v[72:75], v102 offset:4096
    ds_read_b64_tr_b16 v[84:85], v104 offset:8192
    ds_read_b64_tr_b16 v[86:87], v104 offset:9216
    ds_read_b64_tr_b16 v[88:89], v105 offset:8192
    ds_read_b64_tr_b16 v[90:91], v105 offset:9216
    s_waitcnt lgkmcnt(6)
    v_mfma_f32_32x32x16_bf16 v[4:19], v[76:79], v[92:95], v[4:19]
    v_mfma_f32_32x32x16_bf16 v[20:35], v[80:83], v[92:95], v[20:35]
    v_mfma_f32_32x32x16_bf16 v[36:51], v[76:79], v[96:99], v[36:51]
    v_mfma_f32_32x32x16_bf16 v[52:67], v[80:83], v[96:99], v[52:67]
    ds_read_b128 v[76:79], v103 offset:0
    ds_read_b128 v[80:83], v103 offset:4096
    ds_read_b64_tr_b16 v[92:93], v104 offset:12288
    ds_read_b64_tr_b16 v[94:95], v104 offset:13312
    ds_read_b64_tr_b16 v[96:97], v105 offset:12288
    ds_read_b64_tr_b16 v[98:99], v105 offset:13312
    s_waitcnt lgkmcnt(6)
    v_mfma_f32_32x32x16_bf16 v[4:19], v[68:71], v[84:87], v[4:19]
    v_mfma_f32_32x32x16_bf16 v[20:35], v[72:75], v[84:87], v[20:35]
    v_mfma_f32_32x32x16_bf16 v[36:51], v[68:71], v[88:91], v[36:51]
    v_mfma_f32_32x32x16_bf16 v[52:67], v[72:75], v[88:91], v[52:67]
    v_add_u32 v100, 49152, v100
    v_add_u32 v101, 49152, v101
    v_add_u32 v102, 49152, v102
    v_add_u32 v103, 49152, v103
    v_add_u32 v104, 49152, v104
    v_add_u32 v105, 49152, v105
    ds_read_b128 v[68:71], v100 offset:0
    ds_read_b128 v[72:75], v100 offset:4096
    ds_read_b64_tr_b16 v[84:85], v104 offset:0
    ds_read_b64_tr_b16 v[86:87], v104 offset:1024
    ds_read_b64_tr_b16 v[88:89], v105 offset:0
    ds_read_b64_tr_b16 v[90:91], v105 offset:1024
    s_waitcnt lgkmcnt(6)
    v_mfma_f32_32x32x16_bf16 v[4:19], v[76:79], v[92:95], v[4:19]
    v_mfma_f32_32x32x16_bf16 v[20:35], v[80:83], v[92:95], v[20:35]
    v_mfma_f32_32x32x16_bf16 v[36:51], v[76:79], v[96:99], v[36:51]
    v_mfma_f32_32x32x16_bf16 v[52:67], v[80:83], v[96:99], v[52:67]
    ds_read_b128 v[76:79], v101 offset:0
    ds_read_b128 v[80:83], v101 offset:4096
    ds_read_b64_tr_b16 v[92:93], v104 offset:4096
    ds_read_b64_tr_b16 v[94:95], v104 offset:5120
    ds_read_b64_tr_b16 v[96:97], v105 offset:4096
    ds_read_b64_tr_b16 v[98:99], v105 offset:5120
    s_waitcnt lgkmcnt(6)
    v_mfma_f32_32x32x16_bf16 v[4:19], v[68:71], v[84:87], v[4:19]
    v_mfma_f32_32x32x16_bf16 v[20:35], v[72:75], v[84:87], v[20:35]
    v_mfma_f32_32x32x16_bf16 v[36:51], v[68:71], v[88:91], v[36:51]
    v_mfma_f32_32x32x16_bf16 v[52:67], v[72:75], v[88:91], v[52:67]
    s_waitcnt vmcnt(0)
    s_barrier
    s_add_u32 s42, s42, 1
    s_cmp_eq_u32 s42, 8
    s_cselect_b32 s44, s47, s46
    s_cselect_b32 s42, 0, s42
    s_add_u32 s43, s43, 1
    s_cmp_eq_u32 s43, 8
    s_cselect_b32 s45, s49, s48
    s_cselect_b32 s43, 0, s43
    s_add_u32 m0, s40, 0
    s_nop 0
    buffer_load_dwordx4 v106, s[12:15], s34 offen lds
    s_add_u32 s34, s34, s44
    s_add_u32 m0, s40, 1024
    s_nop 0
    buffer_load_dwordx4 v107, s[12:15], s35 offen lds
    s_add_u32 s35, s35, s44
    s_add_u32 m0, s40, 2048
    s_nop 0
    buffer_load_dwordx4 v108, s[12:15], s36 offen lds
    s_add_u32 s36, s36, s44
    s_add_u32 m0, s40, 3072
    s_nop 0
    buffer_load_dwordx4 v109, s[12:15], s37 offen lds
    s_add_u32 s37, s37, s44
    s_add_u32 m0, s41, 0
    s_nop 0
    buffer_load_dwordx4 v110, s[16:19], s38 offen lds
    s_add_u32 s38, s38, s45
    s_add_u32 m0, s41, 1024
    s_nop 0
    buffer_load_dwordx4 v110, s[16:19], s39 offen lds
    s_add_u32 s39, s39, s45
    ds_read_b128 v[68:71], v102 offset:0
    ds_read_b128 v[72:75], v102 offset:4096
    ds_read_b64_tr_b16 v[84:85], v104 offset:8192
    ds_read_b64_tr_b16 v[86:87], v104 offset:9216
    ds_read_b64_tr_b16 v[88:89], v105 offset:8192
    ds_read_b64_tr_b16 v[90:91], v105 offset:9216
    s_waitcnt lgkmcnt(6)
    v_mfma_f32_32x32x16_bf16 v[4:19], v[76:79], v[92:95], v[4:19]
    v_mfma_f32_32x32x16_bf16 v[20:35], v[80:83], v[92:95], v[20:35]
    v_mfma_f32_32x32x16_bf16 v[36:51], v[76:79], v[96:99], v[36:51]
    v_mfma_f32_32x32x16_bf16 v[52:67], v[80:83], v[96:99], v[52:67]
    ds_read_b128 v[76:79], v103 offset:0
    ds_read_b128 v[80:83], v103 offset:4096
    ds_read_b64_tr_b16 v[92:93], v104 offset:12288
    ds_read_b64_tr_b16 v[94:95], v104 offset:13312
    ds_read_b64_tr_b16 v[96:97], v105 offset:12288
    ds_read_b64_tr_b16 v[98:99], v105 offset:13312
    s_waitcnt lgkmcnt(6)
    v_mfma_f32_32x32x16_bf16 v[4:19], v[68:71], v[84:87], v[4:19]
    v_mfma_f32_32x32x16_bf16 v[20:35], v[72:75], v[84:87], v[20:35]
    v_mfma_f32_32x32x16_bf16 v[36:51], v[68:71], v[88:91], v[36:51]
    v_mfma_f32_32x32x16_bf16 v[52:67], v[72:75], v[88:91], v[52:67]
    v_add_u32 v100, 49152, v100
    v_add_u32 v101, 49152, v101
    v_add_u32 v102, 49152, v102
    v_add_u32 v103, 49152, v103
    v_add_u32 v104, 49152, v104
    v_add_u32 v105, 49152, v105
    ds_read_b128 v[68:71], v100 offset:0
    ds_read_b128 v[72:75], v100 offset:4096
    ds_read_b64_tr_b16 v[84:85], v104 offset:0
    ds_read_b64_tr_b16 v[86:87], v104 offset:1024
    ds_read_b64_tr_b16 v[88:89], v105 offset:0
    ds_read_b64_tr_b16 v[90:91], v105 offset:1024
    s_waitcnt lgkmcnt(6)
    v_mfma_f32_32x32x16_bf16 v[4:19], v[76:79], v[92:95], v[4:19]
    v_mfma_f32_32x32x16_bf16 v[20:35], v[80:83], v[92:95], v[20:35]
    v_mfma_f32_32x32x16_bf16 v[36:51], v[76:79], v[96:99], v[36:51]
    v_mfma_f32_32x32x16_bf16 v[52:67], v[80:83], v[96:99], v[52:67]
    ds_read_b128 v[76:79], v101 offset:0
    ds_read_b128 v[80:83], v101 offset:4096
    ds_read_b64_tr_b16 v[92:93], v104 offset:4096
    ds_read_b64_tr_b16 v[94:95], v104 offset:5120
    ds_read_b64_tr_b16 v[96:97], v105 offset:4096
    ds_read_b64_tr_b16 v[98:99], v105 offset:5120
    s_waitcnt lgkmcnt(6)
    v_mfma_f32_32x32x16_bf16 v[4:19], v[68:71], v[84:87], v[4:19]
    v_mfma_f32_32x32x16_bf16 v[20:35], v[72:75], v[84:87], v[20:35]
    v_mfma_f32_32x32x16_bf16 v[36:51], v[68:71], v[88:91], v[36:51]
    v_mfma_f32_32x32x16_bf16 v[52:67], v[72:75], v[88:91], v[52:67]
    s_waitcnt vmcnt(0)
    s_barrier
    s_add_u32 s42, s42, 1
    s_cmp_eq_u32 s42, 8
    s_cselect_b32 s44, s47, s46
    s_cselect_b32 s42, 0, s42
    s_add_u32 s43, s43, 1
    s_cmp_eq_u32 s43, 8
    s_cselect_b32 s45, s49, s48
    s_cselect_b32 s43, 0, s43
    s_add_u32 m0, s40, 49152
    s_nop 0
    buffer_load_dwordx4 v106, s[12:15], s34 offen lds
    s_add_u32 s34, s34, s44
    s_add_u32 m0, s40, 50176
    s_nop 0
    buffer_load_dwordx4 v107, s[12:15], s35 offen lds
    s_add_u32 s35, s35, s44
    s_add_u32 m0, s40, 51200
    s_nop 0
    buffer_load_dwordx4 v108, s[12:15], s36 offen lds
    s_add_u32 s36, s36, s44
    s_add_u32 m0, s40, 52224
    s_nop 0
    buffer_load_dwordx4 v109, s[12:15], s37 offen lds
    s_add_u32 s37, s37, s44
    s_add_u32 m0, s41, 49152
    s_nop 0
    buffer_load_dwordx4 v110, s[16:19], s38 offen lds
    s_add_u32 s38, s38, s45
    s_add_u32 m0, s41, 50176
    s_nop 0
    buffer_load_dwordx4 v110, s[16:19], s39 offen lds
    s_add_u32 s39, s39, s45
    ds_read_b128 v[68:71], v102 offset:0
    ds_read_b128 v[72:75], v102 offset:4096
    ds_read_b64_tr_b16 v[84:85], v104 offset:8192
    ds_read_b64_tr_b16 v[86:87], v104 offset:9216
    ds_read_b64_tr_b16 v[88:89], v105 offset:8192
    ds_read_b64_tr_b16 v[90:91], v105 offset:9216
    s_waitcnt lgkmcnt(6)
    v_mfma_f32_32x32x16_bf16 v[4:19], v[76:79], v[92:95], v[4:19]
    v_mfma_f32_32x32x16_bf16 v[20:35], v[80:83], v[92:95], v[20:35]
    v_mfma_f32_32x32x16_bf16 v[36:51], v[76:79], v[96:99], v[36:51]
    v_mfma_f32_32x32x16_bf16 v[52:67], v[80:83], v[96:99], v[52:67]
    ds_read_b128 v[76:79], v103 offset:0
    ds_read_b128 v[80:83], v103 offset:4096
    ds_read_b64_tr_b16 v[92:93], v104 offset:12288
    ds_read_b64_tr_b16 v[94:95], v104 offset:13312
    ds_read_b64_tr_b16 v[96:97], v105 offset:12288
    ds_read_b64_tr_b16 v[98:99], v105 offset:13312
    s_waitcnt lgkmcnt(6)
    v_mfma_f32_32x32x16_bf16 v[4:19], v[68:71], v[84:87], v[4:19]
    v_mfma_f32_32x32x16_bf16 v[20:35], v[72:75], v[84:87], v[20:35]
    v_mfma_f32_32x32x16_bf16 v[36:51], v[68:71], v[88:91], v[36:51]
    v_mfma_f32_32x32x16_bf16 v[52:67], v[72:75], v[88:91], v[52:67]
    v_subrev_u32 v100, 98304, v100
    v_subrev_u32 v101, 98304, v101
    v_subrev_u32 v102, 98304, v102
    v_subrev_u32 v103, 98304, v103
    v_subrev_u32 v104, 98304, v104
    v_subrev_u32 v105, 98304, v105
    ds_read_b128 v[68:71], v100 offset:0
    ds_read_b128 v[72:75], v100 offset:4096
    ds_read_b64_tr_b16 v[84:85], v104 offset:0
    ds_read_b64_tr_b16 v[86:87], v104 offset:1024
    ds_read_b64_tr_b16 v[88:89], v105 offset:0
    ds_read_b64_tr_b16 v[90:91], v105 offset:1024
    s_waitcnt lgkmcnt(6)
    v_mfma_f32_32x32x16_bf16 v[4:19], v[76:79], v[92:95], v[4:19]
    v_mfma_f32_32x32x16_bf16 v[20:35], v[80:83], v[92:95], v[20:35]
    v_mfma_f32_32x32x16_bf16 v[36:51], v[76:79], v[96:99], v[36:51]
    v_mfma_f32_32x32x16_bf16 v[52:67], v[80:83], v[96:99], v[52:67]
    ds_read_b128 v[76:79], v101 offset:0
    ds_read_b128 v[80:83], v101 offset:4096
    ds_read_b64_tr_b16 v[92:93], v104 offset:4096
    ds_read_b64_tr_b16 v[94:95], v104 offset:5120
    ds_read_b64_tr_b16 v[96:97], v105 offset:4096
    ds_read_b64_tr_b16 v[98:99], v105 offset:5120
    s_waitcnt lgkmcnt(6)
    v_mfma_f32_32x32x16_bf16 v[4:19], v[68:71], v[84:87], v[4:19]
    v_mfma_f32_32x32x16_bf16 v[20:35], v[72:75], v[84:87], v[20:35]
    v_mfma_f32_32x32x16_bf16 v[36:51], v[68:71], v[88:91], v[36:51]
    v_mfma_f32_32x32x16_bf16 v[52:67], v[72:75], v[88:91], v[52:67]
    s_waitcnt vmcnt(0)
    s_barrier
    s_add_u32 s42, s42, 1
    s_cmp_eq_u32 s42, 8
    s_cselect_b32 s44, s47, s46
    s_cselect_b32 s42, 0, s42
    s_add_u32 s43, s43, 1
    s_cmp_eq_u32 s43, 8
    s_cselect_b32 s45, s49, s48
    s_cselect_b32 s43, 0, s43
    s_add_u32 m0, s40, 98304
    s_nop 0
    buffer_load_dwordx4 v106, s[12:15], s34 offen lds
    s_add_u32 s34, s34, s44
    s_add_u32 m0, s40, 99328
    s_nop 0
    buffer_load_dwordx4 v107, s[12:15], s35 offen lds
    s_add_u32 s35, s35, s44
    s_add_u32 m0, s40, 100352
    s_nop 0
    buffer_load_dwordx4 v108, s[12:15], s36 offen lds
    s_add_u32 s36, s36, s44
    s_add_u32 m0, s40, 101376
    s_nop 0
    buffer_load_dwordx4 v109, s[12:15], s37 offen lds
    s_add_u32 s37, s37, s44
    s_add_u32 m0, s41, 98304
    s_nop 0
    buffer_load_dwordx4 v110, s[16:19], s38 offen lds
    s_add_u32 s38, s38, s45
    s_add_u32 m0, s41, 99328
    s_nop 0
    buffer_load_dwordx4 v110, s[16:19], s39 offen lds
    s_add_u32 s39, s39, s45
    ds_read_b128 v[68:71], v102 offset:0
    ds_read_b128 v[72:75], v102 offset:4096
    ds_read_b64_tr_b16 v[84:85], v104 offset:8192
    ds_read_b64_tr_b16 v[86:87], v104 offset:9216
    ds_read_b64_tr_b16 v[88:89], v105 offset:8192
    ds_read_b64_tr_b16 v[90:91], v105 offset:9216
    s_waitcnt lgkmcnt(6)
    v_mfma_f32_32x32x16_bf16 v[4:19], v[76:79], v[92:95], v[4:19]
    v_mfma_f32_32x32x16_bf16 v[20:35], v[80:83], v[92:95], v[20:35]
    v_mfma_f32_32x32x16_bf16 v[36:51], v[76:79], v[96:99], v[36:51]
    v_mfma_f32_32x32x16_bf16 v[52:67], v[80:83], v[96:99], v[52:67]
    ds_read_b128 v[76:79], v103 offset:0
    ds_read_b128 v[80:83], v103 offset:4096
    ds_read_b64_tr_b16 v[92:93], v104 offset:12288
    ds_read_b64_tr_b16 v[94:95], v104 offset:13312
    ds_read_b64_tr_b16 v[96:97], v105 offset:12288
    ds_read_b64_tr_b16 v[98:99], v105 offset:13312
    s_waitcnt lgkmcnt(6)
    v_mfma_f32_32x32x16_bf16 v[4:19], v[68:71], v[84:87], v[4:19]
    v_mfma_f32_32x32x16_bf16 v[20:35], v[72:75], v[84:87], v[20:35]
    v_mfma_f32_32x32x16_bf16 v[36:51], v[68:71], v[88:91], v[36:51]
    v_mfma_f32_32x32x16_bf16 v[52:67], v[72:75], v[88:91], v[52:67]
    v_add_u32 v100, 49152, v100
    v_add_u32 v101, 49152, v101
    v_add_u32 v102, 49152, v102
    v_add_u32 v103, 49152, v103
    v_add_u32 v104, 49152, v104
    v_add_u32 v105, 49152, v105
    ds_read_b128 v[68:71], v100 offset:0
    ds_read_b128 v[72:75], v100 offset:4096
    ds_read_b64_tr_b16 v[84:85], v104 offset:0
    ds_read_b64_tr_b16 v[86:87], v104 offset:1024
    ds_read_b64_tr_b16 v[88:89], v105 offset:0
    ds_read_b64_tr_b16 v[90:91], v105 offset:1024
    s_waitcnt lgkmcnt(6)
    v_mfma_f32_32x32x16_bf16 v[4:19], v[76:79], v[92:95], v[4:19]
    v_mfma_f32_32x32x16_bf16 v[20:35], v[80:83], v[92:95], v[20:35]
    v_mfma_f32_32x32x16_bf16 v[36:51], v[76:79], v[96:99], v[36:51]
    v_mfma_f32_32x32x16_bf16 v[52:67], v[80:83], v[96:99], v[52:67]
    ds_read_b128 v[76:79], v101 offset:0
    ds_read_b128 v[80:83], v101 offset:4096
    ds_read_b64_tr_b16 v[92:93], v104 offset:4096
    ds_read_b64_tr_b16 v[94:95], v104 offset:5120
    ds_read_b64_tr_b16 v[96:97], v105 offset:4096
    ds_read_b64_tr_b16 v[98:99], v105 offset:5120
    s_waitcnt lgkmcnt(6)
    v_mfma_f32_32x32x16_bf16 v[4:19], v[68:71], v[84:87], v[4:19]
    v_mfma_f32_32x32x16_bf16 v[20:35], v[72:75], v[84:87], v[20:35]
    v_mfma_f32_32x32x16_bf16 v[36:51], v[68:71], v[88:91], v[36:51]
    v_mfma_f32_32x32x16_bf16 v[52:67], v[72:75], v[88:91], v[52:67]
    s_waitcnt vmcnt(0)
    s_barrier
    s_add_u32 s42, s42, 1
    s_cmp_eq_u32 s42, 8
    s_cselect_b32 s44, s47, s46
    s_cselect_b32 s42, 0, s42
    s_add_u32 s43, s43, 1
    s_cmp_eq_u32 s43, 8
    s_cselect_b32 s45, s49, s48
    s_cselect_b32 s43, 0, s43
    s_add_u32 m0, s40, 0
    s_nop 0
    buffer_load_dwordx4 v106, s[12:15], s34 offen lds
    s_add_u32 s34, s34, s44
    s_add_u32 m0, s40, 1024
    s_nop 0
    buffer_load_dwordx4 v107, s[12:15], s35 offen lds
    s_add_u32 s35, s35, s44
    s_add_u32 m0, s40, 2048
    s_nop 0
    buffer_load_dwordx4 v108, s[12:15], s36 offen lds
    s_add_u32 s36, s36, s44
    s_add_u32 m0, s40, 3072
    s_nop 0
    buffer_load_dwordx4 v109, s[12:15], s37 offen lds
    s_add_u32 s37, s37, s44
    s_add_u32 m0, s41, 0
    s_nop 0
    buffer_load_dwordx4 v110, s[16:19], s38 offen lds
    s_add_u32 s38, s38, s45
    s_add_u32 m0, s41, 1024
    s_nop 0
    buffer_load_dwordx4 v110, s[16:19], s39 offen lds
    s_add_u32 s39, s39, s45
    ds_read_b128 v[68:71], v102 offset:0
    ds_read_b128 v[72:75], v102 offset:4096
    ds_read_b64_tr_b16 v[84:85], v104 offset:8192
    ds_read_b64_tr_b16 v[86:87], v104 offset:9216
    ds_read_b64_tr_b16 v[88:89], v105 offset:8192
    ds_read_b64_tr_b16 v[90:91], v105 offset:9216
    s_waitcnt lgkmcnt(6)
    v_mfma_f32_32x32x16_bf16 v[4:19], v[76:79], v[92:95], v[4:19]
    v_mfma_f32_32x32x16_bf16 v[20:35], v[80:83], v[92:95], v[20:35]
    v_mfma_f32_32x32x16_bf16 v[36:51], v[76:79], v[96:99], v[36:51]
    v_mfma_f32_32x32x16_bf16 v[52:67], v[80:83], v[96:99], v[52:67]
    ds_read_b128 v[76:79], v103 offset:0
    ds_read_b128 v[80:83], v103 offset:4096
    ds_read_b64_tr_b16 v[92:93], v104 offset:12288
    ds_read_b64_tr_b16 v[94:95], v104 offset:13312
    ds_read_b64_tr_b16 v[96:97], v105 offset:12288
    ds_read_b64_tr_b16 v[98:99], v105 offset:13312
    s_waitcnt lgkmcnt(6)
    v_mfma_f32_32x32x16_bf16 v[4:19], v[68:71], v[84:87], v[4:19]
    v_mfma_f32_32x32x16_bf16 v[20:35], v[72:75], v[84:87], v[20:35]
    v_mfma_f32_32x32x16_bf16 v[36:51], v[68:71], v[88:91], v[36:51]
    v_mfma_f32_32x32x16_bf16 v[52:67], v[72:75], v[88:91], v[52:67]
    v_add_u32 v100, 49152, v100
    v_add_u32 v101, 49152, v101
    v_add_u32 v102, 49152, v102
    v_add_u32 v103, 49152, v103
    v_add_u32 v104, 49152, v104
    v_add_u32 v105, 49152, v105
    ds_read_b128 v[68:71], v100 offset:0
    ds_read_b128 v[72:75], v100 offset:4096
    ds_read_b64_tr_b16 v[84:85], v104 offset:0
    ds_read_b64_tr_b16 v[86:87], v104 offset:1024
    ds_read_b64_tr_b16 v[88:89], v105 offset:0
    ds_read_b64_tr_b16 v[90:91], v105 offset:1024
    s_waitcnt lgkmcnt(6)
    v_mfma_f32_32x32x16_bf16 v[4:19], v[76:79], v[92:95], v[4:19]
    v_mfma_f32_32x32x16_bf16 v[20:35], v[80:83], v[92:95], v[20:35]
    v_mfma_f32_32x32x16_bf16 v[36:51], v[76:79], v[96:99], v[36:51]
    v_mfma_f32_32x32x16_bf16 v[52:67], v[80:83], v[96:99], v[52:67]
    ds_read_b128 v[76:79], v101 offset:0
    ds_read_b128 v[80:83], v101 offset:4096
    ds_read_b64_tr_b16 v[92:93], v104 offset:4096
    ds_read_b64_tr_b16 v[94:95], v104 offset:5120
    ds_read_b64_tr_b16 v[96:97], v105 offset:4096
    ds_read_b64_tr_b16 v[98:99], v105 offset:5120
    s_waitcnt lgkmcnt(6)
    v_mfma_f32_32x32x16_bf16 v[4:19], v[68:71], v[84:87], v[4:19]
    v_mfma_f32_32x32x16_bf16 v[20:35], v[72:75], v[84:87], v[20:35]
    v_mfma_f32_32x32x16_bf16 v[36:51], v[68:71], v[88:91], v[36:51]
    v_mfma_f32_32x32x16_bf16 v[52:67], v[72:75], v[88:91], v[52:67]
    s_waitcnt vmcnt(0)
    s_barrier
    s_add_u32 s42, s42, 1
    s_cmp_eq_u32 s42, 8
    s_cselect_b32 s44, s47, s46
    s_cselect_b32 s42, 0, s42
    s_add_u32 s43, s43, 1
    s_cmp_eq_u32 s43, 8
    s_cselect_b32 s45, s49, s48
    s_cselect_b32 s43, 0, s43
    s_add_u32 m0, s40, 49152
    s_nop 0
    buffer_load_dwordx4 v106, s[12:15], s34 offen lds
    s_add_u32 s34, s34, s44
    s_add_u32 m0, s40, 50176
    s_nop 0
    buffer_load_dwordx4 v107, s[12:15], s35 offen lds
    s_add_u32 s35, s35, s44
    s_add_u32 m0, s40, 51200
    s_nop 0
    buffer_load_dwordx4 v108, s[12:15], s36 offen lds
    s_add_u32 s36, s36, s44
    s_add_u32 m0, s40, 52224
    s_nop 0
    buffer_load_dwordx4 v109, s[12:15], s37 offen lds
    s_add_u32 s37, s37, s44
    s_add_u32 m0, s41, 49152
    s_nop 0
    buffer_load_dwordx4 v110, s[16:19], s38 offen lds
    s_add_u32 s38, s38, s45
    s_add_u32 m0, s41, 50176
    s_nop 0
    buffer_load_dwordx4 v110, s[16:19], s39 offen lds
    s_add_u32 s39, s39, s45
    ds_read_b128 v[68:71], v102 offset:0
    ds_read_b128 v[72:75], v102 offset:4096
    ds_read_b64_tr_b16 v[84:85], v104 offset:8192
    ds_read_b64_tr_b16 v[86:87], v104 offset:9216
    ds_read_b64_tr_b16 v[88:89], v105 offset:8192
    ds_read_b64_tr_b16 v[90:91], v105 offset:9216
    s_waitcnt lgkmcnt(6)
    v_mfma_f32_32x32x16_bf16 v[4:19], v[76:79], v[92:95], v[4:19]
    v_mfma_f32_32x32x16_bf16 v[20:35], v[80:83], v[92:95], v[20:35]
    v_mfma_f32_32x32x16_bf16 v[36:51], v[76:79], v[96:99], v[36:51]
    v_mfma_f32_32x32x16_bf16 v[52:67], v[80:83], v[96:99], v[52:67]
    ds_read_b128 v[76:79], v103 offset:0
    ds_read_b128 v[80:83], v103 offset:4096
    ds_read_b64_tr_b16 v[92:93], v104 offset:12288
    ds_read_b64_tr_b16 v[94:95], v104 offset:13312
    ds_read_b64_tr_b16 v[96:97], v105 offset:12288
    ds_read_b64_tr_b16 v[98:99], v105 offset:13312
    s_waitcnt lgkmcnt(6)
    v_mfma_f32_32x32x16_bf16 v[4:19], v[68:71], v[84:87], v[4:19]
    v_mfma_f32_32x32x16_bf16 v[20:35], v[72:75], v[84:87], v[20:35]
    v_mfma_f32_32x32x16_bf16 v[36:51], v[68:71], v[88:91], v[36:51]
    v_mfma_f32_32x32x16_bf16 v[52:67], v[72:75], v[88:91], v[52:67]
    v_subrev_u32 v100, 98304, v100
    v_subrev_u32 v101, 98304, v101
    v_subrev_u32 v102, 98304, v102
    v_subrev_u32 v103, 98304, v103
    v_subrev_u32 v104, 98304, v104
    v_subrev_u32 v105, 98304, v105
    ds_read_b128 v[68:71], v100 offset:0
    ds_read_b128 v[72:75], v100 offset:4096
    ds_read_b64_tr_b16 v[84:85], v104 offset:0
    ds_read_b64_tr_b16 v[86:87], v104 offset:1024
    ds_read_b64_tr_b16 v[88:89], v105 offset:0
    ds_read_b64_tr_b16 v[90:91], v105 offset:1024
    s_waitcnt lgkmcnt(6)
    v_mfma_f32_32x32x16_bf16 v[4:19], v[76:79], v[92:95], v[4:19]
    v_mfma_f32_32x32x16_bf16 v[20:35], v[80:83], v[92:95], v[20:35]
    v_mfma_f32_32x32x16_bf16 v[36:51], v[76:79], v[96:99], v[36:51]
    v_mfma_f32_32x32x16_bf16 v[52:67], v[80:83], v[96:99], v[52:67]
    ds_read_b128 v[76:79], v101 offset:0
    ds_read_b128 v[80:83], v101 offset:4096
    ds_read_b64_tr_b16 v[92:93], v104 offset:4096
    ds_read_b64_tr_b16 v[94:95], v104 offset:5120
    ds_read_b64_tr_b16 v[96:97], v105 offset:4096
    ds_read_b64_tr_b16 v[98:99], v105 offset:5120
    s_waitcnt lgkmcnt(6)
    v_mfma_f32_32x32x16_bf16 v[4:19], v[68:71], v[84:87], v[4:19]
    v_mfma_f32_32x32x16_bf16 v[20:35], v[72:75], v[84:87], v[20:35]
    v_mfma_f32_32x32x16_bf16 v[36:51], v[68:71], v[88:91], v[36:51]
    v_mfma_f32_32x32x16_bf16 v[52:67], v[72:75], v[88:91], v[52:67]
    s_waitcnt vmcnt(0)
    s_barrier
    ds_read_b128 v[68:71], v102 offset:0
    ds_read_b128 v[72:75], v102 offset:4096
    ds_read_b64_tr_b16 v[84:85], v104 offset:8192
    ds_read_b64_tr_b16 v[86:87], v104 offset:9216
    ds_read_b64_tr_b16 v[88:89], v105 offset:8192
    ds_read_b64_tr_b16 v[90:91], v105 offset:9216
    s_waitcnt lgkmcnt(6)
    v_mfma_f32_32x32x16_bf16 v[4:19], v[76:79], v[92:95], v[4:19]
    v_mfma_f32_32x32x16_bf16 v[20:35], v[80:83], v[92:95], v[20:35]
    v_mfma_f32_32x32x16_bf16 v[36:51], v[76:79], v[96:99], v[36:51]
    v_mfma_f32_32x32x16_bf16 v[52:67], v[80:83], v[96:99], v[52:67]
    ds_read_b128 v[76:79], v103 offset:0
    ds_read_b128 v[80:83], v103 offset:4096
    ds_read_b64_tr_b16 v[92:93], v104 offset:12288
    ds_read_b64_tr_b16 v[94:95], v104 offset:13312
    ds_read_b64_tr_b16 v[96:97], v105 offset:12288
    ds_read_b64_tr_b16 v[98:99], v105 offset:13312
    s_waitcnt lgkmcnt(6)
    v_mfma_f32_32x32x16_bf16 v[4:19], v[68:71], v[84:87], v[4:19]
    v_mfma_f32_32x32x16_bf16 v[20:35], v[72:75], v[84:87], v[20:35]
    v_mfma_f32_32x32x16_bf16 v[36:51], v[68:71], v[88:91], v[36:51]
    v_mfma_f32_32x32x16_bf16 v[52:67], v[72:75], v[88:91], v[52:67]
    v_add_u32 v100, 49152, v100
    v_add_u32 v101, 49152, v101
    v_add_u32 v102, 49152, v102
    v_add_u32 v103, 49152, v103
    v_add_u32 v104, 49152, v104
    v_add_u32 v105, 49152, v105
    ds_read_b128 v[68:71], v100 offset:0
    ds_read_b128 v[72:75], v100 offset:4096
    ds_read_b64_tr_b16 v[84:85], v104 offset:0
    ds_read_b64_tr_b16 v[86:87], v104 offset:1024
    ds_read_b64_tr_b16 v[88:89], v105 offset:0
    ds_read_b64_tr_b16 v[90:91], v105 offset:1024
    s_waitcnt lgkmcnt(6)
    v_mfma_f32_32x32x16_bf16 v[4:19], v[76:79], v[92:95], v[4:19]
    v_mfma_f32_32x32x16_bf16 v[20:35], v[80:83], v[92:95], v[20:35]
    v_mfma_f32_32x32x16_bf16 v[36:51], v[76:79], v[96:99], v[36:51]
    v_mfma_f32_32x32x16_bf16 v[52:67], v[80:83], v[96:99], v[52:67]
    ds_read_b128 v[76:79], v101 offset:0
    ds_read_b128 v[80:83], v101 offset:4096
    ds_read_b64_tr_b16 v[92:93], v104 offset:4096
    ds_read_b64_tr_b16 v[94:95], v104 offset:5120
    ds_read_b64_tr_b16 v[96:97], v105 offset:4096
    ds_read_b64_tr_b16 v[98:99], v105 offset:5120
    s_waitcnt lgkmcnt(6)
    v_mfma_f32_32x32x16_bf16 v[4:19], v[68:71], v[84:87], v[4:19]
    v_mfma_f32_32x32x16_bf16 v[20:35], v[72:75], v[84:87], v[20:35]
    v_mfma_f32_32x32x16_bf16 v[36:51], v[68:71], v[88:91], v[36:51]
    v_mfma_f32_32x32x16_bf16 v[52:67], v[72:75], v[88:91], v[52:67]
    ds_read_b128 v[68:71], v102 offset:0
    ds_read_b128 v[72:75], v102 offset:4096
    ds_read_b64_tr_b16 v[84:85], v104 offset:8192
    ds_read_b64_tr_b16 v[86:87], v104 offset:9216
    ds_read_b64_tr_b16 v[88:89], v105 offset:8192
    ds_read_b64_tr_b16 v[90:91], v105 offset:9216
    s_waitcnt lgkmcnt(6)
    v_mfma_f32_32x32x16_bf16 v[4:19], v[76:79], v[92:95], v[4:19]
    v_mfma_f32_32x32x16_bf16 v[20:35], v[80:83], v[92:95], v[20:35]
    v_mfma_f32_32x32x16_bf16 v[36:51], v[76:79], v[96:99], v[36:51]
    v_mfma_f32_32x32x16_bf16 v[52:67], v[80:83], v[96:99], v[52:67]
    ds_read_b128 v[76:79], v103 offset:0
    ds_read_b128 v[80:83], v103 offset:4096
    ds_read_b64_tr_b16 v[92:93], v104 offset:12288
    ds_read_b64_tr_b16 v[94:95], v104 offset:13312
    ds_read_b64_tr_b16 v[96:97], v105 offset:12288
    ds_read_b64_tr_b16 v[98:99], v105 offset:13312
    s_waitcnt lgkmcnt(6)
    v_mfma_f32_32x32x16_bf16 v[4:19], v[68:71], v[84:87], v[4:19]
    v_mfma_f32_32x32x16_bf16 v[20:35], v[72:75], v[84:87], v[20:35]
    v_mfma_f32_32x32x16_bf16 v[36:51], v[68:71], v[88:91], v[36:51]
    v_mfma_f32_32x32x16_bf16 v[52:67], v[72:75], v[88:91], v[52:67]
    s_waitcnt lgkmcnt(0)
    v_mfma_f32_32x32x16_bf16 v[4:19], v[76:79], v[92:95], v[4:19]
    v_mfma_f32_32x32x16_bf16 v[20:35], v[80:83], v[92:95], v[20:35]
    v_mfma_f32_32x32x16_bf16 v[36:51], v[76:79], v[96:99], v[36:51]
    v_mfma_f32_32x32x16_bf16 v[52:67], v[80:83], v[96:99], v[52:67]
    s_nop 15
    s_lshl_b32 s50, s33, 3
    s_mul_i32 s51, s30, 4
    s_add_u32 s50, s50, s51
    s_lshl_b32 s50, s50, 16
    s_mul_i32 s51, s32, 16
    s_mul_i32 s52, s29, 4
    s_add_u32 s51, s51, s52
    s_lshl_b32 s51, s51, 9
    s_add_u32 s50, s50, s51
    v_lshrrev_b32 v115, 4, v111
    v_and_b32 v115, 1, v115
    v_lshlrev_b32 v115, 16, v115
    v_and_b32 v116, 15, v111
    v_lshlrev_b32 v116, 4, v116
    v_add_u32 v115, v115, v116
    v_lshlrev_b32 v116, 8, v112
    v_add_u32 v114, v115, v116
    v_cvt_pk_bf16_f32 v68, v4, v5
    v_cvt_pk_bf16_f32 v69, v6, v7
    v_cvt_pk_bf16_f32 v70, v8, v9
    v_cvt_pk_bf16_f32 v71, v10, v11
    s_add_u32 s51, s50, 0
    buffer_store_dwordx4 v[68:71], v114, s[20:23], s51 offen
    v_cvt_pk_bf16_f32 v76, v12, v13
    v_cvt_pk_bf16_f32 v77, v14, v15
    v_cvt_pk_bf16_f32 v78, v16, v17
    v_cvt_pk_bf16_f32 v79, v18, v19
    s_add_u32 s51, s50, 512
    buffer_store_dwordx4 v[76:79], v114, s[20:23], s51 offen
    v_cvt_pk_bf16_f32 v84, v20, v21
    v_cvt_pk_bf16_f32 v85, v22, v23
    v_cvt_pk_bf16_f32 v86, v24, v25
    v_cvt_pk_bf16_f32 v87, v26, v27
    s_add_u32 s51, s50, 1024
    buffer_store_dwordx4 v[84:87], v114, s[20:23], s51 offen
    v_cvt_pk_bf16_f32 v92, v28, v29
    v_cvt_pk_bf16_f32 v93, v30, v31
    v_cvt_pk_bf16_f32 v94, v32, v33
    v_cvt_pk_bf16_f32 v95, v34, v35
    s_add_u32 s51, s50, 1536
    buffer_store_dwordx4 v[92:95], v114, s[20:23], s51 offen
    v_cvt_pk_bf16_f32 v68, v36, v37
    v_cvt_pk_bf16_f32 v69, v38, v39
    v_cvt_pk_bf16_f32 v70, v40, v41
    v_cvt_pk_bf16_f32 v71, v42, v43
    s_add_u32 s51, s50, 131072
    buffer_store_dwordx4 v[68:71], v114, s[20:23], s51 offen
    v_cvt_pk_bf16_f32 v76, v44, v45
    v_cvt_pk_bf16_f32 v77, v46, v47
    v_cvt_pk_bf16_f32 v78, v48, v49
    v_cvt_pk_bf16_f32 v79, v50, v51
    s_add_u32 s51, s50, 131584
    buffer_store_dwordx4 v[76:79], v114, s[20:23], s51 offen
    v_cvt_pk_bf16_f32 v84, v52, v53
    v_cvt_pk_bf16_f32 v85, v54, v55
    v_cvt_pk_bf16_f32 v86, v56, v57
    v_cvt_pk_bf16_f32 v87, v58, v59
    s_add_u32 s51, s50, 132096
    buffer_store_dwordx4 v[84:87], v114, s[20:23], s51 offen
    v_cvt_pk_bf16_f32 v92, v60, v61
    v_cvt_pk_bf16_f32 v93, v62, v63
    v_cvt_pk_bf16_f32 v94, v64, v65
    v_cvt_pk_bf16_f32 v95, v66, v67
    s_add_u32 s51, s50, 132608
    buffer_store_dwordx4 v[92:95], v114, s[20:23], s51 offen
    s_endpgm
k1_role_F1:
    s_sub_u32 s7, s7, 12
    s_lshl_b32 s7, s7, 3
    s_add_u32 s3, s7, s6
    s_load_dwordx2 s[4:5], s[0:1], 0
    s_load_dwordx2 s[6:7], s[0:1], 32
    s_load_dwordx2 s[8:9], s[0:1], 88
    s_load_dwordx2 s[10:11], s[0:1], 40
    v_lshrrev_b32 v114, 6, v0
    v_and_b32 v111, 63, v0
    s_nop 0
    v_readfirstlane_b32 s28, v114
    v_lshrrev_b32 v112, 5, v111
    v_and_b32 v113, 31, v111
    s_and_b32 s32, s3, 7
    s_lshr_b32 s33, s3, 3
    s_and_b32 s31, s28, 0
    s_lshr_b32 s50, s28, 0
    s_and_b32 s29, s50, 3
    s_lshr_b32 s30, s50, 2
    s_waitcnt lgkmcnt(0)
    s_mov_b32 s12, s4
    s_mov_b32 s13, s5
    s_mov_b32 s14, 2097152
    s_mov_b32 s15, 0x00020000
    s_mul_i32 s50, s33, 256
    s_add_u32 s50, s50, 0
    s_add_u32 s6, s6, s50
    s_addc_u32 s7, s7, 0
    s_sub_u32 s51, 1835008, s50
    s_mov_b32 s16, s6
    s_mov_b32 s17, s7
    s_mov_b32 s18, s51
    s_mov_b32 s19, 0x00020000
    s_add_u32 s50, s8, 6291456
    s_addc_u32 s51, s9, 0
    s_mov_b32 s20, s50
    s_mov_b32 s21, s51
    s_mov_b32 s22, 7340032
    s_mov_b32 s23, 0x00020000
    s_mov_b32 s24, s10
    s_mov_b32 s25, s11
    s_mov_b32 s26, 3584
    s_mov_b32 s27, 0x00020000
    v_lshrrev_b32 v114, 3, v111
    v_and_b32 v115, 7, v111
    s_mul_i32 s50, s28, 32
    s_mov_b32 s51, 1024
    v_add_u32 v116, s50, v114
    v_lshrrev_b32 v116, 1, v116
    v_and_b32 v116, 7, v116
    v_xor_b32 v116, v116, v115
    v_lshlrev_b32 v116, 4, v116
    v_mul_lo_u32 v117, v114, s51
    v_add_u32 v106, v116, v117
    v_add_u32 v116, s50, v114
    v_add_u32 v116, 8, v116
    v_lshrrev_b32 v116, 1, v116
    v_and_b32 v116, 7, v116
    v_xor_b32 v116, v116, v115
    v_lshlrev_b32 v116, 4, v116
    v_mul_lo_u32 v117, v114, s51
    v_add_u32 v107, v116, v117
    v_add_u32 v116, s50, v114
    v_add_u32 v116, 16, v116
    v_lshrrev_b32 v116, 1, v116
    v_and_b32 v116, 7, v116
    v_xor_b32 v116, v116, v115
    v_lshlrev_b32 v116, 4, v116
    v_mul_lo_u32 v117, v114, s51
    v_add_u32 v108, v116, v117
    v_add_u32 v116, s50, v114
    v_add_u32 v116, 24, v116
    v_lshrrev_b32 v116, 1, v116
    v_and_b32 v116, 7, v116
    v_xor_b32 v116, v116, v115
    v_lshlrev_b32 v116, 4, v116
    v_mul_lo_u32 v117, v114, s51
    v_add_u32 v109, v116, v117
    s_mul_i32 s52, s32, 256
    s_add_u32 s52, s52, s50
    s_add_u32 s53, s52, 0
    s_mul_i32 s34, s53, 1024
    s_add_u32 s53, s52, 8
    s_mul_i32 s35, s53, 1024
    s_add_u32 s53, s52, 16
    s_mul_i32 s36, s53, 1024
    s_add_u32 s53, s52, 24
    s_mul_i32 s37, s53, 1024
    s_mul_i32 s40, s28, 4096
    v_lshrrev_b32 v114, 4, v111
    v_and_b32 v115, 15, v111
    v_and_b32 v116, 3, v114
    v_lshlrev_b32 v116, 2, v116
    v_xor_b32 v115, v115, v116
    v_lshlrev_b32 v115, 4, v115
    s_mov_b32 s51, 3584
    v_mul_lo_u32 v117, v114, s51
    v_add_u32 v110, v115, v117
    s_mul_i32 s52, s28, 8
    s_add_u32 s52, s52, 0
    s_mul_i32 s38, s52, 3584
    s_mul_i32 s52, s28, 8
    s_add_u32 s52, s52, 4
    s_mul_i32 s39, s52, 3584
    s_mul_i32 s41, s28, 2048
    s_add_u32 s41, s41, 32768
    s_mov_b32 s46, 128
    s_mov_b32 s47, 4294966400
    s_mov_b32 s48, 229376
    s_mov_b32 s49, 4293361664
    s_mul_i32 s50, s32, 3
    s_add_u32 s50, s50, s33
    s_lshl_b32 s50, s50, 0
    s_and_b32 s42, s50, 7
    s_mov_b32 s43, s42
    s_mul_i32 s51, s42, 128
    s_add_u32 s34, s34, s51
    s_add_u32 s35, s35, s51
    s_add_u32 s36, s36, s51
    s_add_u32 s37, s37, s51
    s_mul_i32 s51, s42, 229376
    s_add_u32 s38, s38, s51
    s_add_u32 s39, s39, s51
    v_lshlrev_b32 v118, 3, v112
    s_mul_i32 s54, s33, 256
    s_mul_i32 s55, s30, 128
    s_add_u32 s54, s54, s55
    buffer_load_dwordx2 v[84:85], v118, s[24:27], s54 offen offset:0
    buffer_load_dwordx2 v[86:87], v118, s[24:27], s54 offen offset:16
    buffer_load_dwordx2 v[92:93], v118, s[24:27], s54 offen offset:32
    buffer_load_dwordx2 v[94:95], v118, s[24:27], s54 offen offset:48
    buffer_load_dwordx2 v[88:89], v118, s[24:27], s54 offen offset:64
    buffer_load_dwordx2 v[90:91], v118, s[24:27], s54 offen offset:80
    buffer_load_dwordx2 v[96:97], v118, s[24:27], s54 offen offset:96
    buffer_load_dwordx2 v[98:99], v118, s[24:27], s54 offen offset:112
    s_add_u32 s42, s42, 1
    s_cmp_eq_u32 s42, 8
    s_cselect_b32 s44, s47, s46
    s_cselect_b32 s42, 0, s42
    s_add_u32 s43, s43, 1
    s_cmp_eq_u32 s43, 8
    s_cselect_b32 s45, s49, s48
    s_cselect_b32 s43, 0, s43
    s_add_u32 m0, s40, 0
    s_nop 0
    buffer_load_dwordx4 v106, s[12:15], s34 offen lds
    s_add_u32 s34, s34, s44
    s_add_u32 m0, s40, 1024
    s_nop 0
    buffer_load_dwordx4 v107, s[12:15], s35 offen lds
    s_add_u32 s35, s35, s44
    s_add_u32 m0, s40, 2048
    s_nop 0
    buffer_load_dwordx4 v108, s[12:15], s36 offen lds
    s_add_u32 s36, s36, s44
    s_add_u32 m0, s40, 3072
    s_nop 0
    buffer_load_dwordx4 v109, s[12:15], s37 offen lds
    s_add_u32 s37, s37, s44
    s_add_u32 m0, s41, 0
    s_nop 0
    buffer_load_dwordx4 v110, s[16:19], s38 offen lds
    s_add_u32 s38, s38, s45
    s_add_u32 m0, s41, 1024
    s_nop 0
    buffer_load_dwordx4 v110, s[16:19], s39 offen lds
    s_add_u32 s39, s39, s45
    s_add_u32 s42, s42, 1
    s_cmp_eq_u32 s42, 8
    s_cselect_b32 s44, s47, s46
    s_cselect_b32 s42, 0, s42
    s_add_u32 s43, s43, 1
    s_cmp_eq_u32 s43, 8
    s_cselect_b32 s45, s49, s48
    s_cselect_b32 s43, 0, s43
    s_add_u32 m0, s40, 49152
    s_nop 0
    buffer_load_dwordx4 v106, s[12:15], s34 offen lds
    s_add_u32 s34, s34, s44
    s_add_u32 m0, s40, 50176
    s_nop 0
    buffer_load_dwordx4 v107, s[12:15], s35 offen lds
    s_add_u32 s35, s35, s44
    s_add_u32 m0, s40, 51200
    s_nop 0
    buffer_load_dwordx4 v108, s[12:15], s36 offen lds
    s_add_u32 s36, s36, s44
    s_add_u32 m0, s40, 52224
    s_nop 0
    buffer_load_dwordx4 v109, s[12:15], s37 offen lds
    s_add_u32 s37, s37, s44
    s_add_u32 m0, s41, 49152
    s_nop 0
    buffer_load_dwordx4 v110, s[16:19], s38 offen lds
    s_add_u32 s38, s38, s45
    s_add_u32 m0, s41, 50176
    s_nop 0
    buffer_load_dwordx4 v110, s[16:19], s39 offen lds
    s_add_u32 s39, s39, s45
    s_mul_i32 s50, s29, 8192
    v_mul_u32_u24 v114, 128, v113
    v_add_u32 v114, s50, v114
    v_mov_b32 v115, v113
    v_lshrrev_b32 v115, 1, v115
    v_and_b32 v115, 7, v115
    s_lshl_b32 s51, s31, 1
    v_add_u32 v116, s51, v112
    v_add_u32 v117, 0, v116
    v_xor_b32 v117, v117, v115
    v_lshlrev_b32 v117, 4, v117
    v_add_u32 v100, v114, v117
    v_add_u32 v117, 2, v116
    v_xor_b32 v117, v117, v115
    v_lshlrev_b32 v117, 4, v117
    v_add_u32 v101, v114, v117
    v_add_u32 v117, 4, v116
    v_xor_b32 v117, v117, v115
    v_lshlrev_b32 v117, 4, v117
    v_add_u32 v102, v114, v117
    v_add_u32 v117, 6, v116
    v_xor_b32 v117, v117, v115
    v_lshlrev_b32 v117, 4, v117
    v_add_u32 v103, v114, v117
    v_and_b32 v114, 15, v111
    v_lshrrev_b32 v114, 2, v114
    v_mul_u32_u24 v115, 8, v112
    v_add_u32 v115, v115, v114
    v_mul_u32_u24 v115, 256, v115
    v_lshlrev_b32 v116, 2, v114
    v_lshrrev_b32 v117, 4, v111
    v_and_b32 v117, 1, v117
    v_lshlrev_b32 v117, 1, v117
    v_and_b32 v118, 3, v111
    v_lshrrev_b32 v119, 1, v118
    v_add_u32 v117, v117, v119
    s_mul_i32 s50, s30, 8
    v_add_u32 v117, s50, v117
    v_and_b32 v118, 1, v118
    v_lshlrev_b32 v118, 3, v118
    v_add_u32 v118, v118, v115
    v_add_u32 v118, 32768, v118
    v_add_u32 v119, 0, v117
    v_xor_b32 v119, v119, v116
    v_lshlrev_b32 v119, 4, v119
    v_add_u32 v104, v118, v119
    v_add_u32 v119, 4, v117
    v_xor_b32 v119, v119, v116
    v_lshlrev_b32 v119, 4, v119
    v_add_u32 v105, v118, v119
    s_waitcnt vmcnt(12)
    v_lshlrev_b32 v4, 16, v84
    v_and_b32 v5, 0xffff0000, v84
    v_lshlrev_b32 v6, 16, v85
    v_and_b32 v7, 0xffff0000, v85
    v_lshlrev_b32 v8, 16, v86
    v_and_b32 v9, 0xffff0000, v86
    v_lshlrev_b32 v10, 16, v87
    v_and_b32 v11, 0xffff0000, v87
    v_lshlrev_b32 v12, 16, v92
    v_and_b32 v13, 0xffff0000, v92
    v_lshlrev_b32 v14, 16, v93
    v_and_b32 v15, 0xffff0000, v93
    v_lshlrev_b32 v16, 16, v94
    v_and_b32 v17, 0xffff0000, v94
    v_lshlrev_b32 v18, 16, v95
    v_and_b32 v19, 0xffff0000, v95
    v_lshlrev_b32 v20, 16, v84
    v_and_b32 v21, 0xffff0000, v84
    v_lshlrev_b32 v22, 16, v85
    v_and_b32 v23, 0xffff0000, v85
    v_lshlrev_b32 v24, 16, v86
    v_and_b32 v25, 0xffff0000, v86
    v_lshlrev_b32 v26, 16, v87
    v_and_b32 v27, 0xffff0000, v87
    v_lshlrev_b32 v28, 16, v92
    v_and_b32 v29, 0xffff0000, v92
    v_lshlrev_b32 v30, 16, v93
    v_and_b32 v31, 0xffff0000, v93
    v_lshlrev_b32 v32, 16, v94
    v_and_b32 v33, 0xffff0000, v94
    v_lshlrev_b32 v34, 16, v95
    v_and_b32 v35, 0xffff0000, v95
    v_lshlrev_b32 v36, 16, v88
    v_and_b32 v37, 0xffff0000, v88
    v_lshlrev_b32 v38, 16, v89
    v_and_b32 v39, 0xffff0000, v89
    v_lshlrev_b32 v40, 16, v90
    v_and_b32 v41, 0xffff0000, v90
    v_lshlrev_b32 v42, 16, v91
    v_and_b32 v43, 0xffff0000, v91
    v_lshlrev_b32 v44, 16, v96
    v_and_b32 v45, 0xffff0000, v96
    v_lshlrev_b32 v46, 16, v97
    v_and_b32 v47, 0xffff0000, v97
    v_lshlrev_b32 v48, 16, v98
    v_and_b32 v49, 0xffff0000, v98
    v_lshlrev_b32 v50, 16, v99
    v_and_b32 v51, 0xffff0000, v99
    v_lshlrev_b32 v52, 16, v88
    v_and_b32 v53, 0xffff0000, v88
    v_lshlrev_b32 v54, 16, v89
    v_and_b32 v55, 0xffff0000, v89
    v_lshlrev_b32 v56, 16, v90
    v_and_b32 v57, 0xffff0000, v90
    v_lshlrev_b32 v58, 16, v91
    v_and_b32 v59, 0xffff0000, v91
    v_lshlrev_b32 v60, 16, v96
    v_and_b32 v61, 0xffff0000, v96
    v_lshlrev_b32 v62, 16, v97
    v_and_b32 v63, 0xffff0000, v97
    v_lshlrev_b32 v64, 16, v98
    v_and_b32 v65, 0xffff0000, v98
    v_lshlrev_b32 v66, 16, v99
    v_and_b32 v67, 0xffff0000, v99
    s_waitcnt vmcnt(6)
    s_barrier
    ds_read_b128 v[68:71], v100 offset:0
    ds_read_b128 v[72:75], v100 offset:4096
    ds_read_b64_tr_b16 v[84:85], v104 offset:0
    ds_read_b64_tr_b16 v[86:87], v104 offset:1024
    ds_read_b64_tr_b16 v[88:89], v105 offset:0
    ds_read_b64_tr_b16 v[90:91], v105 offset:1024
    ds_read_b128 v[76:79], v101 offset:0
    ds_read_b128 v[80:83], v101 offset:4096
    ds_read_b64_tr_b16 v[92:93], v104 offset:4096
    ds_read_b64_tr_b16 v[94:95], v104 offset:5120
    ds_read_b64_tr_b16 v[96:97], v105 offset:4096
    ds_read_b64_tr_b16 v[98:99], v105 offset:5120
    s_waitcnt lgkmcnt(6)
    v_mfma_f32_32x32x16_bf16 v[4:19], v[84:87], v[68:71], v[4:19]
    v_mfma_f32_32x32x16_bf16 v[20:35], v[84:87], v[72:75], v[20:35]
    v_mfma_f32_32x32x16_bf16 v[36:51], v[88:91], v[68:71], v[36:51]
    v_mfma_f32_32x32x16_bf16 v[52:67], v[88:91], v[72:75], v[52:67]
    s_waitcnt vmcnt(0)
    s_barrier
    s_add_u32 s42, s42, 1
    s_cmp_eq_u32 s42, 8
    s_cselect_b32 s44, s47, s46
    s_cselect_b32 s42, 0, s42
    s_add_u32 s43, s43, 1
    s_cmp_eq_u32 s43, 8
    s_cselect_b32 s45, s49, s48
    s_cselect_b32 s43, 0, s43
    s_add_u32 m0, s40, 98304
    s_nop 0
    buffer_load_dwordx4 v106, s[12:15], s34 offen lds
    s_add_u32 s34, s34, s44
    s_add_u32 m0, s40, 99328
    s_nop 0
    buffer_load_dwordx4 v107, s[12:15], s35 offen lds
    s_add_u32 s35, s35, s44
    s_add_u32 m0, s40, 100352
    s_nop 0
    buffer_load_dwordx4 v108, s[12:15], s36 offen lds
    s_add_u32 s36, s36, s44
    s_add_u32 m0, s40, 101376
    s_nop 0
    buffer_load_dwordx4 v109, s[12:15], s37 offen lds
    s_add_u32 s37, s37, s44
    s_add_u32 m0, s41, 98304
    s_nop 0
    buffer_load_dwordx4 v110, s[16:19], s38 offen lds
    s_add_u32 s38, s38, s45
    s_add_u32 m0, s41, 99328
    s_nop 0
    buffer_load_dwordx4 v110, s[16:19], s39 offen lds
    s_add_u32 s39, s39, s45
    ds_read_b128 v[68:71], v102 offset:0
    ds_read_b128 v[72:75], v102 offset:4096
    ds_read_b64_tr_b16 v[84:85], v104 offset:8192
    ds_read_b64_tr_b16 v[86:87], v104 offset:9216
    ds_read_b64_tr_b16 v[88:89], v105 offset:8192
    ds_read_b64_tr_b16 v[90:91], v105 offset:9216
    s_waitcnt lgkmcnt(6)
    v_mfma_f32_32x32x16_bf16 v[4:19], v[92:95], v[76:79], v[4:19]
    v_mfma_f32_32x32x16_bf16 v[20:35], v[92:95], v[80:83], v[20:35]
    v_mfma_f32_32x32x16_bf16 v[36:51], v[96:99], v[76:79], v[36:51]
    v_mfma_f32_32x32x16_bf16 v[52:67], v[96:99], v[80:83], v[52:67]
    ds_read_b128 v[76:79], v103 offset:0
    ds_read_b128 v[80:83], v103 offset:4096
    ds_read_b64_tr_b16 v[92:93], v104 offset:12288
    ds_read_b64_tr_b16 v[94:95], v104 offset:13312
    ds_read_b64_tr_b16 v[96:97], v105 offset:12288
    ds_read_b64_tr_b16 v[98:99], v105 offset:13312
    s_waitcnt lgkmcnt(6)
    v_mfma_f32_32x32x16_bf16 v[4:19], v[84:87], v[68:71], v[4:19]
    v_mfma_f32_32x32x16_bf16 v[20:35], v[84:87], v[72:75], v[20:35]
    v_mfma_f32_32x32x16_bf16 v[36:51], v[88:91], v[68:71], v[36:51]
    v_mfma_f32_32x32x16_bf16 v[52:67], v[88:91], v[72:75], v[52:67]
    v_add_u32 v100, 49152, v100
    v_add_u32 v101, 49152, v101
    v_add_u32 v102, 49152, v102
    v_add_u32 v103, 49152, v103
    v_add_u32 v104, 49152, v104
    v_add_u32 v105, 49152, v105
    ds_read_b128 v[68:71], v100 offset:0
    ds_read_b128 v[72:75], v100 offset:4096
    ds_read_b64_tr_b16 v[84:85], v104 offset:0
    ds_read_b64_tr_b16 v[86:87], v104 offset:1024
    ds_read_b64_tr_b16 v[88:89], v105 offset:0
    ds_read_b64_tr_b16 v[90:91], v105 offset:1024
    s_waitcnt lgkmcnt(6)
    v_mfma_f32_32x32x16_bf16 v[4:19], v[92:95], v[76:79], v[4:19]
    v_mfma_f32_32x32x16_bf16 v[20:35], v[92:95], v[80:83], v[20:35]
    v_mfma_f32_32x32x16_bf16 v[36:51], v[96:99], v[76:79], v[36:51]
    v_mfma_f32_32x32x16_bf16 v[52:67], v[96:99], v[80:83], v[52:67]
    ds_read_b128 v[76:79], v101 offset:0
    ds_read_b128 v[80:83], v101 offset:4096
    ds_read_b64_tr_b16 v[92:93], v104 offset:4096
    ds_read_b64_tr_b16 v[94:95], v104 offset:5120
    ds_read_b64_tr_b16 v[96:97], v105 offset:4096
    ds_read_b64_tr_b16 v[98:99], v105 offset:5120
    s_waitcnt lgkmcnt(6)
    v_mfma_f32_32x32x16_bf16 v[4:19], v[84:87], v[68:71], v[4:19]
    v_mfma_f32_32x32x16_bf16 v[20:35], v[84:87], v[72:75], v[20:35]
    v_mfma_f32_32x32x16_bf16 v[36:51], v[88:91], v[68:71], v[36:51]
    v_mfma_f32_32x32x16_bf16 v[52:67], v[88:91], v[72:75], v[52:67]
    s_waitcnt vmcnt(0)
    s_barrier
    s_add_u32 s42, s42, 1
    s_cmp_eq_u32 s42, 8
    s_cselect_b32 s44, s47, s46
    s_cselect_b32 s42, 0, s42
    s_add_u32 s43, s43, 1
    s_cmp_eq_u32 s43, 8
    s_cselect_b32 s45, s49, s48
    s_cselect_b32 s43, 0, s43
    s_add_u32 m0, s40, 0
    s_nop 0
    buffer_load_dwordx4 v106, s[12:15], s34 offen lds
    s_add_u32 s34, s34, s44
    s_add_u32 m0, s40, 1024
    s_nop 0
    buffer_load_dwordx4 v107, s[12:15], s35 offen lds
    s_add_u32 s35, s35, s44
    s_add_u32 m0, s40, 2048
    s_nop 0
    buffer_load_dwordx4 v108, s[12:15], s36 offen lds
    s_add_u32 s36, s36, s44
    s_add_u32 m0, s40, 3072
    s_nop 0
    buffer_load_dwordx4 v109, s[12:15], s37 offen lds
    s_add_u32 s37, s37, s44
    s_add_u32 m0, s41, 0
    s_nop 0
    buffer_load_dwordx4 v110, s[16:19], s38 offen lds
    s_add_u32 s38, s38, s45
    s_add_u32 m0, s41, 1024
    s_nop 0
    buffer_load_dwordx4 v110, s[16:19], s39 offen lds
    s_add_u32 s39, s39, s45
    ds_read_b128 v[68:71], v102 offset:0
    ds_read_b128 v[72:75], v102 offset:4096
    ds_read_b64_tr_b16 v[84:85], v104 offset:8192
    ds_read_b64_tr_b16 v[86:87], v104 offset:9216
    ds_read_b64_tr_b16 v[88:89], v105 offset:8192
    ds_read_b64_tr_b16 v[90:91], v105 offset:9216
    s_waitcnt lgkmcnt(6)
    v_mfma_f32_32x32x16_bf16 v[4:19], v[92:95], v[76:79], v[4:19]
    v_mfma_f32_32x32x16_bf16 v[20:35], v[92:95], v[80:83], v[20:35]
    v_mfma_f32_32x32x16_bf16 v[36:51], v[96:99], v[76:79], v[36:51]
    v_mfma_f32_32x32x16_bf16 v[52:67], v[96:99], v[80:83], v[52:67]
    ds_read_b128 v[76:79], v103 offset:0
    ds_read_b128 v[80:83], v103 offset:4096
    ds_read_b64_tr_b16 v[92:93], v104 offset:12288
    ds_read_b64_tr_b16 v[94:95], v104 offset:13312
    ds_read_b64_tr_b16 v[96:97], v105 offset:12288
    ds_read_b64_tr_b16 v[98:99], v105 offset:13312
    s_waitcnt lgkmcnt(6)
    v_mfma_f32_32x32x16_bf16 v[4:19], v[84:87], v[68:71], v[4:19]
    v_mfma_f32_32x32x16_bf16 v[20:35], v[84:87], v[72:75], v[20:35]
    v_mfma_f32_32x32x16_bf16 v[36:51], v[88:91], v[68:71], v[36:51]
    v_mfma_f32_32x32x16_bf16 v[52:67], v[88:91], v[72:75], v[52:67]
    v_add_u32 v100, 49152, v100
    v_add_u32 v101, 49152, v101
    v_add_u32 v102, 49152, v102
    v_add_u32 v103, 49152, v103
    v_add_u32 v104, 49152, v104
    v_add_u32 v105, 49152, v105
    ds_read_b128 v[68:71], v100 offset:0
    ds_read_b128 v[72:75], v100 offset:4096
    ds_read_b64_tr_b16 v[84:85], v104 offset:0
    ds_read_b64_tr_b16 v[86:87], v104 offset:1024
    ds_read_b64_tr_b16 v[88:89], v105 offset:0
    ds_read_b64_tr_b16 v[90:91], v105 offset:1024
    s_waitcnt lgkmcnt(6)
    v_mfma_f32_32x32x16_bf16 v[4:19], v[92:95], v[76:79], v[4:19]
    v_mfma_f32_32x32x16_bf16 v[20:35], v[92:95], v[80:83], v[20:35]
    v_mfma_f32_32x32x16_bf16 v[36:51], v[96:99], v[76:79], v[36:51]
    v_mfma_f32_32x32x16_bf16 v[52:67], v[96:99], v[80:83], v[52:67]
    ds_read_b128 v[76:79], v101 offset:0
    ds_read_b128 v[80:83], v101 offset:4096
    ds_read_b64_tr_b16 v[92:93], v104 offset:4096
    ds_read_b64_tr_b16 v[94:95], v104 offset:5120
    ds_read_b64_tr_b16 v[96:97], v105 offset:4096
    ds_read_b64_tr_b16 v[98:99], v105 offset:5120
    s_waitcnt lgkmcnt(6)
    v_mfma_f32_32x32x16_bf16 v[4:19], v[84:87], v[68:71], v[4:19]
    v_mfma_f32_32x32x16_bf16 v[20:35], v[84:87], v[72:75], v[20:35]
    v_mfma_f32_32x32x16_bf16 v[36:51], v[88:91], v[68:71], v[36:51]
    v_mfma_f32_32x32x16_bf16 v[52:67], v[88:91], v[72:75], v[52:67]
    s_waitcnt vmcnt(0)
    s_barrier
    s_add_u32 s42, s42, 1
    s_cmp_eq_u32 s42, 8
    s_cselect_b32 s44, s47, s46
    s_cselect_b32 s42, 0, s42
    s_add_u32 s43, s43, 1
    s_cmp_eq_u32 s43, 8
    s_cselect_b32 s45, s49, s48
    s_cselect_b32 s43, 0, s43
    s_add_u32 m0, s40, 49152
    s_nop 0
    buffer_load_dwordx4 v106, s[12:15], s34 offen lds
    s_add_u32 s34, s34, s44
    s_add_u32 m0, s40, 50176
    s_nop 0
    buffer_load_dwordx4 v107, s[12:15], s35 offen lds
    s_add_u32 s35, s35, s44
    s_add_u32 m0, s40, 51200
    s_nop 0
    buffer_load_dwordx4 v108, s[12:15], s36 offen lds
    s_add_u32 s36, s36, s44
    s_add_u32 m0, s40, 52224
    s_nop 0
    buffer_load_dwordx4 v109, s[12:15], s37 offen lds
    s_add_u32 s37, s37, s44
    s_add_u32 m0, s41, 49152
    s_nop 0
    buffer_load_dwordx4 v110, s[16:19], s38 offen lds
    s_add_u32 s38, s38, s45
    s_add_u32 m0, s41, 50176
    s_nop 0
    buffer_load_dwordx4 v110, s[16:19], s39 offen lds
    s_add_u32 s39, s39, s45
    ds_read_b128 v[68:71], v102 offset:0
    ds_read_b128 v[72:75], v102 offset:4096
    ds_read_b64_tr_b16 v[84:85], v104 offset:8192
    ds_read_b64_tr_b16 v[86:87], v104 offset:9216
    ds_read_b64_tr_b16 v[88:89], v105 offset:8192
    ds_read_b64_tr_b16 v[90:91], v105 offset:9216
    s_waitcnt lgkmcnt(6)
    v_mfma_f32_32x32x16_bf16 v[4:19], v[92:95], v[76:79], v[4:19]
    v_mfma_f32_32x32x16_bf16 v[20:35], v[92:95], v[80:83], v[20:35]
    v_mfma_f32_32x32x16_bf16 v[36:51], v[96:99], v[76:79], v[36:51]
    v_mfma_f32_32x32x16_bf16 v[52:67], v[96:99], v[80:83], v[52:67]
    ds_read_b128 v[76:79], v103 offset:0
    ds_read_b128 v[80:83], v103 offset:4096
    ds_read_b64_tr_b16 v[92:93], v104 offset:12288
    ds_read_b64_tr_b16 v[94:95], v104 offset:13312
    ds_read_b64_tr_b16 v[96:97], v105 offset:12288
    ds_read_b64_tr_b16 v[98:99], v105 offset:13312
    s_waitcnt lgkmcnt(6)
    v_mfma_f32_32x32x16_bf16 v[4:19], v[84:87], v[68:71], v[4:19]
    v_mfma_f32_32x32x16_bf16 v[20:35], v[84:87], v[72:75], v[20:35]
    v_mfma_f32_32x32x16_bf16 v[36:51], v[88:91], v[68:71], v[36:51]
    v_mfma_f32_32x32x16_bf16 v[52:67], v[88:91], v[72:75], v[52:67]
    v_subrev_u32 v100, 98304, v100
    v_subrev_u32 v101, 98304, v101
    v_subrev_u32 v102, 98304, v102
    v_subrev_u32 v103, 98304, v103
    v_subrev_u32 v104, 98304, v104
    v_subrev_u32 v105, 98304, v105
    ds_read_b128 v[68:71], v100 offset:0
    ds_read_b128 v[72:75], v100 offset:4096
    ds_read_b64_tr_b16 v[84:85], v104 offset:0
    ds_read_b64_tr_b16 v[86:87], v104 offset:1024
    ds_read_b64_tr_b16 v[88:89], v105 offset:0
    ds_read_b64_tr_b16 v[90:91], v105 offset:1024
    s_waitcnt lgkmcnt(6)
    v_mfma_f32_32x32x16_bf16 v[4:19], v[92:95], v[76:79], v[4:19]
    v_mfma_f32_32x32x16_bf16 v[20:35], v[92:95], v[80:83], v[20:35]
    v_mfma_f32_32x32x16_bf16 v[36:51], v[96:99], v[76:79], v[36:51]
    v_mfma_f32_32x32x16_bf16 v[52:67], v[96:99], v[80:83], v[52:67]
    ds_read_b128 v[76:79], v101 offset:0
    ds_read_b128 v[80:83], v101 offset:4096
    ds_read_b64_tr_b16 v[92:93], v104 offset:4096
    ds_read_b64_tr_b16 v[94:95], v104 offset:5120
    ds_read_b64_tr_b16 v[96:97], v105 offset:4096
    ds_read_b64_tr_b16 v[98:99], v105 offset:5120
    s_waitcnt lgkmcnt(6)
    v_mfma_f32_32x32x16_bf16 v[4:19], v[84:87], v[68:71], v[4:19]
    v_mfma_f32_32x32x16_bf16 v[20:35], v[84:87], v[72:75], v[20:35]
    v_mfma_f32_32x32x16_bf16 v[36:51], v[88:91], v[68:71], v[36:51]
    v_mfma_f32_32x32x16_bf16 v[52:67], v[88:91], v[72:75], v[52:67]
    s_waitcnt vmcnt(0)
    s_barrier
    s_add_u32 s42, s42, 1
    s_cmp_eq_u32 s42, 8
    s_cselect_b32 s44, s47, s46
    s_cselect_b32 s42, 0, s42
    s_add_u32 s43, s43, 1
    s_cmp_eq_u32 s43, 8
    s_cselect_b32 s45, s49, s48
    s_cselect_b32 s43, 0, s43
    s_add_u32 m0, s40, 98304
    s_nop 0
    buffer_load_dwordx4 v106, s[12:15], s34 offen lds
    s_add_u32 s34, s34, s44
    s_add_u32 m0, s40, 99328
    s_nop 0
    buffer_load_dwordx4 v107, s[12:15], s35 offen lds
    s_add_u32 s35, s35, s44
    s_add_u32 m0, s40, 100352
    s_nop 0
    buffer_load_dwordx4 v108, s[12:15], s36 offen lds
    s_add_u32 s36, s36, s44
    s_add_u32 m0, s40, 101376
    s_nop 0
    buffer_load_dwordx4 v109, s[12:15], s37 offen lds
    s_add_u32 s37, s37, s44
    s_add_u32 m0, s41, 98304
    s_nop 0
    buffer_load_dwordx4 v110, s[16:19], s38 offen lds
    s_add_u32 s38, s38, s45
    s_add_u32 m0, s41, 99328
    s_nop 0
    buffer_load_dwordx4 v110, s[16:19], s39 offen lds
    s_add_u32 s39, s39, s45
    ds_read_b128 v[68:71], v102 offset:0
    ds_read_b128 v[72:75], v102 offset:4096
    ds_read_b64_tr_b16 v[84:85], v104 offset:8192
    ds_read_b64_tr_b16 v[86:87], v104 offset:9216
    ds_read_b64_tr_b16 v[88:89], v105 offset:8192
    ds_read_b64_tr_b16 v[90:91], v105 offset:9216
    s_waitcnt lgkmcnt(6)
    v_mfma_f32_32x32x16_bf16 v[4:19], v[92:95], v[76:79], v[4:19]
    v_mfma_f32_32x32x16_bf16 v[20:35], v[92:95], v[80:83], v[20:35]
    v_mfma_f32_32x32x16_bf16 v[36:51], v[96:99], v[76:79], v[36:51]
    v_mfma_f32_32x32x16_bf16 v[52:67], v[96:99], v[80:83], v[52:67]
    ds_read_b128 v[76:79], v103 offset:0
    ds_read_b128 v[80:83], v103 offset:4096
    ds_read_b64_tr_b16 v[92:93], v104 offset:12288
    ds_read_b64_tr_b16 v[94:95], v104 offset:13312
    ds_read_b64_tr_b16 v[96:97], v105 offset:12288
    ds_read_b64_tr_b16 v[98:99], v105 offset:13312
    s_waitcnt lgkmcnt(6)
    v_mfma_f32_32x32x16_bf16 v[4:19], v[84:87], v[68:71], v[4:19]
    v_mfma_f32_32x32x16_bf16 v[20:35], v[84:87], v[72:75], v[20:35]
    v_mfma_f32_32x32x16_bf16 v[36:51], v[88:91], v[68:71], v[36:51]
    v_mfma_f32_32x32x16_bf16 v[52:67], v[88:91], v[72:75], v[52:67]
    v_add_u32 v100, 49152, v100
    v_add_u32 v101, 49152, v101
    v_add_u32 v102, 49152, v102
    v_add_u32 v103, 49152, v103
    v_add_u32 v104, 49152, v104
    v_add_u32 v105, 49152, v105
    ds_read_b128 v[68:71], v100 offset:0
    ds_read_b128 v[72:75], v100 offset:4096
    ds_read_b64_tr_b16 v[84:85], v104 offset:0
    ds_read_b64_tr_b16 v[86:87], v104 offset:1024
    ds_read_b64_tr_b16 v[88:89], v105 offset:0
    ds_read_b64_tr_b16 v[90:91], v105 offset:1024
    s_waitcnt lgkmcnt(6)
    v_mfma_f32_32x32x16_bf16 v[4:19], v[92:95], v[76:79], v[4:19]
    v_mfma_f32_32x32x16_bf16 v[20:35], v[92:95], v[80:83], v[20:35]
    v_mfma_f32_32x32x16_bf16 v[36:51], v[96:99], v[76:79], v[36:51]
    v_mfma_f32_32x32x16_bf16 v[52:67], v[96:99], v[80:83], v[52:67]
    ds_read_b128 v[76:79], v101 offset:0
    ds_read_b128 v[80:83], v101 offset:4096
    ds_read_b64_tr_b16 v[92:93], v104 offset:4096
    ds_read_b64_tr_b16 v[94:95], v104 offset:5120
    ds_read_b64_tr_b16 v[96:97], v105 offset:4096
    ds_read_b64_tr_b16 v[98:99], v105 offset:5120
    s_waitcnt lgkmcnt(6)
    v_mfma_f32_32x32x16_bf16 v[4:19], v[84:87], v[68:71], v[4:19]
    v_mfma_f32_32x32x16_bf16 v[20:35], v[84:87], v[72:75], v[20:35]
    v_mfma_f32_32x32x16_bf16 v[36:51], v[88:91], v[68:71], v[36:51]
    v_mfma_f32_32x32x16_bf16 v[52:67], v[88:91], v[72:75], v[52:67]
    s_waitcnt vmcnt(0)
    s_barrier
    s_add_u32 s42, s42, 1
    s_cmp_eq_u32 s42, 8
    s_cselect_b32 s44, s47, s46
    s_cselect_b32 s42, 0, s42
    s_add_u32 s43, s43, 1
    s_cmp_eq_u32 s43, 8
    s_cselect_b32 s45, s49, s48
    s_cselect_b32 s43, 0, s43
    s_add_u32 m0, s40, 0
    s_nop 0
    buffer_load_dwordx4 v106, s[12:15], s34 offen lds
    s_add_u32 s34, s34, s44
    s_add_u32 m0, s40, 1024
    s_nop 0
    buffer_load_dwordx4 v107, s[12:15], s35 offen lds
    s_add_u32 s35, s35, s44
    s_add_u32 m0, s40, 2048
    s_nop 0
    buffer_load_dwordx4 v108, s[12:15], s36 offen lds
    s_add_u32 s36, s36, s44
    s_add_u32 m0, s40, 3072
    s_nop 0
    buffer_load_dwordx4 v109, s[12:15], s37 offen lds
    s_add_u32 s37, s37, s44
    s_add_u32 m0, s41, 0
    s_nop 0
    buffer_load_dwordx4 v110, s[16:19], s38 offen lds
    s_add_u32 s38, s38, s45
    s_add_u32 m0, s41, 1024
    s_nop 0
    buffer_load_dwordx4 v110, s[16:19], s39 offen lds
    s_add_u32 s39, s39, s45
    ds_read_b128 v[68:71], v102 offset:0
    ds_read_b128 v[72:75], v102 offset:4096
    ds_read_b64_tr_b16 v[84:85], v104 offset:8192
    ds_read_b64_tr_b16 v[86:87], v104 offset:9216
    ds_read_b64_tr_b16 v[88:89], v105 offset:8192
    ds_read_b64_tr_b16 v[90:91], v105 offset:9216
    s_waitcnt lgkmcnt(6)
    v_mfma_f32_32x32x16_bf16 v[4:19], v[92:95], v[76:79], v[4:19]
    v_mfma_f32_32x32x16_bf16 v[20:35], v[92:95], v[80:83], v[20:35]
    v_mfma_f32_32x32x16_bf16 v[36:51], v[96:99], v[76:79], v[36:51]
    v_mfma_f32_32x32x16_bf16 v[52:67], v[96:99], v[80:83], v[52:67]
    ds_read_b128 v[76:79], v103 offset:0
    ds_read_b128 v[80:83], v103 offset:4096
    ds_read_b64_tr_b16 v[92:93], v104 offset:12288
    ds_read_b64_tr_b16 v[94:95], v104 offset:13312
    ds_read_b64_tr_b16 v[96:97], v105 offset:12288
    ds_read_b64_tr_b16 v[98:99], v105 offset:13312
    s_waitcnt lgkmcnt(6)
    v_mfma_f32_32x32x16_bf16 v[4:19], v[84:87], v[68:71], v[4:19]
    v_mfma_f32_32x32x16_bf16 v[20:35], v[84:87], v[72:75], v[20:35]
    v_mfma_f32_32x32x16_bf16 v[36:51], v[88:91], v[68:71], v[36:51]
    v_mfma_f32_32x32x16_bf16 v[52:67], v[88:91], v[72:75], v[52:67]
    v_add_u32 v100, 49152, v100
    v_add_u32 v101, 49152, v101
    v_add_u32 v102, 49152, v102
    v_add_u32 v103, 49152, v103
    v_add_u32 v104, 49152, v104
    v_add_u32 v105, 49152, v105
    ds_read_b128 v[68:71], v100 offset:0
    ds_read_b128 v[72:75], v100 offset:4096
    ds_read_b64_tr_b16 v[84:85], v104 offset:0
    ds_read_b64_tr_b16 v[86:87], v104 offset:1024
    ds_read_b64_tr_b16 v[88:89], v105 offset:0
    ds_read_b64_tr_b16 v[90:91], v105 offset:1024
    s_waitcnt lgkmcnt(6)
    v_mfma_f32_32x32x16_bf16 v[4:19], v[92:95], v[76:79], v[4:19]
    v_mfma_f32_32x32x16_bf16 v[20:35], v[92:95], v[80:83], v[20:35]
    v_mfma_f32_32x32x16_bf16 v[36:51], v[96:99], v[76:79], v[36:51]
    v_mfma_f32_32x32x16_bf16 v[52:67], v[96:99], v[80:83], v[52:67]
    ds_read_b128 v[76:79], v101 offset:0
    ds_read_b128 v[80:83], v101 offset:4096
    ds_read_b64_tr_b16 v[92:93], v104 offset:4096
    ds_read_b64_tr_b16 v[94:95], v104 offset:5120
    ds_read_b64_tr_b16 v[96:97], v105 offset:4096
    ds_read_b64_tr_b16 v[98:99], v105 offset:5120
    s_waitcnt lgkmcnt(6)
    v_mfma_f32_32x32x16_bf16 v[4:19], v[84:87], v[68:71], v[4:19]
    v_mfma_f32_32x32x16_bf16 v[20:35], v[84:87], v[72:75], v[20:35]
    v_mfma_f32_32x32x16_bf16 v[36:51], v[88:91], v[68:71], v[36:51]
    v_mfma_f32_32x32x16_bf16 v[52:67], v[88:91], v[72:75], v[52:67]
    s_waitcnt vmcnt(0)
    s_barrier
    s_add_u32 s42, s42, 1
    s_cmp_eq_u32 s42, 8
    s_cselect_b32 s44, s47, s46
    s_cselect_b32 s42, 0, s42
    s_add_u32 s43, s43, 1
    s_cmp_eq_u32 s43, 8
    s_cselect_b32 s45, s49, s48
    s_cselect_b32 s43, 0, s43
    s_add_u32 m0, s40, 49152
    s_nop 0
    buffer_load_dwordx4 v106, s[12:15], s34 offen lds
    s_add_u32 s34, s34, s44
    s_add_u32 m0, s40, 50176
    s_nop 0
    buffer_load_dwordx4 v107, s[12:15], s35 offen lds
    s_add_u32 s35, s35, s44
    s_add_u32 m0, s40, 51200
    s_nop 0
    buffer_load_dwordx4 v108, s[12:15], s36 offen lds
    s_add_u32 s36, s36, s44
    s_add_u32 m0, s40, 52224
    s_nop 0
    buffer_load_dwordx4 v109, s[12:15], s37 offen lds
    s_add_u32 s37, s37, s44
    s_add_u32 m0, s41, 49152
    s_nop 0
    buffer_load_dwordx4 v110, s[16:19], s38 offen lds
    s_add_u32 s38, s38, s45
    s_add_u32 m0, s41, 50176
    s_nop 0
    buffer_load_dwordx4 v110, s[16:19], s39 offen lds
    s_add_u32 s39, s39, s45
    ds_read_b128 v[68:71], v102 offset:0
    ds_read_b128 v[72:75], v102 offset:4096
    ds_read_b64_tr_b16 v[84:85], v104 offset:8192
    ds_read_b64_tr_b16 v[86:87], v104 offset:9216
    ds_read_b64_tr_b16 v[88:89], v105 offset:8192
    ds_read_b64_tr_b16 v[90:91], v105 offset:9216
    s_waitcnt lgkmcnt(6)
    v_mfma_f32_32x32x16_bf16 v[4:19], v[92:95], v[76:79], v[4:19]
    v_mfma_f32_32x32x16_bf16 v[20:35], v[92:95], v[80:83], v[20:35]
    v_mfma_f32_32x32x16_bf16 v[36:51], v[96:99], v[76:79], v[36:51]
    v_mfma_f32_32x32x16_bf16 v[52:67], v[96:99], v[80:83], v[52:67]
    ds_read_b128 v[76:79], v103 offset:0
    ds_read_b128 v[80:83], v103 offset:4096
    ds_read_b64_tr_b16 v[92:93], v104 offset:12288
    ds_read_b64_tr_b16 v[94:95], v104 offset:13312
    ds_read_b64_tr_b16 v[96:97], v105 offset:12288
    ds_read_b64_tr_b16 v[98:99], v105 offset:13312
    s_waitcnt lgkmcnt(6)
    v_mfma_f32_32x32x16_bf16 v[4:19], v[84:87], v[68:71], v[4:19]
    v_mfma_f32_32x32x16_bf16 v[20:35], v[84:87], v[72:75], v[20:35]
    v_mfma_f32_32x32x16_bf16 v[36:51], v[88:91], v[68:71], v[36:51]
    v_mfma_f32_32x32x16_bf16 v[52:67], v[88:91], v[72:75], v[52:67]
    v_subrev_u32 v100, 98304, v100
    v_subrev_u32 v101, 98304, v101
    v_subrev_u32 v102, 98304, v102
    v_subrev_u32 v103, 98304, v103
    v_subrev_u32 v104, 98304, v104
    v_subrev_u32 v105, 98304, v105
    ds_read_b128 v[68:71], v100 offset:0
    ds_read_b128 v[72:75], v100 offset:4096
    ds_read_b64_tr_b16 v[84:85], v104 offset:0
    ds_read_b64_tr_b16 v[86:87], v104 offset:1024
    ds_read_b64_tr_b16 v[88:89], v105 offset:0
    ds_read_b64_tr_b16 v[90:91], v105 offset:1024
    s_waitcnt lgkmcnt(6)
    v_mfma_f32_32x32x16_bf16 v[4:19], v[92:95], v[76:79], v[4:19]
    v_mfma_f32_32x32x16_bf16 v[20:35], v[92:95], v[80:83], v[20:35]
    v_mfma_f32_32x32x16_bf16 v[36:51], v[96:99], v[76:79], v[36:51]
    v_mfma_f32_32x32x16_bf16 v[52:67], v[96:99], v[80:83], v[52:67]
    ds_read_b128 v[76:79], v101 offset:0
    ds_read_b128 v[80:83], v101 offset:4096
    ds_read_b64_tr_b16 v[92:93], v104 offset:4096
    ds_read_b64_tr_b16 v[94:95], v104 offset:5120
    ds_read_b64_tr_b16 v[96:97], v105 offset:4096
    ds_read_b64_tr_b16 v[98:99], v105 offset:5120
    s_waitcnt lgkmcnt(6)
    v_mfma_f32_32x32x16_bf16 v[4:19], v[84:87], v[68:71], v[4:19]
    v_mfma_f32_32x32x16_bf16 v[20:35], v[84:87], v[72:75], v[20:35]
    v_mfma_f32_32x32x16_bf16 v[36:51], v[88:91], v[68:71], v[36:51]
    v_mfma_f32_32x32x16_bf16 v[52:67], v[88:91], v[72:75], v[52:67]
    s_waitcnt vmcnt(0)
    s_barrier
    ds_read_b128 v[68:71], v102 offset:0
    ds_read_b128 v[72:75], v102 offset:4096
    ds_read_b64_tr_b16 v[84:85], v104 offset:8192
    ds_read_b64_tr_b16 v[86:87], v104 offset:9216
    ds_read_b64_tr_b16 v[88:89], v105 offset:8192
    ds_read_b64_tr_b16 v[90:91], v105 offset:9216
    s_waitcnt lgkmcnt(6)
    v_mfma_f32_32x32x16_bf16 v[4:19], v[92:95], v[76:79], v[4:19]
    v_mfma_f32_32x32x16_bf16 v[20:35], v[92:95], v[80:83], v[20:35]
    v_mfma_f32_32x32x16_bf16 v[36:51], v[96:99], v[76:79], v[36:51]
    v_mfma_f32_32x32x16_bf16 v[52:67], v[96:99], v[80:83], v[52:67]
    ds_read_b128 v[76:79], v103 offset:0
    ds_read_b128 v[80:83], v103 offset:4096
    ds_read_b64_tr_b16 v[92:93], v104 offset:12288
    ds_read_b64_tr_b16 v[94:95], v104 offset:13312
    ds_read_b64_tr_b16 v[96:97], v105 offset:12288
    ds_read_b64_tr_b16 v[98:99], v105 offset:13312
    s_waitcnt lgkmcnt(6)
    v_mfma_f32_32x32x16_bf16 v[4:19], v[84:87], v[68:71], v[4:19]
    v_mfma_f32_32x32x16_bf16 v[20:35], v[84:87], v[72:75], v[20:35]
    v_mfma_f32_32x32x16_bf16 v[36:51], v[88:91], v[68:71], v[36:51]
    v_mfma_f32_32x32x16_bf16 v[52:67], v[88:91], v[72:75], v[52:67]
    v_add_u32 v100, 49152, v100
    v_add_u32 v101, 49152, v101
    v_add_u32 v102, 49152, v102
    v_add_u32 v103, 49152, v103
    v_add_u32 v104, 49152, v104
    v_add_u32 v105, 49152, v105
    ds_read_b128 v[68:71], v100 offset:0
    ds_read_b128 v[72:75], v100 offset:4096
    ds_read_b64_tr_b16 v[84:85], v104 offset:0
    ds_read_b64_tr_b16 v[86:87], v104 offset:1024
    ds_read_b64_tr_b16 v[88:89], v105 offset:0
    ds_read_b64_tr_b16 v[90:91], v105 offset:1024
    s_waitcnt lgkmcnt(6)
    v_mfma_f32_32x32x16_bf16 v[4:19], v[92:95], v[76:79], v[4:19]
    v_mfma_f32_32x32x16_bf16 v[20:35], v[92:95], v[80:83], v[20:35]
    v_mfma_f32_32x32x16_bf16 v[36:51], v[96:99], v[76:79], v[36:51]
    v_mfma_f32_32x32x16_bf16 v[52:67], v[96:99], v[80:83], v[52:67]
    ds_read_b128 v[76:79], v101 offset:0
    ds_read_b128 v[80:83], v101 offset:4096
    ds_read_b64_tr_b16 v[92:93], v104 offset:4096
    ds_read_b64_tr_b16 v[94:95], v104 offset:5120
    ds_read_b64_tr_b16 v[96:97], v105 offset:4096
    ds_read_b64_tr_b16 v[98:99], v105 offset:5120
    s_waitcnt lgkmcnt(6)
    v_mfma_f32_32x32x16_bf16 v[4:19], v[84:87], v[68:71], v[4:19]
    v_mfma_f32_32x32x16_bf16 v[20:35], v[84:87], v[72:75], v[20:35]
    v_mfma_f32_32x32x16_bf16 v[36:51], v[88:91], v[68:71], v[36:51]
    v_mfma_f32_32x32x16_bf16 v[52:67], v[88:91], v[72:75], v[52:67]
    ds_read_b128 v[68:71], v102 offset:0
    ds_read_b128 v[72:75], v102 offset:4096
    ds_read_b64_tr_b16 v[84:85], v104 offset:8192
    ds_read_b64_tr_b16 v[86:87], v104 offset:9216
    ds_read_b64_tr_b16 v[88:89], v105 offset:8192
    ds_read_b64_tr_b16 v[90:91], v105 offset:9216
    s_waitcnt lgkmcnt(6)
    v_mfma_f32_32x32x16_bf16 v[4:19], v[92:95], v[76:79], v[4:19]
    v_mfma_f32_32x32x16_bf16 v[20:35], v[92:95], v[80:83], v[20:35]
    v_mfma_f32_32x32x16_bf16 v[36:51], v[96:99], v[76:79], v[36:51]
    v_mfma_f32_32x32x16_bf16 v[52:67], v[96:99], v[80:83], v[52:67]
    ds_read_b128 v[76:79], v103 offset:0
    ds_read_b128 v[80:83], v103 offset:4096
    ds_read_b64_tr_b16 v[92:93], v104 offset:12288
    ds_read_b64_tr_b16 v[94:95], v104 offset:13312
    ds_read_b64_tr_b16 v[96:97], v105 offset:12288
    ds_read_b64_tr_b16 v[98:99], v105 offset:13312
    s_waitcnt lgkmcnt(6)
    v_mfma_f32_32x32x16_bf16 v[4:19], v[84:87], v[68:71], v[4:19]
    v_mfma_f32_32x32x16_bf16 v[20:35], v[84:87], v[72:75], v[20:35]
    v_mfma_f32_32x32x16_bf16 v[36:51], v[88:91], v[68:71], v[36:51]
    v_mfma_f32_32x32x16_bf16 v[52:67], v[88:91], v[72:75], v[52:67]
    s_waitcnt lgkmcnt(0)
    v_mfma_f32_32x32x16_bf16 v[4:19], v[92:95], v[76:79], v[4:19]
    v_mfma_f32_32x32x16_bf16 v[20:35], v[92:95], v[80:83], v[20:35]
    v_mfma_f32_32x32x16_bf16 v[36:51], v[96:99], v[76:79], v[36:51]
    v_mfma_f32_32x32x16_bf16 v[52:67], v[96:99], v[80:83], v[52:67]
    s_nop 15
    s_mul_i32 s50, s32, 256
    s_mul_i32 s51, s29, 64
    s_add_u32 s50, s50, s51
    s_mul_i32 s50, s50, 3584
    s_mul_i32 s51, s33, 256
    s_add_u32 s50, s50, s51
    s_mul_i32 s51, s30, 128
    s_add_u32 s50, s50, s51
    s_mov_b32 s52, 3584
    v_mul_lo_u32 v114, v113, s52
    v_lshlrev_b32 v115, 5, v112
    v_add_u32 v114, v114, v115
    v_max_f32 v4, 0, v4
    v_mul_f32 v4, v4, v4
    v_max_f32 v5, 0, v5
    v_mul_f32 v5, v5, v5
    v_max_f32 v6, 0, v6
    v_mul_f32 v6, v6, v6
    v_max_f32 v7, 0, v7
    v_mul_f32 v7, v7, v7
    v_max_f32 v8, 0, v8
    v_mul_f32 v8, v8, v8
    v_max_f32 v9, 0, v9
    v_mul_f32 v9, v9, v9
    v_max_f32 v10, 0, v10
    v_mul_f32 v10, v10, v10
    v_max_f32 v11, 0, v11
    v_mul_f32 v11, v11, v11
    v_max_f32 v12, 0, v12
    v_mul_f32 v12, v12, v12
    v_max_f32 v13, 0, v13
    v_mul_f32 v13, v13, v13
    v_max_f32 v14, 0, v14
    v_mul_f32 v14, v14, v14
    v_max_f32 v15, 0, v15
    v_mul_f32 v15, v15, v15
    v_max_f32 v16, 0, v16
    v_mul_f32 v16, v16, v16
    v_max_f32 v17, 0, v17
    v_mul_f32 v17, v17, v17
    v_max_f32 v18, 0, v18
    v_mul_f32 v18, v18, v18
    v_max_f32 v19, 0, v19
    v_mul_f32 v19, v19, v19
    v_cvt_pk_bf16_f32 v68, v4, v5
    v_cvt_pk_bf16_f32 v69, v6, v7
    v_cvt_pk_bf16_f32 v70, v8, v9
    v_cvt_pk_bf16_f32 v71, v10, v11
    v_cvt_pk_bf16_f32 v76, v12, v13
    v_cvt_pk_bf16_f32 v77, v14, v15
    v_cvt_pk_bf16_f32 v78, v16, v17
    v_cvt_pk_bf16_f32 v79, v18, v19
    s_add_u32 s51, s50, 0
    buffer_store_dwordx4 v[68:71], v114, s[20:23], s51 offen
    buffer_store_dwordx4 v[76:79], v114, s[20:23], s51 offen offset:16
    v_max_f32 v20, 0, v20
    v_mul_f32 v20, v20, v20
    v_max_f32 v21, 0, v21
    v_mul_f32 v21, v21, v21
    v_max_f32 v22, 0, v22
    v_mul_f32 v22, v22, v22
    v_max_f32 v23, 0, v23
    v_mul_f32 v23, v23, v23
    v_max_f32 v24, 0, v24
    v_mul_f32 v24, v24, v24
    v_max_f32 v25, 0, v25
    v_mul_f32 v25, v25, v25
    v_max_f32 v26, 0, v26
    v_mul_f32 v26, v26, v26
    v_max_f32 v27, 0, v27
    v_mul_f32 v27, v27, v27
    v_max_f32 v28, 0, v28
    v_mul_f32 v28, v28, v28
    v_max_f32 v29, 0, v29
    v_mul_f32 v29, v29, v29
    v_max_f32 v30, 0, v30
    v_mul_f32 v30, v30, v30
    v_max_f32 v31, 0, v31
    v_mul_f32 v31, v31, v31
    v_max_f32 v32, 0, v32
    v_mul_f32 v32, v32, v32
    v_max_f32 v33, 0, v33
    v_mul_f32 v33, v33, v33
    v_max_f32 v34, 0, v34
    v_mul_f32 v34, v34, v34
    v_max_f32 v35, 0, v35
    v_mul_f32 v35, v35, v35
    v_cvt_pk_bf16_f32 v84, v20, v21
    v_cvt_pk_bf16_f32 v85, v22, v23
    v_cvt_pk_bf16_f32 v86, v24, v25
    v_cvt_pk_bf16_f32 v87, v26, v27
    v_cvt_pk_bf16_f32 v92, v28, v29
    v_cvt_pk_bf16_f32 v93, v30, v31
    v_cvt_pk_bf16_f32 v94, v32, v33
    v_cvt_pk_bf16_f32 v95, v34, v35
    s_add_u32 s51, s50, 114688
    buffer_store_dwordx4 v[84:87], v114, s[20:23], s51 offen
    buffer_store_dwordx4 v[92:95], v114, s[20:23], s51 offen offset:16
    v_max_f32 v36, 0, v36
    v_mul_f32 v36, v36, v36
    v_max_f32 v37, 0, v37
    v_mul_f32 v37, v37, v37
    v_max_f32 v38, 0, v38
    v_mul_f32 v38, v38, v38
    v_max_f32 v39, 0, v39
    v_mul_f32 v39, v39, v39
    v_max_f32 v40, 0, v40
    v_mul_f32 v40, v40, v40
    v_max_f32 v41, 0, v41
    v_mul_f32 v41, v41, v41
    v_max_f32 v42, 0, v42
    v_mul_f32 v42, v42, v42
    v_max_f32 v43, 0, v43
    v_mul_f32 v43, v43, v43
    v_max_f32 v44, 0, v44
    v_mul_f32 v44, v44, v44
    v_max_f32 v45, 0, v45
    v_mul_f32 v45, v45, v45
    v_max_f32 v46, 0, v46
    v_mul_f32 v46, v46, v46
    v_max_f32 v47, 0, v47
    v_mul_f32 v47, v47, v47
    v_max_f32 v48, 0, v48
    v_mul_f32 v48, v48, v48
    v_max_f32 v49, 0, v49
    v_mul_f32 v49, v49, v49
    v_max_f32 v50, 0, v50
    v_mul_f32 v50, v50, v50
    v_max_f32 v51, 0, v51
    v_mul_f32 v51, v51, v51
    v_cvt_pk_bf16_f32 v68, v36, v37
    v_cvt_pk_bf16_f32 v69, v38, v39
    v_cvt_pk_bf16_f32 v70, v40, v41
    v_cvt_pk_bf16_f32 v71, v42, v43
    v_cvt_pk_bf16_f32 v76, v44, v45
    v_cvt_pk_bf16_f32 v77, v46, v47
    v_cvt_pk_bf16_f32 v78, v48, v49
    v_cvt_pk_bf16_f32 v79, v50, v51
    s_add_u32 s51, s50, 64
    buffer_store_dwordx4 v[68:71], v114, s[20:23], s51 offen
    buffer_store_dwordx4 v[76:79], v114, s[20:23], s51 offen offset:16
    v_max_f32 v52, 0, v52
    v_mul_f32 v52, v52, v52
    v_max_f32 v53, 0, v53
    v_mul_f32 v53, v53, v53
    v_max_f32 v54, 0, v54
    v_mul_f32 v54, v54, v54
    v_max_f32 v55, 0, v55
    v_mul_f32 v55, v55, v55
    v_max_f32 v56, 0, v56
    v_mul_f32 v56, v56, v56
    v_max_f32 v57, 0, v57
    v_mul_f32 v57, v57, v57
    v_max_f32 v58, 0, v58
    v_mul_f32 v58, v58, v58
    v_max_f32 v59, 0, v59
    v_mul_f32 v59, v59, v59
    v_max_f32 v60, 0, v60
    v_mul_f32 v60, v60, v60
    v_max_f32 v61, 0, v61
    v_mul_f32 v61, v61, v61
    v_max_f32 v62, 0, v62
    v_mul_f32 v62, v62, v62
    v_max_f32 v63, 0, v63
    v_mul_f32 v63, v63, v63
    v_max_f32 v64, 0, v64
    v_mul_f32 v64, v64, v64
    v_max_f32 v65, 0, v65
    v_mul_f32 v65, v65, v65
    v_max_f32 v66, 0, v66
    v_mul_f32 v66, v66, v66
    v_max_f32 v67, 0, v67
    v_mul_f32 v67, v67, v67
    v_cvt_pk_bf16_f32 v84, v52, v53
    v_cvt_pk_bf16_f32 v85, v54, v55
    v_cvt_pk_bf16_f32 v86, v56, v57
    v_cvt_pk_bf16_f32 v87, v58, v59
    v_cvt_pk_bf16_f32 v92, v60, v61
    v_cvt_pk_bf16_f32 v93, v62, v63
    v_cvt_pk_bf16_f32 v94, v64, v65
    v_cvt_pk_bf16_f32 v95, v66, v67
    s_add_u32 s51, s50, 114752
    buffer_store_dwordx4 v[84:87], v114, s[20:23], s51 offen
    buffer_store_dwordx4 v[92:95], v114, s[20:23], s51 offen offset:16
    s_endpgm
k1_role_G:
    s_sub_u32 s3, s2, 208
    s_load_dwordx2 s[4:5], s[0:1], 0
    s_load_dwordx2 s[6:7], s[0:1], 64
    s_load_dwordx2 s[8:9], s[0:1], 88
    v_lshrrev_b32 v56, 6, v0
    v_and_b32 v1, 63, v0
    v_lshlrev_b32 v2, 4, v1
    v_readfirstlane_b32 s24, v56
    s_waitcnt lgkmcnt(0)
    s_mov_b32 s12, s4
    s_mov_b32 s13, s5
    s_mov_b32 s14, 2097152
    s_mov_b32 s15, 0x00020000
    s_mov_b32 s16, s6
    s_mov_b32 s17, s7
    s_mov_b32 s18, 1024
    s_mov_b32 s19, 0x00020000
    s_add_u32 s26, s8, 17825792
    s_addc_u32 s27, s9, 0
    s_mov_b32 s20, s26
    s_mov_b32 s21, s27
    s_mov_b32 s22, 8192
    s_mov_b32 s23, 0x00020000
    s_lshl_b32 s25, s3, 6
    s_lshl_b32 s26, s24, 3
    s_add_u32 s25, s25, s26
    s_lshl_b32 s27, s25, 10
    buffer_load_dwordx4 v[4:7], v2, s[16:19], 0 offen
    s_add_u32 s28, s27, 0
    buffer_load_dwordx4 v[16:19], v2, s[12:15], s28 offen
    s_add_u32 s28, s27, 1024
    buffer_load_dwordx4 v[20:23], v2, s[12:15], s28 offen
    s_add_u32 s28, s27, 2048
    buffer_load_dwordx4 v[24:27], v2, s[12:15], s28 offen
    s_add_u32 s28, s27, 3072
    buffer_load_dwordx4 v[28:31], v2, s[12:15], s28 offen
    s_add_u32 s28, s27, 4096
    buffer_load_dwordx4 v[32:35], v2, s[12:15], s28 offen
    s_add_u32 s28, s27, 5120
    buffer_load_dwordx4 v[36:39], v2, s[12:15], s28 offen
    s_add_u32 s28, s27, 6144
    buffer_load_dwordx4 v[40:43], v2, s[12:15], s28 offen
    s_add_u32 s28, s27, 7168
    buffer_load_dwordx4 v[44:47], v2, s[12:15], s28 offen
    s_waitcnt vmcnt(8)
    v_lshlrev_b32 v8, 16, v4
    v_and_b32 v9, 0xffff0000, v4
    v_lshlrev_b32 v10, 16, v5
    v_and_b32 v11, 0xffff0000, v5
    v_lshlrev_b32 v12, 16, v6
    v_and_b32 v13, 0xffff0000, v6
    v_lshlrev_b32 v14, 16, v7
    v_and_b32 v15, 0xffff0000, v7
    s_waitcnt vmcnt(0)
    v_mov_b32 v48, 0
    v_lshlrev_b32 v56, 16, v16
    v_and_b32 v57, 0xffff0000, v16
    v_mul_f32 v56, v56, v8
    v_mul_f32 v57, v57, v9
    v_cvt_pk_bf16_f32 v58, v56, v57
    v_lshlrev_b32 v56, 16, v58
    v_and_b32 v57, 0xffff0000, v58
    v_add_f32 v48, v48, v56
    v_add_f32 v48, v48, v57
    v_lshlrev_b32 v56, 16, v17
    v_and_b32 v57, 0xffff0000, v17
    v_mul_f32 v56, v56, v10
    v_mul_f32 v57, v57, v11
    v_cvt_pk_bf16_f32 v58, v56, v57
    v_lshlrev_b32 v56, 16, v58
    v_and_b32 v57, 0xffff0000, v58
    v_add_f32 v48, v48, v56
    v_add_f32 v48, v48, v57
    v_lshlrev_b32 v56, 16, v18
    v_and_b32 v57, 0xffff0000, v18
    v_mul_f32 v56, v56, v12
    v_mul_f32 v57, v57, v13
    v_cvt_pk_bf16_f32 v58, v56, v57
    v_lshlrev_b32 v56, 16, v58
    v_and_b32 v57, 0xffff0000, v58
    v_add_f32 v48, v48, v56
    v_add_f32 v48, v48, v57
    v_lshlrev_b32 v56, 16, v19
    v_and_b32 v57, 0xffff0000, v19
    v_mul_f32 v56, v56, v14
    v_mul_f32 v57, v57, v15
    v_cvt_pk_bf16_f32 v58, v56, v57
    v_lshlrev_b32 v56, 16, v58
    v_and_b32 v57, 0xffff0000, v58
    v_add_f32 v48, v48, v56
    v_add_f32 v48, v48, v57
    v_mov_b32 v49, 0
    v_lshlrev_b32 v56, 16, v20
    v_and_b32 v57, 0xffff0000, v20
    v_mul_f32 v56, v56, v8
    v_mul_f32 v57, v57, v9
    v_cvt_pk_bf16_f32 v58, v56, v57
    v_lshlrev_b32 v56, 16, v58
    v_and_b32 v57, 0xffff0000, v58
    v_add_f32 v49, v49, v56
    v_add_f32 v49, v49, v57
    v_lshlrev_b32 v56, 16, v21
    v_and_b32 v57, 0xffff0000, v21
    v_mul_f32 v56, v56, v10
    v_mul_f32 v57, v57, v11
    v_cvt_pk_bf16_f32 v58, v56, v57
    v_lshlrev_b32 v56, 16, v58
    v_and_b32 v57, 0xffff0000, v58
    v_add_f32 v49, v49, v56
    v_add_f32 v49, v49, v57
    v_lshlrev_b32 v56, 16, v22
    v_and_b32 v57, 0xffff0000, v22
    v_mul_f32 v56, v56, v12
    v_mul_f32 v57, v57, v13
    v_cvt_pk_bf16_f32 v58, v56, v57
    v_lshlrev_b32 v56, 16, v58
    v_and_b32 v57, 0xffff0000, v58
    v_add_f32 v49, v49, v56
    v_add_f32 v49, v49, v57
    v_lshlrev_b32 v56, 16, v23
    v_and_b32 v57, 0xffff0000, v23
    v_mul_f32 v56, v56, v14
    v_mul_f32 v57, v57, v15
    v_cvt_pk_bf16_f32 v58, v56, v57
    v_lshlrev_b32 v56, 16, v58
    v_and_b32 v57, 0xffff0000, v58
    v_add_f32 v49, v49, v56
    v_add_f32 v49, v49, v57
    v_mov_b32 v50, 0
    v_lshlrev_b32 v56, 16, v24
    v_and_b32 v57, 0xffff0000, v24
    v_mul_f32 v56, v56, v8
    v_mul_f32 v57, v57, v9
    v_cvt_pk_bf16_f32 v58, v56, v57
    v_lshlrev_b32 v56, 16, v58
    v_and_b32 v57, 0xffff0000, v58
    v_add_f32 v50, v50, v56
    v_add_f32 v50, v50, v57
    v_lshlrev_b32 v56, 16, v25
    v_and_b32 v57, 0xffff0000, v25
    v_mul_f32 v56, v56, v10
    v_mul_f32 v57, v57, v11
    v_cvt_pk_bf16_f32 v58, v56, v57
    v_lshlrev_b32 v56, 16, v58
    v_and_b32 v57, 0xffff0000, v58
    v_add_f32 v50, v50, v56
    v_add_f32 v50, v50, v57
    v_lshlrev_b32 v56, 16, v26
    v_and_b32 v57, 0xffff0000, v26
    v_mul_f32 v56, v56, v12
    v_mul_f32 v57, v57, v13
    v_cvt_pk_bf16_f32 v58, v56, v57
    v_lshlrev_b32 v56, 16, v58
    v_and_b32 v57, 0xffff0000, v58
    v_add_f32 v50, v50, v56
    v_add_f32 v50, v50, v57
    v_lshlrev_b32 v56, 16, v27
    v_and_b32 v57, 0xffff0000, v27
    v_mul_f32 v56, v56, v14
    v_mul_f32 v57, v57, v15
    v_cvt_pk_bf16_f32 v58, v56, v57
    v_lshlrev_b32 v56, 16, v58
    v_and_b32 v57, 0xffff0000, v58
    v_add_f32 v50, v50, v56
    v_add_f32 v50, v50, v57
    v_mov_b32 v51, 0
    v_lshlrev_b32 v56, 16, v28
    v_and_b32 v57, 0xffff0000, v28
    v_mul_f32 v56, v56, v8
    v_mul_f32 v57, v57, v9
    v_cvt_pk_bf16_f32 v58, v56, v57
    v_lshlrev_b32 v56, 16, v58
    v_and_b32 v57, 0xffff0000, v58
    v_add_f32 v51, v51, v56
    v_add_f32 v51, v51, v57
    v_lshlrev_b32 v56, 16, v29
    v_and_b32 v57, 0xffff0000, v29
    v_mul_f32 v56, v56, v10
    v_mul_f32 v57, v57, v11
    v_cvt_pk_bf16_f32 v58, v56, v57
    v_lshlrev_b32 v56, 16, v58
    v_and_b32 v57, 0xffff0000, v58
    v_add_f32 v51, v51, v56
    v_add_f32 v51, v51, v57
    v_lshlrev_b32 v56, 16, v30
    v_and_b32 v57, 0xffff0000, v30
    v_mul_f32 v56, v56, v12
    v_mul_f32 v57, v57, v13
    v_cvt_pk_bf16_f32 v58, v56, v57
    v_lshlrev_b32 v56, 16, v58
    v_and_b32 v57, 0xffff0000, v58
    v_add_f32 v51, v51, v56
    v_add_f32 v51, v51, v57
    v_lshlrev_b32 v56, 16, v31
    v_and_b32 v57, 0xffff0000, v31
    v_mul_f32 v56, v56, v14
    v_mul_f32 v57, v57, v15
    v_cvt_pk_bf16_f32 v58, v56, v57
    v_lshlrev_b32 v56, 16, v58
    v_and_b32 v57, 0xffff0000, v58
    v_add_f32 v51, v51, v56
    v_add_f32 v51, v51, v57
    v_mov_b32 v52, 0
    v_lshlrev_b32 v56, 16, v32
    v_and_b32 v57, 0xffff0000, v32
    v_mul_f32 v56, v56, v8
    v_mul_f32 v57, v57, v9
    v_cvt_pk_bf16_f32 v58, v56, v57
    v_lshlrev_b32 v56, 16, v58
    v_and_b32 v57, 0xffff0000, v58
    v_add_f32 v52, v52, v56
    v_add_f32 v52, v52, v57
    v_lshlrev_b32 v56, 16, v33
    v_and_b32 v57, 0xffff0000, v33
    v_mul_f32 v56, v56, v10
    v_mul_f32 v57, v57, v11
    v_cvt_pk_bf16_f32 v58, v56, v57
    v_lshlrev_b32 v56, 16, v58
    v_and_b32 v57, 0xffff0000, v58
    v_add_f32 v52, v52, v56
    v_add_f32 v52, v52, v57
    v_lshlrev_b32 v56, 16, v34
    v_and_b32 v57, 0xffff0000, v34
    v_mul_f32 v56, v56, v12
    v_mul_f32 v57, v57, v13
    v_cvt_pk_bf16_f32 v58, v56, v57
    v_lshlrev_b32 v56, 16, v58
    v_and_b32 v57, 0xffff0000, v58
    v_add_f32 v52, v52, v56
    v_add_f32 v52, v52, v57
    v_lshlrev_b32 v56, 16, v35
    v_and_b32 v57, 0xffff0000, v35
    v_mul_f32 v56, v56, v14
    v_mul_f32 v57, v57, v15
    v_cvt_pk_bf16_f32 v58, v56, v57
    v_lshlrev_b32 v56, 16, v58
    v_and_b32 v57, 0xffff0000, v58
    v_add_f32 v52, v52, v56
    v_add_f32 v52, v52, v57
    v_mov_b32 v53, 0
    v_lshlrev_b32 v56, 16, v36
    v_and_b32 v57, 0xffff0000, v36
    v_mul_f32 v56, v56, v8
    v_mul_f32 v57, v57, v9
    v_cvt_pk_bf16_f32 v58, v56, v57
    v_lshlrev_b32 v56, 16, v58
    v_and_b32 v57, 0xffff0000, v58
    v_add_f32 v53, v53, v56
    v_add_f32 v53, v53, v57
    v_lshlrev_b32 v56, 16, v37
    v_and_b32 v57, 0xffff0000, v37
    v_mul_f32 v56, v56, v10
    v_mul_f32 v57, v57, v11
    v_cvt_pk_bf16_f32 v58, v56, v57
    v_lshlrev_b32 v56, 16, v58
    v_and_b32 v57, 0xffff0000, v58
    v_add_f32 v53, v53, v56
    v_add_f32 v53, v53, v57
    v_lshlrev_b32 v56, 16, v38
    v_and_b32 v57, 0xffff0000, v38
    v_mul_f32 v56, v56, v12
    v_mul_f32 v57, v57, v13
    v_cvt_pk_bf16_f32 v58, v56, v57
    v_lshlrev_b32 v56, 16, v58
    v_and_b32 v57, 0xffff0000, v58
    v_add_f32 v53, v53, v56
    v_add_f32 v53, v53, v57
    v_lshlrev_b32 v56, 16, v39
    v_and_b32 v57, 0xffff0000, v39
    v_mul_f32 v56, v56, v14
    v_mul_f32 v57, v57, v15
    v_cvt_pk_bf16_f32 v58, v56, v57
    v_lshlrev_b32 v56, 16, v58
    v_and_b32 v57, 0xffff0000, v58
    v_add_f32 v53, v53, v56
    v_add_f32 v53, v53, v57
    v_mov_b32 v54, 0
    v_lshlrev_b32 v56, 16, v40
    v_and_b32 v57, 0xffff0000, v40
    v_mul_f32 v56, v56, v8
    v_mul_f32 v57, v57, v9
    v_cvt_pk_bf16_f32 v58, v56, v57
    v_lshlrev_b32 v56, 16, v58
    v_and_b32 v57, 0xffff0000, v58
    v_add_f32 v54, v54, v56
    v_add_f32 v54, v54, v57
    v_lshlrev_b32 v56, 16, v41
    v_and_b32 v57, 0xffff0000, v41
    v_mul_f32 v56, v56, v10
    v_mul_f32 v57, v57, v11
    v_cvt_pk_bf16_f32 v58, v56, v57
    v_lshlrev_b32 v56, 16, v58
    v_and_b32 v57, 0xffff0000, v58
    v_add_f32 v54, v54, v56
    v_add_f32 v54, v54, v57
    v_lshlrev_b32 v56, 16, v42
    v_and_b32 v57, 0xffff0000, v42
    v_mul_f32 v56, v56, v12
    v_mul_f32 v57, v57, v13
    v_cvt_pk_bf16_f32 v58, v56, v57
    v_lshlrev_b32 v56, 16, v58
    v_and_b32 v57, 0xffff0000, v58
    v_add_f32 v54, v54, v56
    v_add_f32 v54, v54, v57
    v_lshlrev_b32 v56, 16, v43
    v_and_b32 v57, 0xffff0000, v43
    v_mul_f32 v56, v56, v14
    v_mul_f32 v57, v57, v15
    v_cvt_pk_bf16_f32 v58, v56, v57
    v_lshlrev_b32 v56, 16, v58
    v_and_b32 v57, 0xffff0000, v58
    v_add_f32 v54, v54, v56
    v_add_f32 v54, v54, v57
    v_mov_b32 v55, 0
    v_lshlrev_b32 v56, 16, v44
    v_and_b32 v57, 0xffff0000, v44
    v_mul_f32 v56, v56, v8
    v_mul_f32 v57, v57, v9
    v_cvt_pk_bf16_f32 v58, v56, v57
    v_lshlrev_b32 v56, 16, v58
    v_and_b32 v57, 0xffff0000, v58
    v_add_f32 v55, v55, v56
    v_add_f32 v55, v55, v57
    v_lshlrev_b32 v56, 16, v45
    v_and_b32 v57, 0xffff0000, v45
    v_mul_f32 v56, v56, v10
    v_mul_f32 v57, v57, v11
    v_cvt_pk_bf16_f32 v58, v56, v57
    v_lshlrev_b32 v56, 16, v58
    v_and_b32 v57, 0xffff0000, v58
    v_add_f32 v55, v55, v56
    v_add_f32 v55, v55, v57
    v_lshlrev_b32 v56, 16, v46
    v_and_b32 v57, 0xffff0000, v46
    v_mul_f32 v56, v56, v12
    v_mul_f32 v57, v57, v13
    v_cvt_pk_bf16_f32 v58, v56, v57
    v_lshlrev_b32 v56, 16, v58
    v_and_b32 v57, 0xffff0000, v58
    v_add_f32 v55, v55, v56
    v_add_f32 v55, v55, v57
    v_lshlrev_b32 v56, 16, v47
    v_and_b32 v57, 0xffff0000, v47
    v_mul_f32 v56, v56, v14
    v_mul_f32 v57, v57, v15
    v_cvt_pk_bf16_f32 v58, v56, v57
    v_lshlrev_b32 v56, 16, v58
    v_and_b32 v57, 0xffff0000, v58
    v_add_f32 v55, v55, v56
    v_add_f32 v55, v55, v57
    s_mov_b64 s[32:33], exec
    s_nop 1
    v_add_f32_dpp v56, v48, v48 quad_perm:[1,0,3,2] row_mask:0xf bank_mask:0xf
    s_nop 1
    v_add_f32_dpp v57, v56, v56 quad_perm:[2,3,0,1] row_mask:0xf bank_mask:0xf
    s_nop 1
    v_add_f32_dpp v56, v57, v57 row_half_mirror row_mask:0xf bank_mask:0xf
    s_nop 1
    v_add_f32_dpp v57, v56, v56 row_mirror row_mask:0xf bank_mask:0xf
    s_nop 1
    v_readlane_b32 s26, v57, 0
    v_readlane_b32 s27, v57, 16
    v_readlane_b32 s28, v57, 32
    v_readlane_b32 s29, v57, 48
    s_nop 3
    v_mov_b32 v58, s26
    v_add_f32 v58, s27, v58
    v_add_f32 v58, s28, v58
    v_add_f32 v58, s29, v58
    v_cvt_pk_bf16_f32 v59, v58, v58
    v_lshlrev_b32 v59, 16, v59
    v_mul_f32 v59, 0xbfb8aa3b, v59
    v_exp_f32 v60, v59
    s_nop 0
    v_add_f32 v60, 1.0, v60
    v_rcp_f32 v61, v60
    s_nop 0
    v_cvt_pk_bf16_f32 v62, v61, v61
    v_lshlrev_b32 v62, 16, v62
    s_lshl_b32 s30, s25, 2
    s_add_u32 s30, s30, 0
    v_mov_b32 v63, 0
    s_mov_b64 exec, 1
    buffer_store_dword v62, v63, s[20:23], s30 offen
    s_mov_b64 exec, s[32:33]
    s_nop 1
    v_add_f32_dpp v56, v49, v49 quad_perm:[1,0,3,2] row_mask:0xf bank_mask:0xf
    s_nop 1
    v_add_f32_dpp v57, v56, v56 quad_perm:[2,3,0,1] row_mask:0xf bank_mask:0xf
    s_nop 1
    v_add_f32_dpp v56, v57, v57 row_half_mirror row_mask:0xf bank_mask:0xf
    s_nop 1
    v_add_f32_dpp v57, v56, v56 row_mirror row_mask:0xf bank_mask:0xf
    s_nop 1
    v_readlane_b32 s26, v57, 0
    v_readlane_b32 s27, v57, 16
    v_readlane_b32 s28, v57, 32
    v_readlane_b32 s29, v57, 48
    s_nop 3
    v_mov_b32 v58, s26
    v_add_f32 v58, s27, v58
    v_add_f32 v58, s28, v58
    v_add_f32 v58, s29, v58
    v_cvt_pk_bf16_f32 v59, v58, v58
    v_lshlrev_b32 v59, 16, v59
    v_mul_f32 v59, 0xbfb8aa3b, v59
    v_exp_f32 v60, v59
    s_nop 0
    v_add_f32 v60, 1.0, v60
    v_rcp_f32 v61, v60
    s_nop 0
    v_cvt_pk_bf16_f32 v62, v61, v61
    v_lshlrev_b32 v62, 16, v62
    s_lshl_b32 s30, s25, 2
    s_add_u32 s30, s30, 4
    v_mov_b32 v63, 0
    s_mov_b64 exec, 1
    buffer_store_dword v62, v63, s[20:23], s30 offen
    s_mov_b64 exec, s[32:33]
    s_nop 1
    v_add_f32_dpp v56, v50, v50 quad_perm:[1,0,3,2] row_mask:0xf bank_mask:0xf
    s_nop 1
    v_add_f32_dpp v57, v56, v56 quad_perm:[2,3,0,1] row_mask:0xf bank_mask:0xf
    s_nop 1
    v_add_f32_dpp v56, v57, v57 row_half_mirror row_mask:0xf bank_mask:0xf
    s_nop 1
    v_add_f32_dpp v57, v56, v56 row_mirror row_mask:0xf bank_mask:0xf
    s_nop 1
    v_readlane_b32 s26, v57, 0
    v_readlane_b32 s27, v57, 16
    v_readlane_b32 s28, v57, 32
    v_readlane_b32 s29, v57, 48
    s_nop 3
    v_mov_b32 v58, s26
    v_add_f32 v58, s27, v58
    v_add_f32 v58, s28, v58
    v_add_f32 v58, s29, v58
    v_cvt_pk_bf16_f32 v59, v58, v58
    v_lshlrev_b32 v59, 16, v59
    v_mul_f32 v59, 0xbfb8aa3b, v59
    v_exp_f32 v60, v59
    s_nop 0
    v_add_f32 v60, 1.0, v60
    v_rcp_f32 v61, v60
    s_nop 0
    v_cvt_pk_bf16_f32 v62, v61, v61
    v_lshlrev_b32 v62, 16, v62
    s_lshl_b32 s30, s25, 2
    s_add_u32 s30, s30, 8
    v_mov_b32 v63, 0
    s_mov_b64 exec, 1
    buffer_store_dword v62, v63, s[20:23], s30 offen
    s_mov_b64 exec, s[32:33]
    s_nop 1
    v_add_f32_dpp v56, v51, v51 quad_perm:[1,0,3,2] row_mask:0xf bank_mask:0xf
    s_nop 1
    v_add_f32_dpp v57, v56, v56 quad_perm:[2,3,0,1] row_mask:0xf bank_mask:0xf
    s_nop 1
    v_add_f32_dpp v56, v57, v57 row_half_mirror row_mask:0xf bank_mask:0xf
    s_nop 1
    v_add_f32_dpp v57, v56, v56 row_mirror row_mask:0xf bank_mask:0xf
    s_nop 1
    v_readlane_b32 s26, v57, 0
    v_readlane_b32 s27, v57, 16
    v_readlane_b32 s28, v57, 32
    v_readlane_b32 s29, v57, 48
    s_nop 3
    v_mov_b32 v58, s26
    v_add_f32 v58, s27, v58
    v_add_f32 v58, s28, v58
    v_add_f32 v58, s29, v58
    v_cvt_pk_bf16_f32 v59, v58, v58
    v_lshlrev_b32 v59, 16, v59
    v_mul_f32 v59, 0xbfb8aa3b, v59
    v_exp_f32 v60, v59
    s_nop 0
    v_add_f32 v60, 1.0, v60
    v_rcp_f32 v61, v60
    s_nop 0
    v_cvt_pk_bf16_f32 v62, v61, v61
    v_lshlrev_b32 v62, 16, v62
    s_lshl_b32 s30, s25, 2
    s_add_u32 s30, s30, 12
    v_mov_b32 v63, 0
    s_mov_b64 exec, 1
    buffer_store_dword v62, v63, s[20:23], s30 offen
    s_mov_b64 exec, s[32:33]
    s_nop 1
    v_add_f32_dpp v56, v52, v52 quad_perm:[1,0,3,2] row_mask:0xf bank_mask:0xf
    s_nop 1
    v_add_f32_dpp v57, v56, v56 quad_perm:[2,3,0,1] row_mask:0xf bank_mask:0xf
    s_nop 1
    v_add_f32_dpp v56, v57, v57 row_half_mirror row_mask:0xf bank_mask:0xf
    s_nop 1
    v_add_f32_dpp v57, v56, v56 row_mirror row_mask:0xf bank_mask:0xf
    s_nop 1
    v_readlane_b32 s26, v57, 0
    v_readlane_b32 s27, v57, 16
    v_readlane_b32 s28, v57, 32
    v_readlane_b32 s29, v57, 48
    s_nop 3
    v_mov_b32 v58, s26
    v_add_f32 v58, s27, v58
    v_add_f32 v58, s28, v58
    v_add_f32 v58, s29, v58
    v_cvt_pk_bf16_f32 v59, v58, v58
    v_lshlrev_b32 v59, 16, v59
    v_mul_f32 v59, 0xbfb8aa3b, v59
    v_exp_f32 v60, v59
    s_nop 0
    v_add_f32 v60, 1.0, v60
    v_rcp_f32 v61, v60
    s_nop 0
    v_cvt_pk_bf16_f32 v62, v61, v61
    v_lshlrev_b32 v62, 16, v62
    s_lshl_b32 s30, s25, 2
    s_add_u32 s30, s30, 16
    v_mov_b32 v63, 0
    s_mov_b64 exec, 1
    buffer_store_dword v62, v63, s[20:23], s30 offen
    s_mov_b64 exec, s[32:33]
    s_nop 1
    v_add_f32_dpp v56, v53, v53 quad_perm:[1,0,3,2] row_mask:0xf bank_mask:0xf
    s_nop 1
    v_add_f32_dpp v57, v56, v56 quad_perm:[2,3,0,1] row_mask:0xf bank_mask:0xf
    s_nop 1
    v_add_f32_dpp v56, v57, v57 row_half_mirror row_mask:0xf bank_mask:0xf
    s_nop 1
    v_add_f32_dpp v57, v56, v56 row_mirror row_mask:0xf bank_mask:0xf
    s_nop 1
    v_readlane_b32 s26, v57, 0
    v_readlane_b32 s27, v57, 16
    v_readlane_b32 s28, v57, 32
    v_readlane_b32 s29, v57, 48
    s_nop 3
    v_mov_b32 v58, s26
    v_add_f32 v58, s27, v58
    v_add_f32 v58, s28, v58
    v_add_f32 v58, s29, v58
    v_cvt_pk_bf16_f32 v59, v58, v58
    v_lshlrev_b32 v59, 16, v59
    v_mul_f32 v59, 0xbfb8aa3b, v59
    v_exp_f32 v60, v59
    s_nop 0
    v_add_f32 v60, 1.0, v60
    v_rcp_f32 v61, v60
    s_nop 0
    v_cvt_pk_bf16_f32 v62, v61, v61
    v_lshlrev_b32 v62, 16, v62
    s_lshl_b32 s30, s25, 2
    s_add_u32 s30, s30, 20
    v_mov_b32 v63, 0
    s_mov_b64 exec, 1
    buffer_store_dword v62, v63, s[20:23], s30 offen
    s_mov_b64 exec, s[32:33]
    s_nop 1
    v_add_f32_dpp v56, v54, v54 quad_perm:[1,0,3,2] row_mask:0xf bank_mask:0xf
    s_nop 1
    v_add_f32_dpp v57, v56, v56 quad_perm:[2,3,0,1] row_mask:0xf bank_mask:0xf
    s_nop 1
    v_add_f32_dpp v56, v57, v57 row_half_mirror row_mask:0xf bank_mask:0xf
    s_nop 1
    v_add_f32_dpp v57, v56, v56 row_mirror row_mask:0xf bank_mask:0xf
    s_nop 1
    v_readlane_b32 s26, v57, 0
    v_readlane_b32 s27, v57, 16
    v_readlane_b32 s28, v57, 32
    v_readlane_b32 s29, v57, 48
    s_nop 3
    v_mov_b32 v58, s26
    v_add_f32 v58, s27, v58
    v_add_f32 v58, s28, v58
    v_add_f32 v58, s29, v58
    v_cvt_pk_bf16_f32 v59, v58, v58
    v_lshlrev_b32 v59, 16, v59
    v_mul_f32 v59, 0xbfb8aa3b, v59
    v_exp_f32 v60, v59
    s_nop 0
    v_add_f32 v60, 1.0, v60
    v_rcp_f32 v61, v60
    s_nop 0
    v_cvt_pk_bf16_f32 v62, v61, v61
    v_lshlrev_b32 v62, 16, v62
    s_lshl_b32 s30, s25, 2
    s_add_u32 s30, s30, 24
    v_mov_b32 v63, 0
    s_mov_b64 exec, 1
    buffer_store_dword v62, v63, s[20:23], s30 offen
    s_mov_b64 exec, s[32:33]
    s_nop 1
    v_add_f32_dpp v56, v55, v55 quad_perm:[1,0,3,2] row_mask:0xf bank_mask:0xf
    s_nop 1
    v_add_f32_dpp v57, v56, v56 quad_perm:[2,3,0,1] row_mask:0xf bank_mask:0xf
    s_nop 1
    v_add_f32_dpp v56, v57, v57 row_half_mirror row_mask:0xf bank_mask:0xf
    s_nop 1
    v_add_f32_dpp v57, v56, v56 row_mirror row_mask:0xf bank_mask:0xf
    s_nop 1
    v_readlane_b32 s26, v57, 0
    v_readlane_b32 s27, v57, 16
    v_readlane_b32 s28, v57, 32
    v_readlane_b32 s29, v57, 48
    s_nop 3
    v_mov_b32 v58, s26
    v_add_f32 v58, s27, v58
    v_add_f32 v58, s28, v58
    v_add_f32 v58, s29, v58
    v_cvt_pk_bf16_f32 v59, v58, v58
    v_lshlrev_b32 v59, 16, v59
    v_mul_f32 v59, 0xbfb8aa3b, v59
    v_exp_f32 v60, v59
    s_nop 0
    v_add_f32 v60, 1.0, v60
    v_rcp_f32 v61, v60
    s_nop 0
    v_cvt_pk_bf16_f32 v62, v61, v61
    v_lshlrev_b32 v62, 16, v62
    s_lshl_b32 s30, s25, 2
    s_add_u32 s30, s30, 28
    v_mov_b32 v63, 0
    s_mov_b64 exec, 1
    buffer_store_dword v62, v63, s[20:23], s30 offen
    s_mov_b64 exec, s[32:33]
    s_endpgm
.section .rodata,"a"
.p2align 6
.amdhsa_kernel k1_proj_kernel
  .amdhsa_next_free_vgpr 120
  .amdhsa_next_free_sgpr 62
  .amdhsa_accum_offset 120
  .amdhsa_group_segment_fixed_size 0
  .amdhsa_kernarg_size 96
  .amdhsa_user_sgpr_count 2
  .amdhsa_user_sgpr_kernarg_segment_ptr 1
  .amdhsa_system_sgpr_workgroup_id_x 1
.end_amdhsa_kernel
.text

.text
.globl k2_mix_kernel
.p2align 8
.type k2_mix_kernel,@function
k2_mix_kernel:
    s_cmp_ge_u32 s2, 512
    s_cbranch_scc1 k2_exit
    s_cmp_ge_u32 s2, 256
    s_cbranch_scc1 k2_role_F2
    s_branch k2_role_A
k2_exit:
    s_endpgm
k2_role_A:
    s_mov_b32 s3, s2
    s_load_dwordx2 s[4:5], s[0:1], 88
    v_lshrrev_b32 v116, 6, v0
    v_and_b32 v114, 63, v0
    s_nop 0
    v_readfirstlane_b32 s24, v116
    v_lshrrev_b32 v115, 5, v114
    v_lshlrev_b32 v112, 4, v114
    s_and_b32 s25, s3, 31
    s_lshr_b32 s26, s3, 5
    s_mov_b32 s30, 0x0000ffff
    s_mov_b32 s31, 0x0000ffff
    s_waitcnt lgkmcnt(0)
    s_add_u32 s6, s4, 0
    s_addc_u32 s7, s5, 0
    s_mov_b32 s8, s6
    s_mov_b32 s9, s7
    s_mov_b32 s10, 2097152
    s_mov_b32 s11, 0x00020000
    s_add_u32 s6, s4, 2097152
    s_addc_u32 s7, s5, 0
    s_mov_b32 s12, s6
    s_mov_b32 s13, s7
    s_mov_b32 s14, 2097152
    s_mov_b32 s15, 0x00020000
    s_add_u32 s6, s4, 4194304
    s_addc_u32 s7, s5, 0
    s_mov_b32 s16, s6
    s_mov_b32 s17, s7
    s_mov_b32 s18, 2097152
    s_mov_b32 s19, 0x00020000
    s_add_u32 s6, s4, 13631488
    s_addc_u32 s7, s5, 0
    s_mov_b32 s20, s6
    s_mov_b32 s21, s7
    s_mov_b32 s22, 2097152
    s_mov_b32 s23, 0x00020000
    s_lshl_b32 s27, s25, 16
    s_lshl_b32 s29, s24, 10
    s_add_u32 s28, s29, s27
    s_lshl_b32 s32, s26, 3
    s_add_u32 s32, s32, s24
    s_lshl_b32 s32, s32, 10
    s_add_u32 s32, s32, s27
    buffer_load_dwordx4 v[84:87], v112, s[8:11], s32 offen
    s_lshl_b32 s32, s24, 13
    s_add_u32 s32, s32, s27
    s_add_u32 s33, s32, 0
    buffer_load_dwordx4 v[4:7], v112, s[12:15], s33 offen
    s_add_u32 s33, s32, 1024
    buffer_load_dwordx4 v[8:11], v112, s[12:15], s33 offen
    s_add_u32 s33, s32, 2048
    buffer_load_dwordx4 v[12:15], v112, s[12:15], s33 offen
    s_add_u32 s33, s32, 3072
    buffer_load_dwordx4 v[16:19], v112, s[12:15], s33 offen
    s_add_u32 s33, s32, 4096
    buffer_load_dwordx4 v[20:23], v112, s[12:15], s33 offen
    s_add_u32 s33, s32, 5120
    buffer_load_dwordx4 v[24:27], v112, s[12:15], s33 offen
    s_add_u32 s33, s32, 6144
    buffer_load_dwordx4 v[28:31], v112, s[12:15], s33 offen
    s_add_u32 s33, s32, 7168
    buffer_load_dwordx4 v[32:35], v112, s[12:15], s33 offen
    s_add_u32 m0, s29, 0
    s_add_u32 s36, s28, 0
    buffer_load_dwordx4 v112, s[12:15], s36 offen lds
    s_add_u32 m0, s29, 8192
    s_nop 0
    buffer_load_dwordx4 v112, s[16:19], s36 offen lds
    s_add_u32 m0, s29, 16384
    s_add_u32 s36, s28, 8192
    buffer_load_dwordx4 v112, s[12:15], s36 offen lds
    s_add_u32 m0, s29, 24576
    s_nop 0
    buffer_load_dwordx4 v112, s[16:19], s36 offen lds
    s_add_u32 m0, s29, 32768
    s_add_u32 s36, s28, 16384
    buffer_load_dwordx4 v112, s[12:15], s36 offen lds
    s_add_u32 m0, s29, 40960
    s_nop 0
    buffer_load_dwordx4 v112, s[16:19], s36 offen lds
    v_and_b32 v116, 15, v114
    v_lshlrev_b32 v117, 4, v115
    v_add_u32 v116, v116, v117
    v_lshlrev_b32 v116, 4, v116
    v_add_u32 v113, 8192, v116
    v_and_b32 v116, 31, v114
    v_cmp_eq_u32 vcc, 16, v116
    v_mov_b32 v117, 0x3f803f80
    s_nop 1
    v_cndmask_b32 v118, 0, v117, vcc
    v_mov_b32 v96, v118
    v_mov_b32 v97, v118
    v_mov_b32 v98, v118
    v_mov_b32 v99, v118
    v_mov_b32 v100, v118
    v_mov_b32 v101, v118
    v_mov_b32 v102, v118
    v_mov_b32 v103, v118
    v_mov_b32 v104, v118
    v_mov_b32 v105, v118
    v_mov_b32 v106, v118
    v_mov_b32 v107, v118
    v_mov_b32 v108, v118
    v_mov_b32 v109, v118
    v_mov_b32 v110, v118
    v_mov_b32 v111, v118
    v_mov_b32 v52, 0
    v_mov_b32 v53, 0
    v_mov_b32 v54, 0
    v_mov_b32 v55, 0
    v_mov_b32 v56, 0
    v_mov_b32 v57, 0
    v_mov_b32 v58, 0
    v_mov_b32 v59, 0
    v_mov_b32 v60, 0
    v_mov_b32 v61, 0
    v_mov_b32 v62, 0
    v_mov_b32 v63, 0
    v_mov_b32 v64, 0
    v_mov_b32 v65, 0
    v_mov_b32 v66, 0
    v_mov_b32 v67, 0
    s_waitcnt vmcnt(6)
    v_mov_b32 v116, 0
    v_lshlrev_b32 v122, 16, v4
    v_and_b32 v123, 0xffff0000, v4
    v_fma_f32 v116, v122, v122, v116
    v_fma_f32 v116, v123, v123, v116
    v_lshlrev_b32 v122, 16, v5
    v_and_b32 v123, 0xffff0000, v5
    v_fma_f32 v116, v122, v122, v116
    v_fma_f32 v116, v123, v123, v116
    v_lshlrev_b32 v122, 16, v6
    v_and_b32 v123, 0xffff0000, v6
    v_fma_f32 v116, v122, v122, v116
    v_fma_f32 v116, v123, v123, v116
    v_lshlrev_b32 v122, 16, v7
    v_and_b32 v123, 0xffff0000, v7
    v_fma_f32 v116, v122, v122, v116
    v_fma_f32 v116, v123, v123, v116
    v_mov_b32 v117, v116
    s_nop 1
    v_permlane32_swap_b32 v117, v116
    s_nop 1
    v_add_f32 v116, v116, v117
    v_mov_b32 v118, v116
    v_mov_b32 v116, 0
    v_lshlrev_b32 v122, 16, v8
    v_and_b32 v123, 0xffff0000, v8
    v_fma_f32 v116, v122, v122, v116
    v_fma_f32 v116, v123, v123, v116
    v_lshlrev_b32 v122, 16, v9
    v_and_b32 v123, 0xffff0000, v9
    v_fma_f32 v116, v122, v122, v116
    v_fma_f32 v116, v123, v123, v116
    v_lshlrev_b32 v122, 16, v10
    v_and_b32 v123, 0xffff0000, v10
    v_fma_f32 v116, v122, v122, v116
    v_fma_f32 v116, v123, v123, v116
    v_lshlrev_b32 v122, 16, v11
    v_and_b32 v123, 0xffff0000, v11
    v_fma_f32 v116, v122, v122, v116
    v_fma_f32 v116, v123, v123, v116
    v_mov_b32 v117, v116
    s_nop 1
    v_permlane32_swap_b32 v117, v116
    s_nop 1
    v_add_f32 v116, v116, v117
    v_max_f32 v118, v118, v116
    v_mov_b32 v116, 0
    v_lshlrev_b32 v122, 16, v12
    v_and_b32 v123, 0xffff0000, v12
    v_fma_f32 v116, v122, v122, v116
    v_fma_f32 v116, v123, v123, v116
    v_lshlrev_b32 v122, 16, v13
    v_and_b32 v123, 0xffff0000, v13
    v_fma_f32 v116, v122, v122, v116
    v_fma_f32 v116, v123, v123, v116
    v_lshlrev_b32 v122, 16, v14
    v_and_b32 v123, 0xffff0000, v14
    v_fma_f32 v116, v122, v122, v116
    v_fma_f32 v116, v123, v123, v116
    v_lshlrev_b32 v122, 16, v15
    v_and_b32 v123, 0xffff0000, v15
    v_fma_f32 v116, v122, v122, v116
    v_fma_f32 v116, v123, v123, v116
    v_mov_b32 v117, v116
    s_nop 1
    v_permlane32_swap_b32 v117, v116
    s_nop 1
    v_add_f32 v116, v116, v117
    v_max_f32 v118, v118, v116
    v_mov_b32 v116, 0
    v_lshlrev_b32 v122, 16, v16
    v_and_b32 v123, 0xffff0000, v16
    v_fma_f32 v116, v122, v122, v116
    v_fma_f32 v116, v123, v123, v116
    v_lshlrev_b32 v122, 16, v17
    v_and_b32 v123, 0xffff0000, v17
    v_fma_f32 v116, v122, v122, v116
    v_fma_f32 v116, v123, v123, v116
    v_lshlrev_b32 v122, 16, v18
    v_and_b32 v123, 0xffff0000, v18
    v_fma_f32 v116, v122, v122, v116
    v_fma_f32 v116, v123, v123, v116
    v_lshlrev_b32 v122, 16, v19
    v_and_b32 v123, 0xffff0000, v19
    v_fma_f32 v116, v122, v122, v116
    v_fma_f32 v116, v123, v123, v116
    v_mov_b32 v117, v116
    s_nop 1
    v_permlane32_swap_b32 v117, v116
    s_nop 1
    v_add_f32 v116, v116, v117
    v_max_f32 v118, v118, v116
    v_mov_b32 v116, 0
    v_lshlrev_b32 v122, 16, v20
    v_and_b32 v123, 0xffff0000, v20
    v_fma_f32 v116, v122, v122, v116
    v_fma_f32 v116, v123, v123, v116
    v_lshlrev_b32 v122, 16, v21
    v_and_b32 v123, 0xffff0000, v21
    v_fma_f32 v116, v122, v122, v116
    v_fma_f32 v116, v123, v123, v116
    v_lshlrev_b32 v122, 16, v22
    v_and_b32 v123, 0xffff0000, v22
    v_fma_f32 v116, v122, v122, v116
    v_fma_f32 v116, v123, v123, v116
    v_lshlrev_b32 v122, 16, v23
    v_and_b32 v123, 0xffff0000, v23
    v_fma_f32 v116, v122, v122, v116
    v_fma_f32 v116, v123, v123, v116
    v_mov_b32 v117, v116
    s_nop 1
    v_permlane32_swap_b32 v117, v116
    s_nop 1
    v_add_f32 v116, v116, v117
    v_max_f32 v118, v118, v116
    v_mov_b32 v116, 0
    v_lshlrev_b32 v122, 16, v24
    v_and_b32 v123, 0xffff0000, v24
    v_fma_f32 v116, v122, v122, v116
    v_fma_f32 v116, v123, v123, v116
    v_lshlrev_b32 v122, 16, v25
    v_and_b32 v123, 0xffff0000, v25
    v_fma_f32 v116, v122, v122, v116
    v_fma_f32 v116, v123, v123, v116
    v_lshlrev_b32 v122, 16, v26
    v_and_b32 v123, 0xffff0000, v26
    v_fma_f32 v116, v122, v122, v116
    v_fma_f32 v116, v123, v123, v116
    v_lshlrev_b32 v122, 16, v27
    v_and_b32 v123, 0xffff0000, v27
    v_fma_f32 v116, v122, v122, v116
    v_fma_f32 v116, v123, v123, v116
    v_mov_b32 v117, v116
    s_nop 1
    v_permlane32_swap_b32 v117, v116
    s_nop 1
    v_add_f32 v116, v116, v117
    v_max_f32 v118, v118, v116
    v_mov_b32 v116, 0
    v_lshlrev_b32 v122, 16, v28
    v_and_b32 v123, 0xffff0000, v28
    v_fma_f32 v116, v122, v122, v116
    v_fma_f32 v116, v123, v123, v116
    v_lshlrev_b32 v122, 16, v29
    v_and_b32 v123, 0xffff0000, v29
    v_fma_f32 v116, v122, v122, v116
    v_fma_f32 v116, v123, v123, v116
    v_lshlrev_b32 v122, 16, v30
    v_and_b32 v123, 0xffff0000, v30
    v_fma_f32 v116, v122, v122, v116
    v_fma_f32 v116, v123, v123, v116
    v_lshlrev_b32 v122, 16, v31
    v_and_b32 v123, 0xffff0000, v31
    v_fma_f32 v116, v122, v122, v116
    v_fma_f32 v116, v123, v123, v116
    v_mov_b32 v117, v116
    s_nop 1
    v_permlane32_swap_b32 v117, v116
    s_nop 1
    v_add_f32 v116, v116, v117
    v_max_f32 v118, v118, v116
    v_mov_b32 v116, 0
    v_lshlrev_b32 v122, 16, v32
    v_and_b32 v123, 0xffff0000, v32
    v_fma_f32 v116, v122, v122, v116
    v_fma_f32 v116, v123, v123, v116
    v_lshlrev_b32 v122, 16, v33
    v_and_b32 v123, 0xffff0000, v33
    v_fma_f32 v116, v122, v122, v116
    v_fma_f32 v116, v123, v123, v116
    v_lshlrev_b32 v122, 16, v34
    v_and_b32 v123, 0xffff0000, v34
    v_fma_f32 v116, v122, v122, v116
    v_fma_f32 v116, v123, v123, v116
    v_lshlrev_b32 v122, 16, v35
    v_and_b32 v123, 0xffff0000, v35
    v_fma_f32 v116, v122, v122, v116
    v_fma_f32 v116, v123, v123, v116
    v_mov_b32 v117, v116
    s_nop 1
    v_permlane32_swap_b32 v117, v116
    s_nop 1
    v_add_f32 v116, v116, v117
    v_max_f32 v118, v118, v116
    v_mov_b32 v119, 0
    v_lshlrev_b32 v122, 16, v84
    v_and_b32 v123, 0xffff0000, v84
    v_fma_f32 v119, v122, v122, v119
    v_fma_f32 v119, v123, v123, v119
    v_lshlrev_b32 v122, 16, v85
    v_and_b32 v123, 0xffff0000, v85
    v_fma_f32 v119, v122, v122, v119
    v_fma_f32 v119, v123, v123, v119
    v_lshlrev_b32 v122, 16, v86
    v_and_b32 v123, 0xffff0000, v86
    v_fma_f32 v119, v122, v122, v119
    v_fma_f32 v119, v123, v123, v119
    v_lshlrev_b32 v122, 16, v87
    v_and_b32 v123, 0xffff0000, v87
    v_fma_f32 v119, v122, v122, v119
    v_fma_f32 v119, v123, v123, v119
    v_mov_b32 v117, v119
    s_nop 1
    v_permlane32_swap_b32 v117, v119
    s_nop 1
    v_add_f32 v119, v119, v117
    s_nop 1
    v_max_f32_dpp v116, v118, v118 quad_perm:[1,0,3,2] row_mask:0xf bank_mask:0xf
    s_nop 1
    v_max_f32_dpp v117, v116, v116 quad_perm:[2,3,0,1] row_mask:0xf bank_mask:0xf
    s_nop 1
    v_max_f32_dpp v116, v117, v117 row_half_mirror row_mask:0xf bank_mask:0xf
    s_nop 1
    v_max_f32_dpp v117, v116, v116 row_mirror row_mask:0xf bank_mask:0xf
    s_nop 1
    v_readlane_b32 s32, v117, 0
    v_readlane_b32 s33, v117, 16
    v_readlane_b32 s34, v117, 32
    v_readlane_b32 s35, v117, 48
    s_nop 3
    s_max_u32 s32, s32, s33
    s_max_u32 s34, s34, s35
    s_max_u32 s32, s32, s34
    v_mov_b32 v116, s32
    s_lshl_b32 s33, s24, 2
    s_add_u32 s33, s33, 65536
    v_mov_b32 v117, s33
    ds_write_b32 v117, v116
    s_waitcnt vmcnt(4) lgkmcnt(0)
    s_barrier
    v_mov_b32 v117, 65536
    ds_read_b128 v[4:7], v117
    ds_read_b128 v[8:11], v117 offset:16
    ds_read_b128 v[88:91], v112
    ds_read_b128 v[92:95], v112 offset:1024
    s_mov_b64 exec, s[30:31]
    ds_read_b128 v[96:99], v113
    ds_read_b128 v[100:103], v113 offset:512
    s_mov_b64 exec, -1
    s_waitcnt lgkmcnt(4)
    v_max_f32 v118, v4, v5
    v_max_f32 v118, v118, v6
    v_max_f32 v118, v118, v7
    v_max_f32 v118, v118, v8
    v_max_f32 v118, v118, v9
    v_max_f32 v118, v118, v10
    v_max_f32 v118, v118, v11
    v_mul_f32 v118, v118, v119
    v_sqrt_f32 v118, v118
    s_nop 0
    v_mul_f32 v118, 0x3f808000, v118
    v_add_f32 v118, 0x35800000, v118
    v_sub_f32 v36, 0, v118
    v_sub_f32 v37, 0, v118
    v_sub_f32 v38, 0, v118
    v_sub_f32 v39, 0, v118
    v_sub_f32 v40, 0, v118
    v_sub_f32 v41, 0, v118
    v_sub_f32 v42, 0, v118
    v_sub_f32 v43, 0, v118
    v_sub_f32 v44, 0, v118
    v_sub_f32 v45, 0, v118
    v_sub_f32 v46, 0, v118
    v_sub_f32 v47, 0, v118
    v_sub_f32 v48, 0, v118
    v_sub_f32 v49, 0, v118
    v_sub_f32 v50, 0, v118
    v_sub_f32 v51, 0, v118
    s_waitcnt lgkmcnt(2)
    s_nop 1
    v_mfma_f32_32x32x16_bf16 v[4:19], v[88:91], v[84:87], v[36:51]
    s_nop 11
    s_waitcnt lgkmcnt(0)
    v_mfma_f32_32x32x16_bf16 v[20:35], v[92:95], v[84:87], v[36:51]
    ds_read_b128 v[88:91], v112 offset:2048
    v_exp_f32 v4, v4
    v_exp_f32 v5, v5
    v_exp_f32 v6, v6
    v_exp_f32 v7, v7
    v_exp_f32 v8, v8
    v_exp_f32 v9, v9
    v_exp_f32 v10, v10
    v_exp_f32 v11, v11
    v_exp_f32 v12, v12
    v_exp_f32 v13, v13
    v_exp_f32 v14, v14
    v_exp_f32 v15, v15
    v_exp_f32 v16, v16
    v_exp_f32 v17, v17
    v_exp_f32 v18, v18
    v_exp_f32 v19, v19
    v_cvt_pk_bf16_f32 v68, v4, v5
    v_cvt_pk_bf16_f32 v69, v6, v7
    v_cvt_pk_bf16_f32 v70, v8, v9
    v_cvt_pk_bf16_f32 v71, v10, v11
    v_cvt_pk_bf16_f32 v72, v12, v13
    v_cvt_pk_bf16_f32 v73, v14, v15
    v_cvt_pk_bf16_f32 v74, v16, v17
    v_cvt_pk_bf16_f32 v75, v18, v19
    s_waitcnt lgkmcnt(0)
    v_mfma_f32_32x32x16_bf16 v[4:19], v[88:91], v[84:87], v[36:51]
    ds_read_b128 v[92:95], v112 offset:3072
    s_mov_b64 exec, s[30:31]
    ds_read_b128 v[104:107], v113 offset:1024
    ds_read_b128 v[108:111], v113 offset:1536
    s_mov_b64 exec, -1
    v_exp_f32 v20, v20
    v_exp_f32 v21, v21
    v_exp_f32 v22, v22
    v_exp_f32 v23, v23
    v_exp_f32 v24, v24
    v_mfma_f32_32x32x16_bf16 v[52:67], v[96:99], v[68:71], v[52:67]
    v_exp_f32 v25, v25
    v_exp_f32 v26, v26
    v_exp_f32 v27, v27
    v_exp_f32 v28, v28
    v_exp_f32 v29, v29
    v_exp_f32 v30, v30
    v_mfma_f32_32x32x16_bf16 v[52:67], v[100:103], v[72:75], v[52:67]
    v_exp_f32 v31, v31
    v_exp_f32 v32, v32
    v_exp_f32 v33, v33
    v_exp_f32 v34, v34
    v_exp_f32 v35, v35
    v_cvt_pk_bf16_f32 v76, v20, v21
    v_cvt_pk_bf16_f32 v77, v22, v23
    v_cvt_pk_bf16_f32 v78, v24, v25
    v_cvt_pk_bf16_f32 v79, v26, v27
    v_cvt_pk_bf16_f32 v80, v28, v29
    v_cvt_pk_bf16_f32 v81, v30, v31
    v_cvt_pk_bf16_f32 v82, v32, v33
    v_cvt_pk_bf16_f32 v83, v34, v35
    s_waitcnt lgkmcnt(0)
    v_mfma_f32_32x32x16_bf16 v[20:35], v[92:95], v[84:87], v[36:51]
    ds_read_b128 v[88:91], v112 offset:4096
    s_mov_b64 exec, s[30:31]
    ds_read_b128 v[96:99], v113 offset:2048
    ds_read_b128 v[100:103], v113 offset:2560
    s_mov_b64 exec, -1
    v_exp_f32 v4, v4
    v_exp_f32 v5, v5
    v_exp_f32 v6, v6
    v_exp_f32 v7, v7
    v_exp_f32 v8, v8
    v_mfma_f32_32x32x16_bf16 v[52:67], v[104:107], v[76:79], v[52:67]
    v_exp_f32 v9, v9
    v_exp_f32 v10, v10
    v_exp_f32 v11, v11
    v_exp_f32 v12, v12
    v_exp_f32 v13, v13
    v_exp_f32 v14, v14
    v_mfma_f32_32x32x16_bf16 v[52:67], v[108:111], v[80:83], v[52:67]
    v_exp_f32 v15, v15
    v_exp_f32 v16, v16
    v_exp_f32 v17, v17
    v_exp_f32 v18, v18
    v_exp_f32 v19, v19
    v_cvt_pk_bf16_f32 v68, v4, v5
    v_cvt_pk_bf16_f32 v69, v6, v7
    v_cvt_pk_bf16_f32 v70, v8, v9
    v_cvt_pk_bf16_f32 v71, v10, v11
    v_cvt_pk_bf16_f32 v72, v12, v13
    v_cvt_pk_bf16_f32 v73, v14, v15
    v_cvt_pk_bf16_f32 v74, v16, v17
    v_cvt_pk_bf16_f32 v75, v18, v19
    s_waitcnt lgkmcnt(0)
    v_mfma_f32_32x32x16_bf16 v[4:19], v[88:91], v[84:87], v[36:51]
    ds_read_b128 v[92:95], v112 offset:5120
    s_mov_b64 exec, s[30:31]
    ds_read_b128 v[104:107], v113 offset:3072
    ds_read_b128 v[108:111], v113 offset:3584
    s_mov_b64 exec, -1
    v_exp_f32 v20, v20
    v_exp_f32 v21, v21
    v_exp_f32 v22, v22
    v_exp_f32 v23, v23
    v_exp_f32 v24, v24
    v_mfma_f32_32x32x16_bf16 v[52:67], v[96:99], v[68:71], v[52:67]
    v_exp_f32 v25, v25
    v_exp_f32 v26, v26
    v_exp_f32 v27, v27
    v_exp_f32 v28, v28
    v_exp_f32 v29, v29
    v_exp_f32 v30, v30
    v_mfma_f32_32x32x16_bf16 v[52:67], v[100:103], v[72:75], v[52:67]
    v_exp_f32 v31, v31
    v_exp_f32 v32, v32
    v_exp_f32 v33, v33
    v_exp_f32 v34, v34
    v_exp_f32 v35, v35
    v_cvt_pk_bf16_f32 v76, v20, v21
    v_cvt_pk_bf16_f32 v77, v22, v23
    v_cvt_pk_bf16_f32 v78, v24, v25
    v_cvt_pk_bf16_f32 v79, v26, v27
    v_cvt_pk_bf16_f32 v80, v28, v29
    v_cvt_pk_bf16_f32 v81, v30, v31
    v_cvt_pk_bf16_f32 v82, v32, v33
    v_cvt_pk_bf16_f32 v83, v34, v35
    s_waitcnt lgkmcnt(0)
    v_mfma_f32_32x32x16_bf16 v[20:35], v[92:95], v[84:87], v[36:51]
    ds_read_b128 v[88:91], v112 offset:6144
    s_mov_b64 exec, s[30:31]
    ds_read_b128 v[96:99], v113 offset:4096
    ds_read_b128 v[100:103], v113 offset:4608
    s_mov_b64 exec, -1
    v_exp_f32 v4, v4
    v_exp_f32 v5, v5
    v_exp_f32 v6, v6
    v_exp_f32 v7, v7
    v_exp_f32 v8, v8
    v_mfma_f32_32x32x16_bf16 v[52:67], v[104:107], v[76:79], v[52:67]
    v_exp_f32 v9, v9
    v_exp_f32 v10, v10
    v_exp_f32 v11, v11
    v_exp_f32 v12, v12
    v_exp_f32 v13, v13
    v_exp_f32 v14, v14
    v_mfma_f32_32x32x16_bf16 v[52:67], v[108:111], v[80:83], v[52:67]
    v_exp_f32 v15, v15
    v_exp_f32 v16, v16
    v_exp_f32 v17, v17
    v_exp_f32 v18, v18
    v_exp_f32 v19, v19
    v_cvt_pk_bf16_f32 v68, v4, v5
    v_cvt_pk_bf16_f32 v69, v6, v7
    v_cvt_pk_bf16_f32 v70, v8, v9
    v_cvt_pk_bf16_f32 v71, v10, v11
    v_cvt_pk_bf16_f32 v72, v12, v13
    v_cvt_pk_bf16_f32 v73, v14, v15
    v_cvt_pk_bf16_f32 v74, v16, v17
    v_cvt_pk_bf16_f32 v75, v18, v19
    s_waitcnt lgkmcnt(0)
    v_mfma_f32_32x32x16_bf16 v[4:19], v[88:91], v[84:87], v[36:51]
    ds_read_b128 v[92:95], v112 offset:7168
    s_mov_b64 exec, s[30:31]
    ds_read_b128 v[104:107], v113 offset:5120
    ds_read_b128 v[108:111], v113 offset:5632
    s_mov_b64 exec, -1
    v_exp_f32 v20, v20
    v_exp_f32 v21, v21
    v_exp_f32 v22, v22
    v_exp_f32 v23, v23
    v_exp_f32 v24, v24
    v_mfma_f32_32x32x16_bf16 v[52:67], v[96:99], v[68:71], v[52:67]
    v_exp_f32 v25, v25
    v_exp_f32 v26, v26
    v_exp_f32 v27, v27
    v_exp_f32 v28, v28
    v_exp_f32 v29, v29
    v_exp_f32 v30, v30
    v_mfma_f32_32x32x16_bf16 v[52:67], v[100:103], v[72:75], v[52:67]
    v_exp_f32 v31, v31
    v_exp_f32 v32, v32
    v_exp_f32 v33, v33
    v_exp_f32 v34, v34
    v_exp_f32 v35, v35
    v_cvt_pk_bf16_f32 v76, v20, v21
    v_cvt_pk_bf16_f32 v77, v22, v23
    v_cvt_pk_bf16_f32 v78, v24, v25
    v_cvt_pk_bf16_f32 v79, v26, v27
    v_cvt_pk_bf16_f32 v80, v28, v29
    v_cvt_pk_bf16_f32 v81, v30, v31
    v_cvt_pk_bf16_f32 v82, v32, v33
    v_cvt_pk_bf16_f32 v83, v34, v35
    s_waitcnt vmcnt(2)
    s_barrier
    s_add_u32 m0, s29, 49152
    s_add_u32 s36, s28, 24576
    buffer_load_dwordx4 v112, s[12:15], s36 offen lds
    s_add_u32 m0, s29, 57344
    s_nop 0
    buffer_load_dwordx4 v112, s[16:19], s36 offen lds
    s_waitcnt lgkmcnt(0)
    v_mfma_f32_32x32x16_bf16 v[20:35], v[92:95], v[84:87], v[36:51]
    ds_read_b128 v[88:91], v112 offset:16384
    s_mov_b64 exec, s[30:31]
    ds_read_b128 v[96:99], v113 offset:6144
    ds_read_b128 v[100:103], v113 offset:6656
    s_mov_b64 exec, -1
    v_exp_f32 v4, v4
    v_exp_f32 v5, v5
    v_exp_f32 v6, v6
    v_exp_f32 v7, v7
    v_exp_f32 v8, v8
    v_mfma_f32_32x32x16_bf16 v[52:67], v[104:107], v[76:79], v[52:67]
    v_exp_f32 v9, v9
    v_exp_f32 v10, v10
    v_exp_f32 v11, v11
    v_exp_f32 v12, v12
    v_exp_f32 v13, v13
    v_exp_f32 v14, v14
    v_mfma_f32_32x32x16_bf16 v[52:67], v[108:111], v[80:83], v[52:67]
    v_exp_f32 v15, v15
    v_exp_f32 v16, v16
    v_exp_f32 v17, v17
    v_exp_f32 v18, v18
    v_exp_f32 v19, v19
    v_cvt_pk_bf16_f32 v68, v4, v5
    v_cvt_pk_bf16_f32 v69, v6, v7
    v_cvt_pk_bf16_f32 v70, v8, v9
    v_cvt_pk_bf16_f32 v71, v10, v11
    v_cvt_pk_bf16_f32 v72, v12, v13
    v_cvt_pk_bf16_f32 v73, v14, v15
    v_cvt_pk_bf16_f32 v74, v16, v17
    v_cvt_pk_bf16_f32 v75, v18, v19
    s_waitcnt lgkmcnt(0)
    v_mfma_f32_32x32x16_bf16 v[4:19], v[88:91], v[84:87], v[36:51]
    ds_read_b128 v[92:95], v112 offset:17408
    s_mov_b64 exec, s[30:31]
    ds_read_b128 v[104:107], v113 offset:7168
    ds_read_b128 v[108:111], v113 offset:7680
    s_mov_b64 exec, -1
    v_exp_f32 v20, v20
    v_exp_f32 v21, v21
    v_exp_f32 v22, v22
    v_exp_f32 v23, v23
    v_exp_f32 v24, v24
    v_mfma_f32_32x32x16_bf16 v[52:67], v[96:99], v[68:71], v[52:67]
    v_exp_f32 v25, v25
    v_exp_f32 v26, v26
    v_exp_f32 v27, v27
    v_exp_f32 v28, v28
    v_exp_f32 v29, v29
    v_exp_f32 v30, v30
    v_mfma_f32_32x32x16_bf16 v[52:67], v[100:103], v[72:75], v[52:67]
    v_exp_f32 v31, v31
    v_exp_f32 v32, v32
    v_exp_f32 v33, v33
    v_exp_f32 v34, v34
    v_exp_f32 v35, v35
    v_cvt_pk_bf16_f32 v76, v20, v21
    v_cvt_pk_bf16_f32 v77, v22, v23
    v_cvt_pk_bf16_f32 v78, v24, v25
    v_cvt_pk_bf16_f32 v79, v26, v27
    v_cvt_pk_bf16_f32 v80, v28, v29
    v_cvt_pk_bf16_f32 v81, v30, v31
    v_cvt_pk_bf16_f32 v82, v32, v33
    v_cvt_pk_bf16_f32 v83, v34, v35
    s_waitcnt lgkmcnt(0)
    v_mfma_f32_32x32x16_bf16 v[20:35], v[92:95], v[84:87], v[36:51]
    ds_read_b128 v[88:91], v112 offset:18432
    s_mov_b64 exec, s[30:31]
    ds_read_b128 v[96:99], v113 offset:16384
    ds_read_b128 v[100:103], v113 offset:16896
    s_mov_b64 exec, -1
    v_exp_f32 v4, v4
    v_exp_f32 v5, v5
    v_exp_f32 v6, v6
    v_exp_f32 v7, v7
    v_exp_f32 v8, v8
    v_mfma_f32_32x32x16_bf16 v[52:67], v[104:107], v[76:79], v[52:67]
    v_exp_f32 v9, v9
    v_exp_f32 v10, v10
    v_exp_f32 v11, v11
    v_exp_f32 v12, v12
    v_exp_f32 v13, v13
    v_exp_f32 v14, v14
    v_mfma_f32_32x32x16_bf16 v[52:67], v[108:111], v[80:83], v[52:67]
    v_exp_f32 v15, v15
    v_exp_f32 v16, v16
    v_exp_f32 v17, v17
    v_exp_f32 v18, v18
    v_exp_f32 v19, v19
    v_cvt_pk_bf16_f32 v68, v4, v5
    v_cvt_pk_bf16_f32 v69, v6, v7
    v_cvt_pk_bf16_f32 v70, v8, v9
    v_cvt_pk_bf16_f32 v71, v10, v11
    v_cvt_pk_bf16_f32 v72, v12, v13
    v_cvt_pk_bf16_f32 v73, v14, v15
    v_cvt_pk_bf16_f32 v74, v16, v17
    v_cvt_pk_bf16_f32 v75, v18, v19
    s_waitcnt lgkmcnt(0)
    v_mfma_f32_32x32x16_bf16 v[4:19], v[88:91], v[84:87], v[36:51]
    ds_read_b128 v[92:95], v112 offset:19456
    s_mov_b64 exec, s[30:31]
    ds_read_b128 v[104:107], v113 offset:17408
    ds_read_b128 v[108:111], v113 offset:17920
    s_mov_b64 exec, -1
    v_exp_f32 v20, v20
    v_exp_f32 v21, v21
    v_exp_f32 v22, v22
    v_exp_f32 v23, v23
    v_exp_f32 v24, v24
    v_mfma_f32_32x32x16_bf16 v[52:67], v[96:99], v[68:71], v[52:67]
    v_exp_f32 v25, v25
    v_exp_f32 v26, v26
    v_exp_f32 v27, v27
    v_exp_f32 v28, v28
    v_exp_f32 v29, v29
    v_exp_f32 v30, v30
    v_mfma_f32_32x32x16_bf16 v[52:67], v[100:103], v[72:75], v[52:67]
    v_exp_f32 v31, v31
    v_exp_f32 v32, v32
    v_exp_f32 v33, v33
    v_exp_f32 v34, v34
    v_exp_f32 v35, v35
    v_cvt_pk_bf16_f32 v76, v20, v21
    v_cvt_pk_bf16_f32 v77, v22, v23
    v_cvt_pk_bf16_f32 v78, v24, v25
    v_cvt_pk_bf16_f32 v79, v26, v27
    v_cvt_pk_bf16_f32 v80, v28, v29
    v_cvt_pk_bf16_f32 v81, v30, v31
    v_cvt_pk_bf16_f32 v82, v32, v33
    v_cvt_pk_bf16_f32 v83, v34, v35
    s_waitcnt lgkmcnt(0)
    v_mfma_f32_32x32x16_bf16 v[20:35], v[92:95], v[84:87], v[36:51]
    ds_read_b128 v[88:91], v112 offset:20480
    s_mov_b64 exec, s[30:31]
    ds_read_b128 v[96:99], v113 offset:18432
    ds_read_b128 v[100:103], v113 offset:18944
    s_mov_b64 exec, -1
    v_exp_f32 v4, v4
    v_exp_f32 v5, v5
    v_exp_f32 v6, v6
    v_exp_f32 v7, v7
    v_exp_f32 v8, v8
    v_mfma_f32_32x32x16_bf16 v[52:67], v[104:107], v[76:79], v[52:67]
    v_exp_f32 v9, v9
    v_exp_f32 v10, v10
    v_exp_f32 v11, v11
    v_exp_f32 v12, v12
    v_exp_f32 v13, v13
    v_exp_f32 v14, v14
    v_mfma_f32_32x32x16_bf16 v[52:67], v[108:111], v[80:83], v[52:67]
    v_exp_f32 v15, v15
    v_exp_f32 v16, v16
    v_exp_f32 v17, v17
    v_exp_f32 v18, v18
    v_exp_f32 v19, v19
    v_cvt_pk_bf16_f32 v68, v4, v5
    v_cvt_pk_bf16_f32 v69, v6, v7
    v_cvt_pk_bf16_f32 v70, v8, v9
    v_cvt_pk_bf16_f32 v71, v10, v11
    v_cvt_pk_bf16_f32 v72, v12, v13
    v_cvt_pk_bf16_f32 v73, v14, v15
    v_cvt_pk_bf16_f32 v74, v16, v17
    v_cvt_pk_bf16_f32 v75, v18, v19
    s_waitcnt lgkmcnt(0)
    v_mfma_f32_32x32x16_bf16 v[4:19], v[88:91], v[84:87], v[36:51]
    ds_read_b128 v[92:95], v112 offset:21504
    s_mov_b64 exec, s[30:31]
    ds_read_b128 v[104:107], v113 offset:19456
    ds_read_b128 v[108:111], v113 offset:19968
    s_mov_b64 exec, -1
    v_exp_f32 v20, v20
    v_exp_f32 v21, v21
    v_exp_f32 v22, v22
    v_exp_f32 v23, v23
    v_exp_f32 v24, v24
    v_mfma_f32_32x32x16_bf16 v[52:67], v[96:99], v[68:71], v[52:67]
    v_exp_f32 v25, v25
    v_exp_f32 v26, v26
    v_exp_f32 v27, v27
    v_exp_f32 v28, v28
    v_exp_f32 v29, v29
    v_exp_f32 v30, v30
    v_mfma_f32_32x32x16_bf16 v[52:67], v[100:103], v[72:75], v[52:67]
    v_exp_f32 v31, v31
    v_exp_f32 v32, v32
    v_exp_f32 v33, v33
    v_exp_f32 v34, v34
    v_exp_f32 v35, v35
    v_cvt_pk_bf16_f32 v76, v20, v21
    v_cvt_pk_bf16_f32 v77, v22, v23
    v_cvt_pk_bf16_f32 v78, v24, v25
    v_cvt_pk_bf16_f32 v79, v26, v27
    v_cvt_pk_bf16_f32 v80, v28, v29
    v_cvt_pk_bf16_f32 v81, v30, v31
    v_cvt_pk_bf16_f32 v82, v32, v33
    v_cvt_pk_bf16_f32 v83, v34, v35
    s_waitcnt lgkmcnt(0)
    v_mfma_f32_32x32x16_bf16 v[20:35], v[92:95], v[84:87], v[36:51]
    ds_read_b128 v[88:91], v112 offset:22528
    s_mov_b64 exec, s[30:31]
    ds_read_b128 v[96:99], v113 offset:20480
    ds_read_b128 v[100:103], v113 offset:20992
    s_mov_b64 exec, -1
    v_exp_f32 v4, v4
    v_exp_f32 v5, v5
    v_exp_f32 v6, v6
    v_exp_f32 v7, v7
    v_exp_f32 v8, v8
    v_mfma_f32_32x32x16_bf16 v[52:67], v[104:107], v[76:79], v[52:67]
    v_exp_f32 v9, v9
    v_exp_f32 v10, v10
    v_exp_f32 v11, v11
    v_exp_f32 v12, v12
    v_exp_f32 v13, v13
    v_exp_f32 v14, v14
    v_mfma_f32_32x32x16_bf16 v[52:67], v[108:111], v[80:83], v[52:67]
    v_exp_f32 v15, v15
    v_exp_f32 v16, v16
    v_exp_f32 v17, v17
    v_exp_f32 v18, v18
    v_exp_f32 v19, v19
    v_cvt_pk_bf16_f32 v68, v4, v5
    v_cvt_pk_bf16_f32 v69, v6, v7
    v_cvt_pk_bf16_f32 v70, v8, v9
    v_cvt_pk_bf16_f32 v71, v10, v11
    v_cvt_pk_bf16_f32 v72, v12, v13
    v_cvt_pk_bf16_f32 v73, v14, v15
    v_cvt_pk_bf16_f32 v74, v16, v17
    v_cvt_pk_bf16_f32 v75, v18, v19
    s_waitcnt lgkmcnt(0)
    v_mfma_f32_32x32x16_bf16 v[4:19], v[88:91], v[84:87], v[36:51]
    ds_read_b128 v[92:95], v112 offset:23552
    s_mov_b64 exec, s[30:31]
    ds_read_b128 v[104:107], v113 offset:21504
    ds_read_b128 v[108:111], v113 offset:22016
    s_mov_b64 exec, -1
    v_exp_f32 v20, v20
    v_exp_f32 v21, v21
    v_exp_f32 v22, v22
    v_exp_f32 v23, v23
    v_exp_f32 v24, v24
    v_mfma_f32_32x32x16_bf16 v[52:67], v[96:99], v[68:71], v[52:67]
    v_exp_f32 v25, v25
    v_exp_f32 v26, v26
    v_exp_f32 v27, v27
    v_exp_f32 v28, v28
    v_exp_f32 v29, v29
    v_exp_f32 v30, v30
    v_mfma_f32_32x32x16_bf16 v[52:67], v[100:103], v[72:75], v[52:67]
    v_exp_f32 v31, v31
    v_exp_f32 v32, v32
    v_exp_f32 v33, v33
    v_exp_f32 v34, v34
    v_exp_f32 v35, v35
    v_cvt_pk_bf16_f32 v76, v20, v21
    v_cvt_pk_bf16_f32 v77, v22, v23
    v_cvt_pk_bf16_f32 v78, v24, v25
    v_cvt_pk_bf16_f32 v79, v26, v27
    v_cvt_pk_bf16_f32 v80, v28, v29
    v_cvt_pk_bf16_f32 v81, v30, v31
    v_cvt_pk_bf16_f32 v82, v32, v33
    v_cvt_pk_bf16_f32 v83, v34, v35
    s_waitcnt vmcnt(2)
    s_barrier
    s_add_u32 m0, s29, 0
    s_add_u32 s36, s28, 32768
    buffer_load_dwordx4 v112, s[12:15], s36 offen lds
    s_add_u32 m0, s29, 8192
    s_nop 0
    buffer_load_dwordx4 v112, s[16:19], s36 offen lds
    s_waitcnt lgkmcnt(0)
    v_mfma_f32_32x32x16_bf16 v[20:35], v[92:95], v[84:87], v[36:51]
    ds_read_b128 v[88:91], v112 offset:32768
    s_mov_b64 exec, s[30:31]
    ds_read_b128 v[96:99], v113 offset:22528
    ds_read_b128 v[100:103], v113 offset:23040
    s_mov_b64 exec, -1
    v_exp_f32 v4, v4
    v_exp_f32 v5, v5
    v_exp_f32 v6, v6
    v_exp_f32 v7, v7
    v_exp_f32 v8, v8
    v_mfma_f32_32x32x16_bf16 v[52:67], v[104:107], v[76:79], v[52:67]
    v_exp_f32 v9, v9
    v_exp_f32 v10, v10
    v_exp_f32 v11, v11
    v_exp_f32 v12, v12
    v_exp_f32 v13, v13
    v_exp_f32 v14, v14
    v_mfma_f32_32x32x16_bf16 v[52:67], v[108:111], v[80:83], v[52:67]
    v_exp_f32 v15, v15
    v_exp_f32 v16, v16
    v_exp_f32 v17, v17
    v_exp_f32 v18, v18
    v_exp_f32 v19, v19
    v_cvt_pk_bf16_f32 v68, v4, v5
    v_cvt_pk_bf16_f32 v69, v6, v7
    v_cvt_pk_bf16_f32 v70, v8, v9
    v_cvt_pk_bf16_f32 v71, v10, v11
    v_cvt_pk_bf16_f32 v72, v12, v13
    v_cvt_pk_bf16_f32 v73, v14, v15
    v_cvt_pk_bf16_f32 v74, v16, v17
    v_cvt_pk_bf16_f32 v75, v18, v19
    s_waitcnt lgkmcnt(0)
    v_mfma_f32_32x32x16_bf16 v[4:19], v[88:91], v[84:87], v[36:51]
    ds_read_b128 v[92:95], v112 offset:33792
    s_mov_b64 exec, s[30:31]
    ds_read_b128 v[104:107], v113 offset:23552
    ds_read_b128 v[108:111], v113 offset:24064
    s_mov_b64 exec, -1
    v_exp_f32 v20, v20
    v_exp_f32 v21, v21
    v_exp_f32 v22, v22
    v_exp_f32 v23, v23
    v_exp_f32 v24, v24
    v_mfma_f32_32x32x16_bf16 v[52:67], v[96:99], v[68:71], v[52:67]
    v_exp_f32 v25, v25
    v_exp_f32 v26, v26
    v_exp_f32 v27, v27
    v_exp_f32 v28, v28
    v_exp_f32 v29, v29
    v_exp_f32 v30, v30
    v_mfma_f32_32x32x16_bf16 v[52:67], v[100:103], v[72:75], v[52:67]
    v_exp_f32 v31, v31
    v_exp_f32 v32, v32
    v_exp_f32 v33, v33
    v_exp_f32 v34, v34
    v_exp_f32 v35, v35
    v_cvt_pk_bf16_f32 v76, v20, v21
    v_cvt_pk_bf16_f32 v77, v22, v23
    v_cvt_pk_bf16_f32 v78, v24, v25
    v_cvt_pk_bf16_f32 v79, v26, v27
    v_cvt_pk_bf16_f32 v80, v28, v29
    v_cvt_pk_bf16_f32 v81, v30, v31
    v_cvt_pk_bf16_f32 v82, v32, v33
    v_cvt_pk_bf16_f32 v83, v34, v35
    s_waitcnt lgkmcnt(0)
    v_mfma_f32_32x32x16_bf16 v[20:35], v[92:95], v[84:87], v[36:51]
    ds_read_b128 v[88:91], v112 offset:34816
    s_mov_b64 exec, s[30:31]
    ds_read_b128 v[96:99], v113 offset:32768
    ds_read_b128 v[100:103], v113 offset:33280
    s_mov_b64 exec, -1
    v_exp_f32 v4, v4
    v_exp_f32 v5, v5
    v_exp_f32 v6, v6
    v_exp_f32 v7, v7
    v_exp_f32 v8, v8
    v_mfma_f32_32x32x16_bf16 v[52:67], v[104:107], v[76:79], v[52:67]
    v_exp_f32 v9, v9
    v_exp_f32 v10, v10
    v_exp_f32 v11, v11
    v_exp_f32 v12, v12
    v_exp_f32 v13, v13
    v_exp_f32 v14, v14
    v_mfma_f32_32x32x16_bf16 v[52:67], v[108:111], v[80:83], v[52:67]
    v_exp_f32 v15, v15
    v_exp_f32 v16, v16
    v_exp_f32 v17, v17
    v_exp_f32 v18, v18
    v_exp_f32 v19, v19
    v_cvt_pk_bf16_f32 v68, v4, v5
    v_cvt_pk_bf16_f32 v69, v6, v7
    v_cvt_pk_bf16_f32 v70, v8, v9
    v_cvt_pk_bf16_f32 v71, v10, v11
    v_cvt_pk_bf16_f32 v72, v12, v13
    v_cvt_pk_bf16_f32 v73, v14, v15
    v_cvt_pk_bf16_f32 v74, v16, v17
    v_cvt_pk_bf16_f32 v75, v18, v19
    s_waitcnt lgkmcnt(0)
    v_mfma_f32_32x32x16_bf16 v[4:19], v[88:91], v[84:87], v[36:51]
    ds_read_b128 v[92:95], v112 offset:35840
    s_mov_b64 exec, s[30:31]
    ds_read_b128 v[104:107], v113 offset:33792
    ds_read_b128 v[108:111], v113 offset:34304
    s_mov_b64 exec, -1
    v_exp_f32 v20, v20
    v_exp_f32 v21, v21
    v_exp_f32 v22, v22
    v_exp_f32 v23, v23
    v_exp_f32 v24, v24
    v_mfma_f32_32x32x16_bf16 v[52:67], v[96:99], v[68:71], v[52:67]
    v_exp_f32 v25, v25
    v_exp_f32 v26, v26
    v_exp_f32 v27, v27
    v_exp_f32 v28, v28
    v_exp_f32 v29, v29
    v_exp_f32 v30, v30
    v_mfma_f32_32x32x16_bf16 v[52:67], v[100:103], v[72:75], v[52:67]
    v_exp_f32 v31, v31
    v_exp_f32 v32, v32
    v_exp_f32 v33, v33
    v_exp_f32 v34, v34
    v_exp_f32 v35, v35
    v_cvt_pk_bf16_f32 v76, v20, v21
    v_cvt_pk_bf16_f32 v77, v22, v23
    v_cvt_pk_bf16_f32 v78, v24, v25
    v_cvt_pk_bf16_f32 v79, v26, v27
    v_cvt_pk_bf16_f32 v80, v28, v29
    v_cvt_pk_bf16_f32 v81, v30, v31
    v_cvt_pk_bf16_f32 v82, v32, v33
    v_cvt_pk_bf16_f32 v83, v34, v35
    s_waitcnt lgkmcnt(0)
    v_mfma_f32_32x32x16_bf16 v[20:35], v[92:95], v[84:87], v[36:51]
    ds_read_b128 v[88:91], v112 offset:36864
    s_mov_b64 exec, s[30:31]
    ds_read_b128 v[96:99], v113 offset:34816
    ds_read_b128 v[100:103], v113 offset:35328
    s_mov_b64 exec, -1
    v_exp_f32 v4, v4
    v_exp_f32 v5, v5
    v_exp_f32 v6, v6
    v_exp_f32 v7, v7
    v_exp_f32 v8, v8
    v_mfma_f32_32x32x16_bf16 v[52:67], v[104:107], v[76:79], v[52:67]
    v_exp_f32 v9, v9
    v_exp_f32 v10, v10
    v_exp_f32 v11, v11
    v_exp_f32 v12, v12
    v_exp_f32 v13, v13
    v_exp_f32 v14, v14
    v_mfma_f32_32x32x16_bf16 v[52:67], v[108:111], v[80:83], v[52:67]
    v_exp_f32 v15, v15
    v_exp_f32 v16, v16
    v_exp_f32 v17, v17
    v_exp_f32 v18, v18
    v_exp_f32 v19, v19
    v_cvt_pk_bf16_f32 v68, v4, v5
    v_cvt_pk_bf16_f32 v69, v6, v7
    v_cvt_pk_bf16_f32 v70, v8, v9
    v_cvt_pk_bf16_f32 v71, v10, v11
    v_cvt_pk_bf16_f32 v72, v12, v13
    v_cvt_pk_bf16_f32 v73, v14, v15
    v_cvt_pk_bf16_f32 v74, v16, v17
    v_cvt_pk_bf16_f32 v75, v18, v19
    s_waitcnt lgkmcnt(0)
    v_mfma_f32_32x32x16_bf16 v[4:19], v[88:91], v[84:87], v[36:51]
    ds_read_b128 v[92:95], v112 offset:37888
    s_mov_b64 exec, s[30:31]
    ds_read_b128 v[104:107], v113 offset:35840
    ds_read_b128 v[108:111], v113 offset:36352
    s_mov_b64 exec, -1
    v_exp_f32 v20, v20
    v_exp_f32 v21, v21
    v_exp_f32 v22, v22
    v_exp_f32 v23, v23
    v_exp_f32 v24, v24
    v_mfma_f32_32x32x16_bf16 v[52:67], v[96:99], v[68:71], v[52:67]
    v_exp_f32 v25, v25
    v_exp_f32 v26, v26
    v_exp_f32 v27, v27
    v_exp_f32 v28, v28
    v_exp_f32 v29, v29
    v_exp_f32 v30, v30
    v_mfma_f32_32x32x16_bf16 v[52:67], v[100:103], v[72:75], v[52:67]
    v_exp_f32 v31, v31
    v_exp_f32 v32, v32
    v_exp_f32 v33, v33
    v_exp_f32 v34, v34
    v_exp_f32 v35, v35
    v_cvt_pk_bf16_f32 v76, v20, v21
    v_cvt_pk_bf16_f32 v77, v22, v23
    v_cvt_pk_bf16_f32 v78, v24, v25
    v_cvt_pk_bf16_f32 v79, v26, v27
    v_cvt_pk_bf16_f32 v80, v28, v29
    v_cvt_pk_bf16_f32 v81, v30, v31
    v_cvt_pk_bf16_f32 v82, v32, v33
    v_cvt_pk_bf16_f32 v83, v34, v35
    s_waitcnt lgkmcnt(0)
    v_mfma_f32_32x32x16_bf16 v[20:35], v[92:95], v[84:87], v[36:51]
    ds_read_b128 v[88:91], v112 offset:38912
    s_mov_b64 exec, s[30:31]
    ds_read_b128 v[96:99], v113 offset:36864
    ds_read_b128 v[100:103], v113 offset:37376
    s_mov_b64 exec, -1
    v_exp_f32 v4, v4
    v_exp_f32 v5, v5
    v_exp_f32 v6, v6
    v_exp_f32 v7, v7
    v_exp_f32 v8, v8
    v_mfma_f32_32x32x16_bf16 v[52:67], v[104:107], v[76:79], v[52:67]
    v_exp_f32 v9, v9
    v_exp_f32 v10, v10
    v_exp_f32 v11, v11
    v_exp_f32 v12, v12
    v_exp_f32 v13, v13
    v_exp_f32 v14, v14
    v_mfma_f32_32x32x16_bf16 v[52:67], v[108:111], v[80:83], v[52:67]
    v_exp_f32 v15, v15
    v_exp_f32 v16, v16
    v_exp_f32 v17, v17
    v_exp_f32 v18, v18
    v_exp_f32 v19, v19
    v_cvt_pk_bf16_f32 v68, v4, v5
    v_cvt_pk_bf16_f32 v69, v6, v7
    v_cvt_pk_bf16_f32 v70, v8, v9
    v_cvt_pk_bf16_f32 v71, v10, v11
    v_cvt_pk_bf16_f32 v72, v12, v13
    v_cvt_pk_bf16_f32 v73, v14, v15
    v_cvt_pk_bf16_f32 v74, v16, v17
    v_cvt_pk_bf16_f32 v75, v18, v19
    s_waitcnt lgkmcnt(0)
    v_mfma_f32_32x32x16_bf16 v[4:19], v[88:91], v[84:87], v[36:51]
    ds_read_b128 v[92:95], v112 offset:39936
    s_mov_b64 exec, s[30:31]
    ds_read_b128 v[104:107], v113 offset:37888
    ds_read_b128 v[108:111], v113 offset:38400
    s_mov_b64 exec, -1
    v_exp_f32 v20, v20
    v_exp_f32 v21, v21
    v_exp_f32 v22, v22
    v_exp_f32 v23, v23
    v_exp_f32 v24, v24
    v_mfma_f32_32x32x16_bf16 v[52:67], v[96:99], v[68:71], v[52:67]
    v_exp_f32 v25, v25
    v_exp_f32 v26, v26
    v_exp_f32 v27, v27
    v_exp_f32 v28, v28
    v_exp_f32 v29, v29
    v_exp_f32 v30, v30
    v_mfma_f32_32x32x16_bf16 v[52:67], v[100:103], v[72:75], v[52:67]
    v_exp_f32 v31, v31
    v_exp_f32 v32, v32
    v_exp_f32 v33, v33
    v_exp_f32 v34, v34
    v_exp_f32 v35, v35
    v_cvt_pk_bf16_f32 v76, v20, v21
    v_cvt_pk_bf16_f32 v77, v22, v23
    v_cvt_pk_bf16_f32 v78, v24, v25
    v_cvt_pk_bf16_f32 v79, v26, v27
    v_cvt_pk_bf16_f32 v80, v28, v29
    v_cvt_pk_bf16_f32 v81, v30, v31
    v_cvt_pk_bf16_f32 v82, v32, v33
    v_cvt_pk_bf16_f32 v83, v34, v35
    s_waitcnt vmcnt(2)
    s_barrier
    s_add_u32 m0, s29, 16384
    s_add_u32 s36, s28, 40960
    buffer_load_dwordx4 v112, s[12:15], s36 offen lds
    s_add_u32 m0, s29, 24576
    s_nop 0
    buffer_load_dwordx4 v112, s[16:19], s36 offen lds
    s_waitcnt lgkmcnt(0)
    v_mfma_f32_32x32x16_bf16 v[20:35], v[92:95], v[84:87], v[36:51]
    ds_read_b128 v[88:91], v112 offset:49152
    s_mov_b64 exec, s[30:31]
    ds_read_b128 v[96:99], v113 offset:38912
    ds_read_b128 v[100:103], v113 offset:39424
    s_mov_b64 exec, -1
    v_exp_f32 v4, v4
    v_exp_f32 v5, v5
    v_exp_f32 v6, v6
    v_exp_f32 v7, v7
    v_exp_f32 v8, v8
    v_mfma_f32_32x32x16_bf16 v[52:67], v[104:107], v[76:79], v[52:67]
    v_exp_f32 v9, v9
    v_exp_f32 v10, v10
    v_exp_f32 v11, v11
    v_exp_f32 v12, v12
    v_exp_f32 v13, v13
    v_exp_f32 v14, v14
    v_mfma_f32_32x32x16_bf16 v[52:67], v[108:111], v[80:83], v[52:67]
    v_exp_f32 v15, v15
    v_exp_f32 v16, v16
    v_exp_f32 v17, v17
    v_exp_f32 v18, v18
    v_exp_f32 v19, v19
    v_cvt_pk_bf16_f32 v68, v4, v5
    v_cvt_pk_bf16_f32 v69, v6, v7
    v_cvt_pk_bf16_f32 v70, v8, v9
    v_cvt_pk_bf16_f32 v71, v10, v11
    v_cvt_pk_bf16_f32 v72, v12, v13
    v_cvt_pk_bf16_f32 v73, v14, v15
    v_cvt_pk_bf16_f32 v74, v16, v17
    v_cvt_pk_bf16_f32 v75, v18, v19
    s_waitcnt lgkmcnt(0)
    v_mfma_f32_32x32x16_bf16 v[4:19], v[88:91], v[84:87], v[36:51]
    ds_read_b128 v[92:95], v112 offset:50176
    s_mov_b64 exec, s[30:31]
    ds_read_b128 v[104:107], v113 offset:39936
    ds_read_b128 v[108:111], v113 offset:40448
    s_mov_b64 exec, -1
    v_exp_f32 v20, v20
    v_exp_f32 v21, v21
    v_exp_f32 v22, v22
    v_exp_f32 v23, v23
    v_exp_f32 v24, v24
    v_mfma_f32_32x32x16_bf16 v[52:67], v[96:99], v[68:71], v[52:67]
    v_exp_f32 v25, v25
    v_exp_f32 v26, v26
    v_exp_f32 v27, v27
    v_exp_f32 v28, v28
    v_exp_f32 v29, v29
    v_exp_f32 v30, v30
    v_mfma_f32_32x32x16_bf16 v[52:67], v[100:103], v[72:75], v[52:67]
    v_exp_f32 v31, v31
    v_exp_f32 v32, v32
    v_exp_f32 v33, v33
    v_exp_f32 v34, v34
    v_exp_f32 v35, v35
    v_cvt_pk_bf16_f32 v76, v20, v21
    v_cvt_pk_bf16_f32 v77, v22, v23
    v_cvt_pk_bf16_f32 v78, v24, v25
    v_cvt_pk_bf16_f32 v79, v26, v27
    v_cvt_pk_bf16_f32 v80, v28, v29
    v_cvt_pk_bf16_f32 v81, v30, v31
    v_cvt_pk_bf16_f32 v82, v32, v33
    v_cvt_pk_bf16_f32 v83, v34, v35
    s_waitcnt lgkmcnt(0)
    v_mfma_f32_32x32x16_bf16 v[20:35], v[92:95], v[84:87], v[36:51]
    ds_read_b128 v[88:91], v112 offset:51200
    s_mov_b64 exec, s[30:31]
    ds_read_b128 v[96:99], v113 offset:49152
    ds_read_b128 v[100:103], v113 offset:49664
    s_mov_b64 exec, -1
    v_exp_f32 v4, v4
    v_exp_f32 v5, v5
    v_exp_f32 v6, v6
    v_exp_f32 v7, v7
    v_exp_f32 v8, v8
    v_mfma_f32_32x32x16_bf16 v[52:67], v[104:107], v[76:79], v[52:67]
    v_exp_f32 v9, v9
    v_exp_f32 v10, v10
    v_exp_f32 v11, v11
    v_exp_f32 v12, v12
    v_exp_f32 v13, v13
    v_exp_f32 v14, v14
    v_mfma_f32_32x32x16_bf16 v[52:67], v[108:111], v[80:83], v[52:67]
    v_exp_f32 v15, v15
    v_exp_f32 v16, v16
    v_exp_f32 v17, v17
    v_exp_f32 v18, v18
    v_exp_f32 v19, v19
    v_cvt_pk_bf16_f32 v68, v4, v5
    v_cvt_pk_bf16_f32 v69, v6, v7
    v_cvt_pk_bf16_f32 v70, v8, v9
    v_cvt_pk_bf16_f32 v71, v10, v11
    v_cvt_pk_bf16_f32 v72, v12, v13
    v_cvt_pk_bf16_f32 v73, v14, v15
    v_cvt_pk_bf16_f32 v74, v16, v17
    v_cvt_pk_bf16_f32 v75, v18, v19
    s_waitcnt lgkmcnt(0)
    v_mfma_f32_32x32x16_bf16 v[4:19], v[88:91], v[84:87], v[36:51]
    ds_read_b128 v[92:95], v112 offset:52224
    s_mov_b64 exec, s[30:31]
    ds_read_b128 v[104:107], v113 offset:50176
    ds_read_b128 v[108:111], v113 offset:50688
    s_mov_b64 exec, -1
    v_exp_f32 v20, v20
    v_exp_f32 v21, v21
    v_exp_f32 v22, v22
    v_exp_f32 v23, v23
    v_exp_f32 v24, v24
    v_mfma_f32_32x32x16_bf16 v[52:67], v[96:99], v[68:71], v[52:67]
    v_exp_f32 v25, v25
    v_exp_f32 v26, v26
    v_exp_f32 v27, v27
    v_exp_f32 v28, v28
    v_exp_f32 v29, v29
    v_exp_f32 v30, v30
    v_mfma_f32_32x32x16_bf16 v[52:67], v[100:103], v[72:75], v[52:67]
    v_exp_f32 v31, v31
    v_exp_f32 v32, v32
    v_exp_f32 v33, v33
    v_exp_f32 v34, v34
    v_exp_f32 v35, v35
    v_cvt_pk_bf16_f32 v76, v20, v21
    v_cvt_pk_bf16_f32 v77, v22, v23
    v_cvt_pk_bf16_f32 v78, v24, v25
    v_cvt_pk_bf16_f32 v79, v26, v27
    v_cvt_pk_bf16_f32 v80, v28, v29
    v_cvt_pk_bf16_f32 v81, v30, v31
    v_cvt_pk_bf16_f32 v82, v32, v33
    v_cvt_pk_bf16_f32 v83, v34, v35
    s_waitcnt lgkmcnt(0)
    v_mfma_f32_32x32x16_bf16 v[20:35], v[92:95], v[84:87], v[36:51]
    ds_read_b128 v[88:91], v112 offset:53248
    s_mov_b64 exec, s[30:31]
    ds_read_b128 v[96:99], v113 offset:51200
    ds_read_b128 v[100:103], v113 offset:51712
    s_mov_b64 exec, -1
    v_exp_f32 v4, v4
    v_exp_f32 v5, v5
    v_exp_f32 v6, v6
    v_exp_f32 v7, v7
    v_exp_f32 v8, v8
    v_mfma_f32_32x32x16_bf16 v[52:67], v[104:107], v[76:79], v[52:67]
    v_exp_f32 v9, v9
    v_exp_f32 v10, v10
    v_exp_f32 v11, v11
    v_exp_f32 v12, v12
    v_exp_f32 v13, v13
    v_exp_f32 v14, v14
    v_mfma_f32_32x32x16_bf16 v[52:67], v[108:111], v[80:83], v[52:67]
    v_exp_f32 v15, v15
    v_exp_f32 v16, v16
    v_exp_f32 v17, v17
    v_exp_f32 v18, v18
    v_exp_f32 v19, v19
    v_cvt_pk_bf16_f32 v68, v4, v5
    v_cvt_pk_bf16_f32 v69, v6, v7
    v_cvt_pk_bf16_f32 v70, v8, v9
    v_cvt_pk_bf16_f32 v71, v10, v11
    v_cvt_pk_bf16_f32 v72, v12, v13
    v_cvt_pk_bf16_f32 v73, v14, v15
    v_cvt_pk_bf16_f32 v74, v16, v17
    v_cvt_pk_bf16_f32 v75, v18, v19
    s_waitcnt lgkmcnt(0)
    v_mfma_f32_32x32x16_bf16 v[4:19], v[88:91], v[84:87], v[36:51]
    ds_read_b128 v[92:95], v112 offset:54272
    s_mov_b64 exec, s[30:31]
    ds_read_b128 v[104:107], v113 offset:52224
    ds_read_b128 v[108:111], v113 offset:52736
    s_mov_b64 exec, -1
    v_exp_f32 v20, v20
    v_exp_f32 v21, v21
    v_exp_f32 v22, v22
    v_exp_f32 v23, v23
    v_exp_f32 v24, v24
    v_mfma_f32_32x32x16_bf16 v[52:67], v[96:99], v[68:71], v[52:67]
    v_exp_f32 v25, v25
    v_exp_f32 v26, v26
    v_exp_f32 v27, v27
    v_exp_f32 v28, v28
    v_exp_f32 v29, v29
    v_exp_f32 v30, v30
    v_mfma_f32_32x32x16_bf16 v[52:67], v[100:103], v[72:75], v[52:67]
    v_exp_f32 v31, v31
    v_exp_f32 v32, v32
    v_exp_f32 v33, v33
    v_exp_f32 v34, v34
    v_exp_f32 v35, v35
    v_cvt_pk_bf16_f32 v76, v20, v21
    v_cvt_pk_bf16_f32 v77, v22, v23
    v_cvt_pk_bf16_f32 v78, v24, v25
    v_cvt_pk_bf16_f32 v79, v26, v27
    v_cvt_pk_bf16_f32 v80, v28, v29
    v_cvt_pk_bf16_f32 v81, v30, v31
    v_cvt_pk_bf16_f32 v82, v32, v33
    v_cvt_pk_bf16_f32 v83, v34, v35
    s_waitcnt lgkmcnt(0)
    v_mfma_f32_32x32x16_bf16 v[20:35], v[92:95], v[84:87], v[36:51]
    ds_read_b128 v[88:91], v112 offset:55296
    s_mov_b64 exec, s[30:31]
    ds_read_b128 v[96:99], v113 offset:53248
    ds_read_b128 v[100:103], v113 offset:53760
    s_mov_b64 exec, -1
    v_exp_f32 v4, v4
    v_exp_f32 v5, v5
    v_exp_f32 v6, v6
    v_exp_f32 v7, v7
    v_exp_f32 v8, v8
    v_mfma_f32_32x32x16_bf16 v[52:67], v[104:107], v[76:79], v[52:67]
    v_exp_f32 v9, v9
    v_exp_f32 v10, v10
    v_exp_f32 v11, v11
    v_exp_f32 v12, v12
    v_exp_f32 v13, v13
    v_exp_f32 v14, v14
    v_mfma_f32_32x32x16_bf16 v[52:67], v[108:111], v[80:83], v[52:67]
    v_exp_f32 v15, v15
    v_exp_f32 v16, v16
    v_exp_f32 v17, v17
    v_exp_f32 v18, v18
    v_exp_f32 v19, v19
    v_cvt_pk_bf16_f32 v68, v4, v5
    v_cvt_pk_bf16_f32 v69, v6, v7
    v_cvt_pk_bf16_f32 v70, v8, v9
    v_cvt_pk_bf16_f32 v71, v10, v11
    v_cvt_pk_bf16_f32 v72, v12, v13
    v_cvt_pk_bf16_f32 v73, v14, v15
    v_cvt_pk_bf16_f32 v74, v16, v17
    v_cvt_pk_bf16_f32 v75, v18, v19
    s_waitcnt lgkmcnt(0)
    v_mfma_f32_32x32x16_bf16 v[4:19], v[88:91], v[84:87], v[36:51]
    ds_read_b128 v[92:95], v112 offset:56320
    s_mov_b64 exec, s[30:31]
    ds_read_b128 v[104:107], v113 offset:54272
    ds_read_b128 v[108:111], v113 offset:54784
    s_mov_b64 exec, -1
    v_exp_f32 v20, v20
    v_exp_f32 v21, v21
    v_exp_f32 v22, v22
    v_exp_f32 v23, v23
    v_exp_f32 v24, v24
    v_mfma_f32_32x32x16_bf16 v[52:67], v[96:99], v[68:71], v[52:67]
    v_exp_f32 v25, v25
    v_exp_f32 v26, v26
    v_exp_f32 v27, v27
    v_exp_f32 v28, v28
    v_exp_f32 v29, v29
    v_exp_f32 v30, v30
    v_mfma_f32_32x32x16_bf16 v[52:67], v[100:103], v[72:75], v[52:67]
    v_exp_f32 v31, v31
    v_exp_f32 v32, v32
    v_exp_f32 v33, v33
    v_exp_f32 v34, v34
    v_exp_f32 v35, v35
    v_cvt_pk_bf16_f32 v76, v20, v21
    v_cvt_pk_bf16_f32 v77, v22, v23
    v_cvt_pk_bf16_f32 v78, v24, v25
    v_cvt_pk_bf16_f32 v79, v26, v27
    v_cvt_pk_bf16_f32 v80, v28, v29
    v_cvt_pk_bf16_f32 v81, v30, v31
    v_cvt_pk_bf16_f32 v82, v32, v33
    v_cvt_pk_bf16_f32 v83, v34, v35
    s_waitcnt vmcnt(2)
    s_barrier
    s_add_u32 m0, s29, 32768
    s_add_u32 s36, s28, 49152
    buffer_load_dwordx4 v112, s[12:15], s36 offen lds
    s_add_u32 m0, s29, 40960
    s_nop 0
    buffer_load_dwordx4 v112, s[16:19], s36 offen lds
    s_waitcnt lgkmcnt(0)
    v_mfma_f32_32x32x16_bf16 v[20:35], v[92:95], v[84:87], v[36:51]
    ds_read_b128 v[88:91], v112 offset:0
    s_mov_b64 exec, s[30:31]
    ds_read_b128 v[96:99], v113 offset:55296
    ds_read_b128 v[100:103], v113 offset:55808
    s_mov_b64 exec, -1
    v_exp_f32 v4, v4
    v_exp_f32 v5, v5
    v_exp_f32 v6, v6
    v_exp_f32 v7, v7
    v_exp_f32 v8, v8
    v_mfma_f32_32x32x16_bf16 v[52:67], v[104:107], v[76:79], v[52:67]
    v_exp_f32 v9, v9
    v_exp_f32 v10, v10
    v_exp_f32 v11, v11
    v_exp_f32 v12, v12
    v_exp_f32 v13, v13
    v_exp_f32 v14, v14
    v_mfma_f32_32x32x16_bf16 v[52:67], v[108:111], v[80:83], v[52:67]
    v_exp_f32 v15, v15
    v_exp_f32 v16, v16
    v_exp_f32 v17, v17
    v_exp_f32 v18, v18
    v_exp_f32 v19, v19
    v_cvt_pk_bf16_f32 v68, v4, v5
    v_cvt_pk_bf16_f32 v69, v6, v7
    v_cvt_pk_bf16_f32 v70, v8, v9
    v_cvt_pk_bf16_f32 v71, v10, v11
    v_cvt_pk_bf16_f32 v72, v12, v13
    v_cvt_pk_bf16_f32 v73, v14, v15
    v_cvt_pk_bf16_f32 v74, v16, v17
    v_cvt_pk_bf16_f32 v75, v18, v19
    s_waitcnt lgkmcnt(0)
    v_mfma_f32_32x32x16_bf16 v[4:19], v[88:91], v[84:87], v[36:51]
    ds_read_b128 v[92:95], v112 offset:1024
    s_mov_b64 exec, s[30:31]
    ds_read_b128 v[104:107], v113 offset:56320
    ds_read_b128 v[108:111], v113 offset:56832
    s_mov_b64 exec, -1
    v_exp_f32 v20, v20
    v_exp_f32 v21, v21
    v_exp_f32 v22, v22
    v_exp_f32 v23, v23
    v_exp_f32 v24, v24
    v_mfma_f32_32x32x16_bf16 v[52:67], v[96:99], v[68:71], v[52:67]
    v_exp_f32 v25, v25
    v_exp_f32 v26, v26
    v_exp_f32 v27, v27
    v_exp_f32 v28, v28
    v_exp_f32 v29, v29
    v_exp_f32 v30, v30
    v_mfma_f32_32x32x16_bf16 v[52:67], v[100:103], v[72:75], v[52:67]
    v_exp_f32 v31, v31
    v_exp_f32 v32, v32
    v_exp_f32 v33, v33
    v_exp_f32 v34, v34
    v_exp_f32 v35, v35
    v_cvt_pk_bf16_f32 v76, v20, v21
    v_cvt_pk_bf16_f32 v77, v22, v23
    v_cvt_pk_bf16_f32 v78, v24, v25
    v_cvt_pk_bf16_f32 v79, v26, v27
    v_cvt_pk_bf16_f32 v80, v28, v29
    v_cvt_pk_bf16_f32 v81, v30, v31
    v_cvt_pk_bf16_f32 v82, v32, v33
    v_cvt_pk_bf16_f32 v83, v34, v35
    s_waitcnt lgkmcnt(0)
    v_mfma_f32_32x32x16_bf16 v[20:35], v[92:95], v[84:87], v[36:51]
    ds_read_b128 v[88:91], v112 offset:2048
    s_mov_b64 exec, s[30:31]
    ds_read_b128 v[96:99], v113 offset:0
    ds_read_b128 v[100:103], v113 offset:512
    s_mov_b64 exec, -1
    v_exp_f32 v4, v4
    v_exp_f32 v5, v5
    v_exp_f32 v6, v6
    v_exp_f32 v7, v7
    v_exp_f32 v8, v8
    v_mfma_f32_32x32x16_bf16 v[52:67], v[104:107], v[76:79], v[52:67]
    v_exp_f32 v9, v9
    v_exp_f32 v10, v10
    v_exp_f32 v11, v11
    v_exp_f32 v12, v12
    v_exp_f32 v13, v13
    v_exp_f32 v14, v14
    v_mfma_f32_32x32x16_bf16 v[52:67], v[108:111], v[80:83], v[52:67]
    v_exp_f32 v15, v15
    v_exp_f32 v16, v16
    v_exp_f32 v17, v17
    v_exp_f32 v18, v18
    v_exp_f32 v19, v19
    v_cvt_pk_bf16_f32 v68, v4, v5
    v_cvt_pk_bf16_f32 v69, v6, v7
    v_cvt_pk_bf16_f32 v70, v8, v9
    v_cvt_pk_bf16_f32 v71, v10, v11
    v_cvt_pk_bf16_f32 v72, v12, v13
    v_cvt_pk_bf16_f32 v73, v14, v15
    v_cvt_pk_bf16_f32 v74, v16, v17
    v_cvt_pk_bf16_f32 v75, v18, v19
    s_waitcnt lgkmcnt(0)
    v_mfma_f32_32x32x16_bf16 v[4:19], v[88:91], v[84:87], v[36:51]
    ds_read_b128 v[92:95], v112 offset:3072
    s_mov_b64 exec, s[30:31]
    ds_read_b128 v[104:107], v113 offset:1024
    ds_read_b128 v[108:111], v113 offset:1536
    s_mov_b64 exec, -1
    v_exp_f32 v20, v20
    v_exp_f32 v21, v21
    v_exp_f32 v22, v22
    v_exp_f32 v23, v23
    v_exp_f32 v24, v24
    v_mfma_f32_32x32x16_bf16 v[52:67], v[96:99], v[68:71], v[52:67]
    v_exp_f32 v25, v25
    v_exp_f32 v26, v26
    v_exp_f32 v27, v27
    v_exp_f32 v28, v28
    v_exp_f32 v29, v29
    v_exp_f32 v30, v30
    v_mfma_f32_32x32x16_bf16 v[52:67], v[100:103], v[72:75], v[52:67]
    v_exp_f32 v31, v31
    v_exp_f32 v32, v32
    v_exp_f32 v33, v33
    v_exp_f32 v34, v34
    v_exp_f32 v35, v35
    v_cvt_pk_bf16_f32 v76, v20, v21
    v_cvt_pk_bf16_f32 v77, v22, v23
    v_cvt_pk_bf16_f32 v78, v24, v25
    v_cvt_pk_bf16_f32 v79, v26, v27
    v_cvt_pk_bf16_f32 v80, v28, v29
    v_cvt_pk_bf16_f32 v81, v30, v31
    v_cvt_pk_bf16_f32 v82, v32, v33
    v_cvt_pk_bf16_f32 v83, v34, v35
    s_waitcnt lgkmcnt(0)
    v_mfma_f32_32x32x16_bf16 v[20:35], v[92:95], v[84:87], v[36:51]
    ds_read_b128 v[88:91], v112 offset:4096
    s_mov_b64 exec, s[30:31]
    ds_read_b128 v[96:99], v113 offset:2048
    ds_read_b128 v[100:103], v113 offset:2560
    s_mov_b64 exec, -1
    v_exp_f32 v4, v4
    v_exp_f32 v5, v5
    v_exp_f32 v6, v6
    v_exp_f32 v7, v7
    v_exp_f32 v8, v8
    v_mfma_f32_32x32x16_bf16 v[52:67], v[104:107], v[76:79], v[52:67]
    v_exp_f32 v9, v9
    v_exp_f32 v10, v10
    v_exp_f32 v11, v11
    v_exp_f32 v12, v12
    v_exp_f32 v13, v13
    v_exp_f32 v14, v14
    v_mfma_f32_32x32x16_bf16 v[52:67], v[108:111], v[80:83], v[52:67]
    v_exp_f32 v15, v15
    v_exp_f32 v16, v16
    v_exp_f32 v17, v17
    v_exp_f32 v18, v18
    v_exp_f32 v19, v19
    v_cvt_pk_bf16_f32 v68, v4, v5
    v_cvt_pk_bf16_f32 v69, v6, v7
    v_cvt_pk_bf16_f32 v70, v8, v9
    v_cvt_pk_bf16_f32 v71, v10, v11
    v_cvt_pk_bf16_f32 v72, v12, v13
    v_cvt_pk_bf16_f32 v73, v14, v15
    v_cvt_pk_bf16_f32 v74, v16, v17
    v_cvt_pk_bf16_f32 v75, v18, v19
    s_waitcnt lgkmcnt(0)
    v_mfma_f32_32x32x16_bf16 v[4:19], v[88:91], v[84:87], v[36:51]
    ds_read_b128 v[92:95], v112 offset:5120
    s_mov_b64 exec, s[30:31]
    ds_read_b128 v[104:107], v113 offset:3072
    ds_read_b128 v[108:111], v113 offset:3584
    s_mov_b64 exec, -1
    v_exp_f32 v20, v20
    v_exp_f32 v21, v21
    v_exp_f32 v22, v22
    v_exp_f32 v23, v23
    v_exp_f32 v24, v24
    v_mfma_f32_32x32x16_bf16 v[52:67], v[96:99], v[68:71], v[52:67]
    v_exp_f32 v25, v25
    v_exp_f32 v26, v26
    v_exp_f32 v27, v27
    v_exp_f32 v28, v28
    v_exp_f32 v29, v29
    v_exp_f32 v30, v30
    v_mfma_f32_32x32x16_bf16 v[52:67], v[100:103], v[72:75], v[52:67]
    v_exp_f32 v31, v31
    v_exp_f32 v32, v32
    v_exp_f32 v33, v33
    v_exp_f32 v34, v34
    v_exp_f32 v35, v35
    v_cvt_pk_bf16_f32 v76, v20, v21
    v_cvt_pk_bf16_f32 v77, v22, v23
    v_cvt_pk_bf16_f32 v78, v24, v25
    v_cvt_pk_bf16_f32 v79, v26, v27
    v_cvt_pk_bf16_f32 v80, v28, v29
    v_cvt_pk_bf16_f32 v81, v30, v31
    v_cvt_pk_bf16_f32 v82, v32, v33
    v_cvt_pk_bf16_f32 v83, v34, v35
    s_waitcnt lgkmcnt(0)
    v_mfma_f32_32x32x16_bf16 v[20:35], v[92:95], v[84:87], v[36:51]
    ds_read_b128 v[88:91], v112 offset:6144
    s_mov_b64 exec, s[30:31]
    ds_read_b128 v[96:99], v113 offset:4096
    ds_read_b128 v[100:103], v113 offset:4608
    s_mov_b64 exec, -1
    v_exp_f32 v4, v4
    v_exp_f32 v5, v5
    v_exp_f32 v6, v6
    v_exp_f32 v7, v7
    v_exp_f32 v8, v8
    v_mfma_f32_32x32x16_bf16 v[52:67], v[104:107], v[76:79], v[52:67]
    v_exp_f32 v9, v9
    v_exp_f32 v10, v10
    v_exp_f32 v11, v11
    v_exp_f32 v12, v12
    v_exp_f32 v13, v13
    v_exp_f32 v14, v14
    v_mfma_f32_32x32x16_bf16 v[52:67], v[108:111], v[80:83], v[52:67]
    v_exp_f32 v15, v15
    v_exp_f32 v16, v16
    v_exp_f32 v17, v17
    v_exp_f32 v18, v18
    v_exp_f32 v19, v19
    v_cvt_pk_bf16_f32 v68, v4, v5
    v_cvt_pk_bf16_f32 v69, v6, v7
    v_cvt_pk_bf16_f32 v70, v8, v9
    v_cvt_pk_bf16_f32 v71, v10, v11
    v_cvt_pk_bf16_f32 v72, v12, v13
    v_cvt_pk_bf16_f32 v73, v14, v15
    v_cvt_pk_bf16_f32 v74, v16, v17
    v_cvt_pk_bf16_f32 v75, v18, v19
    s_waitcnt lgkmcnt(0)
    v_mfma_f32_32x32x16_bf16 v[4:19], v[88:91], v[84:87], v[36:51]
    ds_read_b128 v[92:95], v112 offset:7168
    s_mov_b64 exec, s[30:31]
    ds_read_b128 v[104:107], v113 offset:5120
    ds_read_b128 v[108:111], v113 offset:5632
    s_mov_b64 exec, -1
    v_exp_f32 v20, v20
    v_exp_f32 v21, v21
    v_exp_f32 v22, v22
    v_exp_f32 v23, v23
    v_exp_f32 v24, v24
    v_mfma_f32_32x32x16_bf16 v[52:67], v[96:99], v[68:71], v[52:67]
    v_exp_f32 v25, v25
    v_exp_f32 v26, v26
    v_exp_f32 v27, v27
    v_exp_f32 v28, v28
    v_exp_f32 v29, v29
    v_exp_f32 v30, v30
    v_mfma_f32_32x32x16_bf16 v[52:67], v[100:103], v[72:75], v[52:67]
    v_exp_f32 v31, v31
    v_exp_f32 v32, v32
    v_exp_f32 v33, v33
    v_exp_f32 v34, v34
    v_exp_f32 v35, v35
    v_cvt_pk_bf16_f32 v76, v20, v21
    v_cvt_pk_bf16_f32 v77, v22, v23
    v_cvt_pk_bf16_f32 v78, v24, v25
    v_cvt_pk_bf16_f32 v79, v26, v27
    v_cvt_pk_bf16_f32 v80, v28, v29
    v_cvt_pk_bf16_f32 v81, v30, v31
    v_cvt_pk_bf16_f32 v82, v32, v33
    v_cvt_pk_bf16_f32 v83, v34, v35
    s_waitcnt vmcnt(2)
    s_barrier
    s_add_u32 m0, s29, 49152
    s_add_u32 s36, s28, 57344
    buffer_load_dwordx4 v112, s[12:15], s36 offen lds
    s_add_u32 m0, s29, 57344
    s_nop 0
    buffer_load_dwordx4 v112, s[16:19], s36 offen lds
    s_waitcnt lgkmcnt(0)
    v_mfma_f32_32x32x16_bf16 v[20:35], v[92:95], v[84:87], v[36:51]
    ds_read_b128 v[88:91], v112 offset:16384
    s_mov_b64 exec, s[30:31]
    ds_read_b128 v[96:99], v113 offset:6144
    ds_read_b128 v[100:103], v113 offset:6656
    s_mov_b64 exec, -1
    v_exp_f32 v4, v4
    v_exp_f32 v5, v5
    v_exp_f32 v6, v6
    v_exp_f32 v7, v7
    v_exp_f32 v8, v8
    v_mfma_f32_32x32x16_bf16 v[52:67], v[104:107], v[76:79], v[52:67]
    v_exp_f32 v9, v9
    v_exp_f32 v10, v10
    v_exp_f32 v11, v11
    v_exp_f32 v12, v12
    v_exp_f32 v13, v13
    v_exp_f32 v14, v14
    v_mfma_f32_32x32x16_bf16 v[52:67], v[108:111], v[80:83], v[52:67]
    v_exp_f32 v15, v15
    v_exp_f32 v16, v16
    v_exp_f32 v17, v17
    v_exp_f32 v18, v18
    v_exp_f32 v19, v19
    v_cvt_pk_bf16_f32 v68, v4, v5
    v_cvt_pk_bf16_f32 v69, v6, v7
    v_cvt_pk_bf16_f32 v70, v8, v9
    v_cvt_pk_bf16_f32 v71, v10, v11
    v_cvt_pk_bf16_f32 v72, v12, v13
    v_cvt_pk_bf16_f32 v73, v14, v15
    v_cvt_pk_bf16_f32 v74, v16, v17
    v_cvt_pk_bf16_f32 v75, v18, v19
    s_waitcnt lgkmcnt(0)
    v_mfma_f32_32x32x16_bf16 v[4:19], v[88:91], v[84:87], v[36:51]
    ds_read_b128 v[92:95], v112 offset:17408
    s_mov_b64 exec, s[30:31]
    ds_read_b128 v[104:107], v113 offset:7168
    ds_read_b128 v[108:111], v113 offset:7680
    s_mov_b64 exec, -1
    v_exp_f32 v20, v20
    v_exp_f32 v21, v21
    v_exp_f32 v22, v22
    v_exp_f32 v23, v23
    v_exp_f32 v24, v24
    v_mfma_f32_32x32x16_bf16 v[52:67], v[96:99], v[68:71], v[52:67]
    v_exp_f32 v25, v25
    v_exp_f32 v26, v26
    v_exp_f32 v27, v27
    v_exp_f32 v28, v28
    v_exp_f32 v29, v29
    v_exp_f32 v30, v30
    v_mfma_f32_32x32x16_bf16 v[52:67], v[100:103], v[72:75], v[52:67]
    v_exp_f32 v31, v31
    v_exp_f32 v32, v32
    v_exp_f32 v33, v33
    v_exp_f32 v34, v34
    v_exp_f32 v35, v35
    v_cvt_pk_bf16_f32 v76, v20, v21
    v_cvt_pk_bf16_f32 v77, v22, v23
    v_cvt_pk_bf16_f32 v78, v24, v25
    v_cvt_pk_bf16_f32 v79, v26, v27
    v_cvt_pk_bf16_f32 v80, v28, v29
    v_cvt_pk_bf16_f32 v81, v30, v31
    v_cvt_pk_bf16_f32 v82, v32, v33
    v_cvt_pk_bf16_f32 v83, v34, v35
    s_waitcnt lgkmcnt(0)
    v_mfma_f32_32x32x16_bf16 v[20:35], v[92:95], v[84:87], v[36:51]
    ds_read_b128 v[88:91], v112 offset:18432
    s_mov_b64 exec, s[30:31]
    ds_read_b128 v[96:99], v113 offset:16384
    ds_read_b128 v[100:103], v113 offset:16896
    s_mov_b64 exec, -1
    v_exp_f32 v4, v4
    v_exp_f32 v5, v5
    v_exp_f32 v6, v6
    v_exp_f32 v7, v7
    v_exp_f32 v8, v8
    v_mfma_f32_32x32x16_bf16 v[52:67], v[104:107], v[76:79], v[52:67]
    v_exp_f32 v9, v9
    v_exp_f32 v10, v10
    v_exp_f32 v11, v11
    v_exp_f32 v12, v12
    v_exp_f32 v13, v13
    v_exp_f32 v14, v14
    v_mfma_f32_32x32x16_bf16 v[52:67], v[108:111], v[80:83], v[52:67]
    v_exp_f32 v15, v15
    v_exp_f32 v16, v16
    v_exp_f32 v17, v17
    v_exp_f32 v18, v18
    v_exp_f32 v19, v19
    v_cvt_pk_bf16_f32 v68, v4, v5
    v_cvt_pk_bf16_f32 v69, v6, v7
    v_cvt_pk_bf16_f32 v70, v8, v9
    v_cvt_pk_bf16_f32 v71, v10, v11
    v_cvt_pk_bf16_f32 v72, v12, v13
    v_cvt_pk_bf16_f32 v73, v14, v15
    v_cvt_pk_bf16_f32 v74, v16, v17
    v_cvt_pk_bf16_f32 v75, v18, v19
    s_waitcnt lgkmcnt(0)
    v_mfma_f32_32x32x16_bf16 v[4:19], v[88:91], v[84:87], v[36:51]
    ds_read_b128 v[92:95], v112 offset:19456
    s_mov_b64 exec, s[30:31]
    ds_read_b128 v[104:107], v113 offset:17408
    ds_read_b128 v[108:111], v113 offset:17920
    s_mov_b64 exec, -1
    v_exp_f32 v20, v20
    v_exp_f32 v21, v21
    v_exp_f32 v22, v22
    v_exp_f32 v23, v23
    v_exp_f32 v24, v24
    v_mfma_f32_32x32x16_bf16 v[52:67], v[96:99], v[68:71], v[52:67]
    v_exp_f32 v25, v25
    v_exp_f32 v26, v26
    v_exp_f32 v27, v27
    v_exp_f32 v28, v28
    v_exp_f32 v29, v29
    v_exp_f32 v30, v30
    v_mfma_f32_32x32x16_bf16 v[52:67], v[100:103], v[72:75], v[52:67]
    v_exp_f32 v31, v31
    v_exp_f32 v32, v32
    v_exp_f32 v33, v33
    v_exp_f32 v34, v34
    v_exp_f32 v35, v35
    v_cvt_pk_bf16_f32 v76, v20, v21
    v_cvt_pk_bf16_f32 v77, v22, v23
    v_cvt_pk_bf16_f32 v78, v24, v25
    v_cvt_pk_bf16_f32 v79, v26, v27
    v_cvt_pk_bf16_f32 v80, v28, v29
    v_cvt_pk_bf16_f32 v81, v30, v31
    v_cvt_pk_bf16_f32 v82, v32, v33
    v_cvt_pk_bf16_f32 v83, v34, v35
    s_waitcnt lgkmcnt(0)
    v_mfma_f32_32x32x16_bf16 v[20:35], v[92:95], v[84:87], v[36:51]
    ds_read_b128 v[88:91], v112 offset:20480
    s_mov_b64 exec, s[30:31]
    ds_read_b128 v[96:99], v113 offset:18432
    ds_read_b128 v[100:103], v113 offset:18944
    s_mov_b64 exec, -1
    v_exp_f32 v4, v4
    v_exp_f32 v5, v5
    v_exp_f32 v6, v6
    v_exp_f32 v7, v7
    v_exp_f32 v8, v8
    v_mfma_f32_32x32x16_bf16 v[52:67], v[104:107], v[76:79], v[52:67]
    v_exp_f32 v9, v9
    v_exp_f32 v10, v10
    v_exp_f32 v11, v11
    v_exp_f32 v12, v12
    v_exp_f32 v13, v13
    v_exp_f32 v14, v14
    v_mfma_f32_32x32x16_bf16 v[52:67], v[108:111], v[80:83], v[52:67]
    v_exp_f32 v15, v15
    v_exp_f32 v16, v16
    v_exp_f32 v17, v17
    v_exp_f32 v18, v18
    v_exp_f32 v19, v19
    v_cvt_pk_bf16_f32 v68, v4, v5
    v_cvt_pk_bf16_f32 v69, v6, v7
    v_cvt_pk_bf16_f32 v70, v8, v9
    v_cvt_pk_bf16_f32 v71, v10, v11
    v_cvt_pk_bf16_f32 v72, v12, v13
    v_cvt_pk_bf16_f32 v73, v14, v15
    v_cvt_pk_bf16_f32 v74, v16, v17
    v_cvt_pk_bf16_f32 v75, v18, v19
    s_waitcnt lgkmcnt(0)
    v_mfma_f32_32x32x16_bf16 v[4:19], v[88:91], v[84:87], v[36:51]
    ds_read_b128 v[92:95], v112 offset:21504
    s_mov_b64 exec, s[30:31]
    ds_read_b128 v[104:107], v113 offset:19456
    ds_read_b128 v[108:111], v113 offset:19968
    s_mov_b64 exec, -1
    v_exp_f32 v20, v20
    v_exp_f32 v21, v21
    v_exp_f32 v22, v22
    v_exp_f32 v23, v23
    v_exp_f32 v24, v24
    v_mfma_f32_32x32x16_bf16 v[52:67], v[96:99], v[68:71], v[52:67]
    v_exp_f32 v25, v25
    v_exp_f32 v26, v26
    v_exp_f32 v27, v27
    v_exp_f32 v28, v28
    v_exp_f32 v29, v29
    v_exp_f32 v30, v30
    v_mfma_f32_32x32x16_bf16 v[52:67], v[100:103], v[72:75], v[52:67]
    v_exp_f32 v31, v31
    v_exp_f32 v32, v32
    v_exp_f32 v33, v33
    v_exp_f32 v34, v34
    v_exp_f32 v35, v35
    v_cvt_pk_bf16_f32 v76, v20, v21
    v_cvt_pk_bf16_f32 v77, v22, v23
    v_cvt_pk_bf16_f32 v78, v24, v25
    v_cvt_pk_bf16_f32 v79, v26, v27
    v_cvt_pk_bf16_f32 v80, v28, v29
    v_cvt_pk_bf16_f32 v81, v30, v31
    v_cvt_pk_bf16_f32 v82, v32, v33
    v_cvt_pk_bf16_f32 v83, v34, v35
    s_waitcnt lgkmcnt(0)
    v_mfma_f32_32x32x16_bf16 v[20:35], v[92:95], v[84:87], v[36:51]
    ds_read_b128 v[88:91], v112 offset:22528
    s_mov_b64 exec, s[30:31]
    ds_read_b128 v[96:99], v113 offset:20480
    ds_read_b128 v[100:103], v113 offset:20992
    s_mov_b64 exec, -1
    v_exp_f32 v4, v4
    v_exp_f32 v5, v5
    v_exp_f32 v6, v6
    v_exp_f32 v7, v7
    v_exp_f32 v8, v8
    v_mfma_f32_32x32x16_bf16 v[52:67], v[104:107], v[76:79], v[52:67]
    v_exp_f32 v9, v9
    v_exp_f32 v10, v10
    v_exp_f32 v11, v11
    v_exp_f32 v12, v12
    v_exp_f32 v13, v13
    v_exp_f32 v14, v14
    v_mfma_f32_32x32x16_bf16 v[52:67], v[108:111], v[80:83], v[52:67]
    v_exp_f32 v15, v15
    v_exp_f32 v16, v16
    v_exp_f32 v17, v17
    v_exp_f32 v18, v18
    v_exp_f32 v19, v19
    v_cvt_pk_bf16_f32 v68, v4, v5
    v_cvt_pk_bf16_f32 v69, v6, v7
    v_cvt_pk_bf16_f32 v70, v8, v9
    v_cvt_pk_bf16_f32 v71, v10, v11
    v_cvt_pk_bf16_f32 v72, v12, v13
    v_cvt_pk_bf16_f32 v73, v14, v15
    v_cvt_pk_bf16_f32 v74, v16, v17
    v_cvt_pk_bf16_f32 v75, v18, v19
    s_waitcnt lgkmcnt(0)
    v_mfma_f32_32x32x16_bf16 v[4:19], v[88:91], v[84:87], v[36:51]
    ds_read_b128 v[92:95], v112 offset:23552
    s_mov_b64 exec, s[30:31]
    ds_read_b128 v[104:107], v113 offset:21504
    ds_read_b128 v[108:111], v113 offset:22016
    s_mov_b64 exec, -1
    v_exp_f32 v20, v20
    v_exp_f32 v21, v21
    v_exp_f32 v22, v22
    v_exp_f32 v23, v23
    v_exp_f32 v24, v24
    v_mfma_f32_32x32x16_bf16 v[52:67], v[96:99], v[68:71], v[52:67]
    v_exp_f32 v25, v25
    v_exp_f32 v26, v26
    v_exp_f32 v27, v27
    v_exp_f32 v28, v28
    v_exp_f32 v29, v29
    v_exp_f32 v30, v30
    v_mfma_f32_32x32x16_bf16 v[52:67], v[100:103], v[72:75], v[52:67]
    v_exp_f32 v31, v31
    v_exp_f32 v32, v32
    v_exp_f32 v33, v33
    v_exp_f32 v34, v34
    v_exp_f32 v35, v35
    v_cvt_pk_bf16_f32 v76, v20, v21
    v_cvt_pk_bf16_f32 v77, v22, v23
    v_cvt_pk_bf16_f32 v78, v24, v25
    v_cvt_pk_bf16_f32 v79, v26, v27
    v_cvt_pk_bf16_f32 v80, v28, v29
    v_cvt_pk_bf16_f32 v81, v30, v31
    v_cvt_pk_bf16_f32 v82, v32, v33
    v_cvt_pk_bf16_f32 v83, v34, v35
    s_waitcnt vmcnt(2)
    s_barrier
    s_waitcnt lgkmcnt(0)
    v_mfma_f32_32x32x16_bf16 v[20:35], v[92:95], v[84:87], v[36:51]
    ds_read_b128 v[88:91], v112 offset:32768
    s_mov_b64 exec, s[30:31]
    ds_read_b128 v[96:99], v113 offset:22528
    ds_read_b128 v[100:103], v113 offset:23040
    s_mov_b64 exec, -1
    v_exp_f32 v4, v4
    v_exp_f32 v5, v5
    v_exp_f32 v6, v6
    v_exp_f32 v7, v7
    v_exp_f32 v8, v8
    v_mfma_f32_32x32x16_bf16 v[52:67], v[104:107], v[76:79], v[52:67]
    v_exp_f32 v9, v9
    v_exp_f32 v10, v10
    v_exp_f32 v11, v11
    v_exp_f32 v12, v12
    v_exp_f32 v13, v13
    v_exp_f32 v14, v14
    v_mfma_f32_32x32x16_bf16 v[52:67], v[108:111], v[80:83], v[52:67]
    v_exp_f32 v15, v15
    v_exp_f32 v16, v16
    v_exp_f32 v17, v17
    v_exp_f32 v18, v18
    v_exp_f32 v19, v19
    v_cvt_pk_bf16_f32 v68, v4, v5
    v_cvt_pk_bf16_f32 v69, v6, v7
    v_cvt_pk_bf16_f32 v70, v8, v9
    v_cvt_pk_bf16_f32 v71, v10, v11
    v_cvt_pk_bf16_f32 v72, v12, v13
    v_cvt_pk_bf16_f32 v73, v14, v15
    v_cvt_pk_bf16_f32 v74, v16, v17
    v_cvt_pk_bf16_f32 v75, v18, v19
    s_waitcnt lgkmcnt(0)
    v_mfma_f32_32x32x16_bf16 v[4:19], v[88:91], v[84:87], v[36:51]
    ds_read_b128 v[92:95], v112 offset:33792
    s_mov_b64 exec, s[30:31]
    ds_read_b128 v[104:107], v113 offset:23552
    ds_read_b128 v[108:111], v113 offset:24064
    s_mov_b64 exec, -1
    v_exp_f32 v20, v20
    v_exp_f32 v21, v21
    v_exp_f32 v22, v22
    v_exp_f32 v23, v23
    v_exp_f32 v24, v24
    v_mfma_f32_32x32x16_bf16 v[52:67], v[96:99], v[68:71], v[52:67]
    v_exp_f32 v25, v25
    v_exp_f32 v26, v26
    v_exp_f32 v27, v27
    v_exp_f32 v28, v28
    v_exp_f32 v29, v29
    v_exp_f32 v30, v30
    v_mfma_f32_32x32x16_bf16 v[52:67], v[100:103], v[72:75], v[52:67]
    v_exp_f32 v31, v31
    v_exp_f32 v32, v32
    v_exp_f32 v33, v33
    v_exp_f32 v34, v34
    v_exp_f32 v35, v35
    v_cvt_pk_bf16_f32 v76, v20, v21
    v_cvt_pk_bf16_f32 v77, v22, v23
    v_cvt_pk_bf16_f32 v78, v24, v25
    v_cvt_pk_bf16_f32 v79, v26, v27
    v_cvt_pk_bf16_f32 v80, v28, v29
    v_cvt_pk_bf16_f32 v81, v30, v31
    v_cvt_pk_bf16_f32 v82, v32, v33
    v_cvt_pk_bf16_f32 v83, v34, v35
    s_waitcnt lgkmcnt(0)
    v_mfma_f32_32x32x16_bf16 v[20:35], v[92:95], v[84:87], v[36:51]
    ds_read_b128 v[88:91], v112 offset:34816
    s_mov_b64 exec, s[30:31]
    ds_read_b128 v[96:99], v113 offset:32768
    ds_read_b128 v[100:103], v113 offset:33280
    s_mov_b64 exec, -1
    v_exp_f32 v4, v4
    v_exp_f32 v5, v5
    v_exp_f32 v6, v6
    v_exp_f32 v7, v7
    v_exp_f32 v8, v8
    v_mfma_f32_32x32x16_bf16 v[52:67], v[104:107], v[76:79], v[52:67]
    v_exp_f32 v9, v9
    v_exp_f32 v10, v10
    v_exp_f32 v11, v11
    v_exp_f32 v12, v12
    v_exp_f32 v13, v13
    v_exp_f32 v14, v14
    v_mfma_f32_32x32x16_bf16 v[52:67], v[108:111], v[80:83], v[52:67]
    v_exp_f32 v15, v15
    v_exp_f32 v16, v16
    v_exp_f32 v17, v17
    v_exp_f32 v18, v18
    v_exp_f32 v19, v19
    v_cvt_pk_bf16_f32 v68, v4, v5
    v_cvt_pk_bf16_f32 v69, v6, v7
    v_cvt_pk_bf16_f32 v70, v8, v9
    v_cvt_pk_bf16_f32 v71, v10, v11
    v_cvt_pk_bf16_f32 v72, v12, v13
    v_cvt_pk_bf16_f32 v73, v14, v15
    v_cvt_pk_bf16_f32 v74, v16, v17
    v_cvt_pk_bf16_f32 v75, v18, v19
    s_waitcnt lgkmcnt(0)
    v_mfma_f32_32x32x16_bf16 v[4:19], v[88:91], v[84:87], v[36:51]
    ds_read_b128 v[92:95], v112 offset:35840
    s_mov_b64 exec, s[30:31]
    ds_read_b128 v[104:107], v113 offset:33792
    ds_read_b128 v[108:111], v113 offset:34304
    s_mov_b64 exec, -1
    v_exp_f32 v20, v20
    v_exp_f32 v21, v21
    v_exp_f32 v22, v22
    v_exp_f32 v23, v23
    v_exp_f32 v24, v24
    v_mfma_f32_32x32x16_bf16 v[52:67], v[96:99], v[68:71], v[52:67]
    v_exp_f32 v25, v25
    v_exp_f32 v26, v26
    v_exp_f32 v27, v27
    v_exp_f32 v28, v28
    v_exp_f32 v29, v29
    v_exp_f32 v30, v30
    v_mfma_f32_32x32x16_bf16 v[52:67], v[100:103], v[72:75], v[52:67]
    v_exp_f32 v31, v31
    v_exp_f32 v32, v32
    v_exp_f32 v33, v33
    v_exp_f32 v34, v34
    v_exp_f32 v35, v35
    v_cvt_pk_bf16_f32 v76, v20, v21
    v_cvt_pk_bf16_f32 v77, v22, v23
    v_cvt_pk_bf16_f32 v78, v24, v25
    v_cvt_pk_bf16_f32 v79, v26, v27
    v_cvt_pk_bf16_f32 v80, v28, v29
    v_cvt_pk_bf16_f32 v81, v30, v31
    v_cvt_pk_bf16_f32 v82, v32, v33
    v_cvt_pk_bf16_f32 v83, v34, v35
    s_waitcnt lgkmcnt(0)
    v_mfma_f32_32x32x16_bf16 v[20:35], v[92:95], v[84:87], v[36:51]
    ds_read_b128 v[88:91], v112 offset:36864
    s_mov_b64 exec, s[30:31]
    ds_read_b128 v[96:99], v113 offset:34816
    ds_read_b128 v[100:103], v113 offset:35328
    s_mov_b64 exec, -1
    v_exp_f32 v4, v4
    v_exp_f32 v5, v5
    v_exp_f32 v6, v6
    v_exp_f32 v7, v7
    v_exp_f32 v8, v8
    v_mfma_f32_32x32x16_bf16 v[52:67], v[104:107], v[76:79], v[52:67]
    v_exp_f32 v9, v9
    v_exp_f32 v10, v10
    v_exp_f32 v11, v11
    v_exp_f32 v12, v12
    v_exp_f32 v13, v13
    v_exp_f32 v14, v14
    v_mfma_f32_32x32x16_bf16 v[52:67], v[108:111], v[80:83], v[52:67]
    v_exp_f32 v15, v15
    v_exp_f32 v16, v16
    v_exp_f32 v17, v17
    v_exp_f32 v18, v18
    v_exp_f32 v19, v19
    v_cvt_pk_bf16_f32 v68, v4, v5
    v_cvt_pk_bf16_f32 v69, v6, v7
    v_cvt_pk_bf16_f32 v70, v8, v9
    v_cvt_pk_bf16_f32 v71, v10, v11
    v_cvt_pk_bf16_f32 v72, v12, v13
    v_cvt_pk_bf16_f32 v73, v14, v15
    v_cvt_pk_bf16_f32 v74, v16, v17
    v_cvt_pk_bf16_f32 v75, v18, v19
    s_waitcnt lgkmcnt(0)
    v_mfma_f32_32x32x16_bf16 v[4:19], v[88:91], v[84:87], v[36:51]
    ds_read_b128 v[92:95], v112 offset:37888
    s_mov_b64 exec, s[30:31]
    ds_read_b128 v[104:107], v113 offset:35840
    ds_read_b128 v[108:111], v113 offset:36352
    s_mov_b64 exec, -1
    v_exp_f32 v20, v20
    v_exp_f32 v21, v21
    v_exp_f32 v22, v22
    v_exp_f32 v23, v23
    v_exp_f32 v24, v24
    v_mfma_f32_32x32x16_bf16 v[52:67], v[96:99], v[68:71], v[52:67]
    v_exp_f32 v25, v25
    v_exp_f32 v26, v26
    v_exp_f32 v27, v27
    v_exp_f32 v28, v28
    v_exp_f32 v29, v29
    v_exp_f32 v30, v30
    v_mfma_f32_32x32x16_bf16 v[52:67], v[100:103], v[72:75], v[52:67]
    v_exp_f32 v31, v31
    v_exp_f32 v32, v32
    v_exp_f32 v33, v33
    v_exp_f32 v34, v34
    v_exp_f32 v35, v35
    v_cvt_pk_bf16_f32 v76, v20, v21
    v_cvt_pk_bf16_f32 v77, v22, v23
    v_cvt_pk_bf16_f32 v78, v24, v25
    v_cvt_pk_bf16_f32 v79, v26, v27
    v_cvt_pk_bf16_f32 v80, v28, v29
    v_cvt_pk_bf16_f32 v81, v30, v31
    v_cvt_pk_bf16_f32 v82, v32, v33
    v_cvt_pk_bf16_f32 v83, v34, v35
    s_waitcnt lgkmcnt(0)
    v_mfma_f32_32x32x16_bf16 v[20:35], v[92:95], v[84:87], v[36:51]
    ds_read_b128 v[88:91], v112 offset:38912
    s_mov_b64 exec, s[30:31]
    ds_read_b128 v[96:99], v113 offset:36864
    ds_read_b128 v[100:103], v113 offset:37376
    s_mov_b64 exec, -1
    v_exp_f32 v4, v4
    v_exp_f32 v5, v5
    v_exp_f32 v6, v6
    v_exp_f32 v7, v7
    v_exp_f32 v8, v8
    v_mfma_f32_32x32x16_bf16 v[52:67], v[104:107], v[76:79], v[52:67]
    v_exp_f32 v9, v9
    v_exp_f32 v10, v10
    v_exp_f32 v11, v11
    v_exp_f32 v12, v12
    v_exp_f32 v13, v13
    v_exp_f32 v14, v14
    v_mfma_f32_32x32x16_bf16 v[52:67], v[108:111], v[80:83], v[52:67]
    v_exp_f32 v15, v15
    v_exp_f32 v16, v16
    v_exp_f32 v17, v17
    v_exp_f32 v18, v18
    v_exp_f32 v19, v19
    v_cvt_pk_bf16_f32 v68, v4, v5
    v_cvt_pk_bf16_f32 v69, v6, v7
    v_cvt_pk_bf16_f32 v70, v8, v9
    v_cvt_pk_bf16_f32 v71, v10, v11
    v_cvt_pk_bf16_f32 v72, v12, v13
    v_cvt_pk_bf16_f32 v73, v14, v15
    v_cvt_pk_bf16_f32 v74, v16, v17
    v_cvt_pk_bf16_f32 v75, v18, v19
    s_waitcnt lgkmcnt(0)
    v_mfma_f32_32x32x16_bf16 v[4:19], v[88:91], v[84:87], v[36:51]
    ds_read_b128 v[92:95], v112 offset:39936
    s_mov_b64 exec, s[30:31]
    ds_read_b128 v[104:107], v113 offset:37888
    ds_read_b128 v[108:111], v113 offset:38400
    s_mov_b64 exec, -1
    v_exp_f32 v20, v20
    v_exp_f32 v21, v21
    v_exp_f32 v22, v22
    v_exp_f32 v23, v23
    v_exp_f32 v24, v24
    v_mfma_f32_32x32x16_bf16 v[52:67], v[96:99], v[68:71], v[52:67]
    v_exp_f32 v25, v25
    v_exp_f32 v26, v26
    v_exp_f32 v27, v27
    v_exp_f32 v28, v28
    v_exp_f32 v29, v29
    v_exp_f32 v30, v30
    v_mfma_f32_32x32x16_bf16 v[52:67], v[100:103], v[72:75], v[52:67]
    v_exp_f32 v31, v31
    v_exp_f32 v32, v32
    v_exp_f32 v33, v33
    v_exp_f32 v34, v34
    v_exp_f32 v35, v35
    v_cvt_pk_bf16_f32 v76, v20, v21
    v_cvt_pk_bf16_f32 v77, v22, v23
    v_cvt_pk_bf16_f32 v78, v24, v25
    v_cvt_pk_bf16_f32 v79, v26, v27
    v_cvt_pk_bf16_f32 v80, v28, v29
    v_cvt_pk_bf16_f32 v81, v30, v31
    v_cvt_pk_bf16_f32 v82, v32, v33
    v_cvt_pk_bf16_f32 v83, v34, v35
    s_waitcnt vmcnt(0)
    s_barrier
    s_waitcnt lgkmcnt(0)
    v_mfma_f32_32x32x16_bf16 v[20:35], v[92:95], v[84:87], v[36:51]
    ds_read_b128 v[88:91], v112 offset:49152
    s_mov_b64 exec, s[30:31]
    ds_read_b128 v[96:99], v113 offset:38912
    ds_read_b128 v[100:103], v113 offset:39424
    s_mov_b64 exec, -1
    v_exp_f32 v4, v4
    v_exp_f32 v5, v5
    v_exp_f32 v6, v6
    v_exp_f32 v7, v7
    v_exp_f32 v8, v8
    v_mfma_f32_32x32x16_bf16 v[52:67], v[104:107], v[76:79], v[52:67]
    v_exp_f32 v9, v9
    v_exp_f32 v10, v10
    v_exp_f32 v11, v11
    v_exp_f32 v12, v12
    v_exp_f32 v13, v13
    v_exp_f32 v14, v14
    v_mfma_f32_32x32x16_bf16 v[52:67], v[108:111], v[80:83], v[52:67]
    v_exp_f32 v15, v15
    v_exp_f32 v16, v16
    v_exp_f32 v17, v17
    v_exp_f32 v18, v18
    v_exp_f32 v19, v19
    v_cvt_pk_bf16_f32 v68, v4, v5
    v_cvt_pk_bf16_f32 v69, v6, v7
    v_cvt_pk_bf16_f32 v70, v8, v9
    v_cvt_pk_bf16_f32 v71, v10, v11
    v_cvt_pk_bf16_f32 v72, v12, v13
    v_cvt_pk_bf16_f32 v73, v14, v15
    v_cvt_pk_bf16_f32 v74, v16, v17
    v_cvt_pk_bf16_f32 v75, v18, v19
    s_waitcnt lgkmcnt(0)
    v_mfma_f32_32x32x16_bf16 v[4:19], v[88:91], v[84:87], v[36:51]
    ds_read_b128 v[92:95], v112 offset:50176
    s_mov_b64 exec, s[30:31]
    ds_read_b128 v[104:107], v113 offset:39936
    ds_read_b128 v[108:111], v113 offset:40448
    s_mov_b64 exec, -1
    v_exp_f32 v20, v20
    v_exp_f32 v21, v21
    v_exp_f32 v22, v22
    v_exp_f32 v23, v23
    v_exp_f32 v24, v24
    v_mfma_f32_32x32x16_bf16 v[52:67], v[96:99], v[68:71], v[52:67]
    v_exp_f32 v25, v25
    v_exp_f32 v26, v26
    v_exp_f32 v27, v27
    v_exp_f32 v28, v28
    v_exp_f32 v29, v29
    v_exp_f32 v30, v30
    v_mfma_f32_32x32x16_bf16 v[52:67], v[100:103], v[72:75], v[52:67]
    v_exp_f32 v31, v31
    v_exp_f32 v32, v32
    v_exp_f32 v33, v33
    v_exp_f32 v34, v34
    v_exp_f32 v35, v35
    v_cvt_pk_bf16_f32 v76, v20, v21
    v_cvt_pk_bf16_f32 v77, v22, v23
    v_cvt_pk_bf16_f32 v78, v24, v25
    v_cvt_pk_bf16_f32 v79, v26, v27
    v_cvt_pk_bf16_f32 v80, v28, v29
    v_cvt_pk_bf16_f32 v81, v30, v31
    v_cvt_pk_bf16_f32 v82, v32, v33
    v_cvt_pk_bf16_f32 v83, v34, v35
    s_waitcnt lgkmcnt(0)
    v_mfma_f32_32x32x16_bf16 v[20:35], v[92:95], v[84:87], v[36:51]
    ds_read_b128 v[88:91], v112 offset:51200
    s_mov_b64 exec, s[30:31]
    ds_read_b128 v[96:99], v113 offset:49152
    ds_read_b128 v[100:103], v113 offset:49664
    s_mov_b64 exec, -1
    v_exp_f32 v4, v4
    v_exp_f32 v5, v5
    v_exp_f32 v6, v6
    v_exp_f32 v7, v7
    v_exp_f32 v8, v8
    v_mfma_f32_32x32x16_bf16 v[52:67], v[104:107], v[76:79], v[52:67]
    v_exp_f32 v9, v9
    v_exp_f32 v10, v10
    v_exp_f32 v11, v11
    v_exp_f32 v12, v12
    v_exp_f32 v13, v13
    v_exp_f32 v14, v14
    v_mfma_f32_32x32x16_bf16 v[52:67], v[108:111], v[80:83], v[52:67]
    v_exp_f32 v15, v15
    v_exp_f32 v16, v16
    v_exp_f32 v17, v17
    v_exp_f32 v18, v18
    v_exp_f32 v19, v19
    v_cvt_pk_bf16_f32 v68, v4, v5
    v_cvt_pk_bf16_f32 v69, v6, v7
    v_cvt_pk_bf16_f32 v70, v8, v9
    v_cvt_pk_bf16_f32 v71, v10, v11
    v_cvt_pk_bf16_f32 v72, v12, v13
    v_cvt_pk_bf16_f32 v73, v14, v15
    v_cvt_pk_bf16_f32 v74, v16, v17
    v_cvt_pk_bf16_f32 v75, v18, v19
    s_waitcnt lgkmcnt(0)
    v_mfma_f32_32x32x16_bf16 v[4:19], v[88:91], v[84:87], v[36:51]
    ds_read_b128 v[92:95], v112 offset:52224
    s_mov_b64 exec, s[30:31]
    ds_read_b128 v[104:107], v113 offset:50176
    ds_read_b128 v[108:111], v113 offset:50688
    s_mov_b64 exec, -1
    v_exp_f32 v20, v20
    v_exp_f32 v21, v21
    v_exp_f32 v22, v22
    v_exp_f32 v23, v23
    v_exp_f32 v24, v24
    v_mfma_f32_32x32x16_bf16 v[52:67], v[96:99], v[68:71], v[52:67]
    v_exp_f32 v25, v25
    v_exp_f32 v26, v26
    v_exp_f32 v27, v27
    v_exp_f32 v28, v28
    v_exp_f32 v29, v29
    v_exp_f32 v30, v30
    v_mfma_f32_32x32x16_bf16 v[52:67], v[100:103], v[72:75], v[52:67]
    v_exp_f32 v31, v31
    v_exp_f32 v32, v32
    v_exp_f32 v33, v33
    v_exp_f32 v34, v34
    v_exp_f32 v35, v35
    v_cvt_pk_bf16_f32 v76, v20, v21
    v_cvt_pk_bf16_f32 v77, v22, v23
    v_cvt_pk_bf16_f32 v78, v24, v25
    v_cvt_pk_bf16_f32 v79, v26, v27
    v_cvt_pk_bf16_f32 v80, v28, v29
    v_cvt_pk_bf16_f32 v81, v30, v31
    v_cvt_pk_bf16_f32 v82, v32, v33
    v_cvt_pk_bf16_f32 v83, v34, v35
    s_waitcnt lgkmcnt(0)
    v_mfma_f32_32x32x16_bf16 v[20:35], v[92:95], v[84:87], v[36:51]
    ds_read_b128 v[88:91], v112 offset:53248
    s_mov_b64 exec, s[30:31]
    ds_read_b128 v[96:99], v113 offset:51200
    ds_read_b128 v[100:103], v113 offset:51712
    s_mov_b64 exec, -1
    v_exp_f32 v4, v4
    v_exp_f32 v5, v5
    v_exp_f32 v6, v6
    v_exp_f32 v7, v7
    v_exp_f32 v8, v8
    v_mfma_f32_32x32x16_bf16 v[52:67], v[104:107], v[76:79], v[52:67]
    v_exp_f32 v9, v9
    v_exp_f32 v10, v10
    v_exp_f32 v11, v11
    v_exp_f32 v12, v12
    v_exp_f32 v13, v13
    v_exp_f32 v14, v14
    v_mfma_f32_32x32x16_bf16 v[52:67], v[108:111], v[80:83], v[52:67]
    v_exp_f32 v15, v15
    v_exp_f32 v16, v16
    v_exp_f32 v17, v17
    v_exp_f32 v18, v18
    v_exp_f32 v19, v19
    v_cvt_pk_bf16_f32 v68, v4, v5
    v_cvt_pk_bf16_f32 v69, v6, v7
    v_cvt_pk_bf16_f32 v70, v8, v9
    v_cvt_pk_bf16_f32 v71, v10, v11
    v_cvt_pk_bf16_f32 v72, v12, v13
    v_cvt_pk_bf16_f32 v73, v14, v15
    v_cvt_pk_bf16_f32 v74, v16, v17
    v_cvt_pk_bf16_f32 v75, v18, v19
    s_waitcnt lgkmcnt(0)
    v_mfma_f32_32x32x16_bf16 v[4:19], v[88:91], v[84:87], v[36:51]
    ds_read_b128 v[92:95], v112 offset:54272
    s_mov_b64 exec, s[30:31]
    ds_read_b128 v[104:107], v113 offset:52224
    ds_read_b128 v[108:111], v113 offset:52736
    s_mov_b64 exec, -1
    v_exp_f32 v20, v20
    v_exp_f32 v21, v21
    v_exp_f32 v22, v22
    v_exp_f32 v23, v23
    v_exp_f32 v24, v24
    v_mfma_f32_32x32x16_bf16 v[52:67], v[96:99], v[68:71], v[52:67]
    v_exp_f32 v25, v25
    v_exp_f32 v26, v26
    v_exp_f32 v27, v27
    v_exp_f32 v28, v28
    v_exp_f32 v29, v29
    v_exp_f32 v30, v30
    v_mfma_f32_32x32x16_bf16 v[52:67], v[100:103], v[72:75], v[52:67]
    v_exp_f32 v31, v31
    v_exp_f32 v32, v32
    v_exp_f32 v33, v33
    v_exp_f32 v34, v34
    v_exp_f32 v35, v35
    v_cvt_pk_bf16_f32 v76, v20, v21
    v_cvt_pk_bf16_f32 v77, v22, v23
    v_cvt_pk_bf16_f32 v78, v24, v25
    v_cvt_pk_bf16_f32 v79, v26, v27
    v_cvt_pk_bf16_f32 v80, v28, v29
    v_cvt_pk_bf16_f32 v81, v30, v31
    v_cvt_pk_bf16_f32 v82, v32, v33
    v_cvt_pk_bf16_f32 v83, v34, v35
    s_waitcnt lgkmcnt(0)
    v_mfma_f32_32x32x16_bf16 v[20:35], v[92:95], v[84:87], v[36:51]
    ds_read_b128 v[88:91], v112 offset:55296
    s_mov_b64 exec, s[30:31]
    ds_read_b128 v[96:99], v113 offset:53248
    ds_read_b128 v[100:103], v113 offset:53760
    s_mov_b64 exec, -1
    v_exp_f32 v4, v4
    v_exp_f32 v5, v5
    v_exp_f32 v6, v6
    v_exp_f32 v7, v7
    v_exp_f32 v8, v8
    v_mfma_f32_32x32x16_bf16 v[52:67], v[104:107], v[76:79], v[52:67]
    v_exp_f32 v9, v9
    v_exp_f32 v10, v10
    v_exp_f32 v11, v11
    v_exp_f32 v12, v12
    v_exp_f32 v13, v13
    v_exp_f32 v14, v14
    v_mfma_f32_32x32x16_bf16 v[52:67], v[108:111], v[80:83], v[52:67]
    v_exp_f32 v15, v15
    v_exp_f32 v16, v16
    v_exp_f32 v17, v17
    v_exp_f32 v18, v18
    v_exp_f32 v19, v19
    v_cvt_pk_bf16_f32 v68, v4, v5
    v_cvt_pk_bf16_f32 v69, v6, v7
    v_cvt_pk_bf16_f32 v70, v8, v9
    v_cvt_pk_bf16_f32 v71, v10, v11
    v_cvt_pk_bf16_f32 v72, v12, v13
    v_cvt_pk_bf16_f32 v73, v14, v15
    v_cvt_pk_bf16_f32 v74, v16, v17
    v_cvt_pk_bf16_f32 v75, v18, v19
    s_waitcnt lgkmcnt(0)
    v_mfma_f32_32x32x16_bf16 v[4:19], v[88:91], v[84:87], v[36:51]
    ds_read_b128 v[92:95], v112 offset:56320
    s_mov_b64 exec, s[30:31]
    ds_read_b128 v[104:107], v113 offset:54272
    ds_read_b128 v[108:111], v113 offset:54784
    s_mov_b64 exec, -1
    v_exp_f32 v20, v20
    v_exp_f32 v21, v21
    v_exp_f32 v22, v22
    v_exp_f32 v23, v23
    v_exp_f32 v24, v24
    v_mfma_f32_32x32x16_bf16 v[52:67], v[96:99], v[68:71], v[52:67]
    v_exp_f32 v25, v25
    v_exp_f32 v26, v26
    v_exp_f32 v27, v27
    v_exp_f32 v28, v28
    v_exp_f32 v29, v29
    v_exp_f32 v30, v30
    v_mfma_f32_32x32x16_bf16 v[52:67], v[100:103], v[72:75], v[52:67]
    v_exp_f32 v31, v31
    v_exp_f32 v32, v32
    v_exp_f32 v33, v33
    v_exp_f32 v34, v34
    v_exp_f32 v35, v35
    v_cvt_pk_bf16_f32 v76, v20, v21
    v_cvt_pk_bf16_f32 v77, v22, v23
    v_cvt_pk_bf16_f32 v78, v24, v25
    v_cvt_pk_bf16_f32 v79, v26, v27
    v_cvt_pk_bf16_f32 v80, v28, v29
    v_cvt_pk_bf16_f32 v81, v30, v31
    v_cvt_pk_bf16_f32 v82, v32, v33
    v_cvt_pk_bf16_f32 v83, v34, v35
    s_waitcnt lgkmcnt(0)
    v_mfma_f32_32x32x16_bf16 v[20:35], v[92:95], v[84:87], v[36:51]
    s_mov_b64 exec, s[30:31]
    ds_read_b128 v[96:99], v113 offset:55296
    ds_read_b128 v[100:103], v113 offset:55808
    s_mov_b64 exec, -1
    v_exp_f32 v4, v4
    v_exp_f32 v5, v5
    v_exp_f32 v6, v6
    v_exp_f32 v7, v7
    v_exp_f32 v8, v8
    v_mfma_f32_32x32x16_bf16 v[52:67], v[104:107], v[76:79], v[52:67]
    v_exp_f32 v9, v9
    v_exp_f32 v10, v10
    v_exp_f32 v11, v11
    v_exp_f32 v12, v12
    v_exp_f32 v13, v13
    v_exp_f32 v14, v14
    v_mfma_f32_32x32x16_bf16 v[52:67], v[108:111], v[80:83], v[52:67]
    v_exp_f32 v15, v15
    v_exp_f32 v16, v16
    v_exp_f32 v17, v17
    v_exp_f32 v18, v18
    v_exp_f32 v19, v19
    v_cvt_pk_bf16_f32 v68, v4, v5
    v_cvt_pk_bf16_f32 v69, v6, v7
    v_cvt_pk_bf16_f32 v70, v8, v9
    v_cvt_pk_bf16_f32 v71, v10, v11
    v_cvt_pk_bf16_f32 v72, v12, v13
    v_cvt_pk_bf16_f32 v73, v14, v15
    v_cvt_pk_bf16_f32 v74, v16, v17
    v_cvt_pk_bf16_f32 v75, v18, v19
    s_waitcnt lgkmcnt(0)
    s_mov_b64 exec, s[30:31]
    ds_read_b128 v[104:107], v113 offset:56320
    ds_read_b128 v[108:111], v113 offset:56832
    s_mov_b64 exec, -1
    v_exp_f32 v20, v20
    v_exp_f32 v21, v21
    v_exp_f32 v22, v22
    v_exp_f32 v23, v23
    v_exp_f32 v24, v24
    v_mfma_f32_32x32x16_bf16 v[52:67], v[96:99], v[68:71], v[52:67]
    v_exp_f32 v25, v25
    v_exp_f32 v26, v26
    v_exp_f32 v27, v27
    v_exp_f32 v28, v28
    v_exp_f32 v29, v29
    v_exp_f32 v30, v30
    v_mfma_f32_32x32x16_bf16 v[52:67], v[100:103], v[72:75], v[52:67]
    v_exp_f32 v31, v31
    v_exp_f32 v32, v32
    v_exp_f32 v33, v33
    v_exp_f32 v34, v34
    v_exp_f32 v35, v35
    v_cvt_pk_bf16_f32 v76, v20, v21
    v_cvt_pk_bf16_f32 v77, v22, v23
    v_cvt_pk_bf16_f32 v78, v24, v25
    v_cvt_pk_bf16_f32 v79, v26, v27
    v_cvt_pk_bf16_f32 v80, v28, v29
    v_cvt_pk_bf16_f32 v81, v30, v31
    v_cvt_pk_bf16_f32 v82, v32, v33
    v_cvt_pk_bf16_f32 v83, v34, v35
    s_waitcnt lgkmcnt(0)
    s_nop 1
    v_mfma_f32_32x32x16_bf16 v[52:67], v[104:107], v[76:79], v[52:67]
    v_mfma_f32_32x32x16_bf16 v[52:67], v[108:111], v[80:83], v[52:67]
    s_nop 15
    v_mov_b32 v117, v60
    s_nop 1
    v_permlane32_swap_b32 v117, v60
    s_nop 1
    v_cmp_nle_f32 vcc, 0x12800000, v117
    s_cbranch_vccz Lnorm_1
    v_mov_b32 v118, 0xff7fffff
    v_mov_b32 v52, 0
    v_mov_b32 v53, 0
    v_mov_b32 v54, 0
    v_mov_b32 v55, 0
    v_mov_b32 v56, 0
    v_mov_b32 v57, 0
    v_mov_b32 v58, 0
    v_mov_b32 v59, 0
    v_mov_b32 v60, 0
    v_mov_b32 v61, 0
    v_mov_b32 v62, 0
    v_mov_b32 v63, 0
    v_mov_b32 v64, 0
    v_mov_b32 v65, 0
    v_mov_b32 v66, 0
    v_mov_b32 v67, 0
    v_subrev_u32 v120, 8192, v113
    s_mov_b32 s40, 0
    s_mov_b32 s37, s27
Lfb_2:
    buffer_load_dwordx4 v[88:91], v112, s[12:15], s37 offen
    s_mov_b64 exec, s[30:31]
    buffer_load_dwordx4 v[96:99], v120, s[16:19], s37 offen
    buffer_load_dwordx4 v[100:103], v120, s[16:19], s37 offen offset:512
    s_mov_b64 exec, -1
    s_waitcnt vmcnt(0)
    s_nop 1
    v_mfma_f32_32x32x16_bf16 v[4:19], v[88:91], v[84:87], 0
    s_nop 15
    v_max3_f32 v116, v4, v5, v6
    v_max3_f32 v116, v116, v7, v8
    v_max3_f32 v116, v116, v9, v10
    v_max3_f32 v116, v116, v11, v12
    v_max3_f32 v116, v116, v13, v14
    v_max3_f32 v116, v116, v15, v16
    v_max3_f32 v116, v116, v17, v18
    v_max_f32 v116, v116, v19
    v_mov_b32 v117, v116
    s_nop 1
    v_permlane32_swap_b32 v117, v116
    s_nop 1
    v_max3_f32 v116, v116, v117, v118
    v_sub_f32 v117, v118, v116
    v_exp_f32 v117, v117
    v_mov_b32 v118, v116
    v_mul_f32 v52, v52, v117
    v_mul_f32 v53, v53, v117
    v_mul_f32 v54, v54, v117
    v_mul_f32 v55, v55, v117
    v_mul_f32 v56, v56, v117
    v_mul_f32 v57, v57, v117
    v_mul_f32 v58, v58, v117
    v_mul_f32 v59, v59, v117
    v_mul_f32 v60, v60, v117
    v_sub_f32 v4, v4, v118
    v_exp_f32 v4, v4
    v_sub_f32 v5, v5, v118
    v_exp_f32 v5, v5
    v_sub_f32 v6, v6, v118
    v_exp_f32 v6, v6
    v_sub_f32 v7, v7, v118
    v_exp_f32 v7, v7
    v_sub_f32 v8, v8, v118
    v_exp_f32 v8, v8
    v_sub_f32 v9, v9, v118
    v_exp_f32 v9, v9
    v_sub_f32 v10, v10, v118
    v_exp_f32 v10, v10
    v_sub_f32 v11, v11, v118
    v_exp_f32 v11, v11
    v_sub_f32 v12, v12, v118
    v_exp_f32 v12, v12
    v_sub_f32 v13, v13, v118
    v_exp_f32 v13, v13
    v_sub_f32 v14, v14, v118
    v_exp_f32 v14, v14
    v_sub_f32 v15, v15, v118
    v_exp_f32 v15, v15
    v_sub_f32 v16, v16, v118
    v_exp_f32 v16, v16
    v_sub_f32 v17, v17, v118
    v_exp_f32 v17, v17
    v_sub_f32 v18, v18, v118
    v_exp_f32 v18, v18
    v_sub_f32 v19, v19, v118
    v_exp_f32 v19, v19
    s_nop 0
    v_cvt_pk_bf16_f32 v68, v4, v5
    v_cvt_pk_bf16_f32 v69, v6, v7
    v_cvt_pk_bf16_f32 v70, v8, v9
    v_cvt_pk_bf16_f32 v71, v10, v11
    v_cvt_pk_bf16_f32 v72, v12, v13
    v_cvt_pk_bf16_f32 v73, v14, v15
    v_cvt_pk_bf16_f32 v74, v16, v17
    v_cvt_pk_bf16_f32 v75, v18, v19
    s_nop 1
    v_mfma_f32_32x32x16_bf16 v[52:67], v[96:99], v[68:71], v[52:67]
    v_mfma_f32_32x32x16_bf16 v[52:67], v[100:103], v[72:75], v[52:67]
    s_nop 15
    s_add_u32 s37, s37, 1024
    s_add_u32 s40, s40, 1
    s_cmp_lt_u32 s40, 64
    s_cbranch_scc1 Lfb_2
    v_mov_b32 v117, v60
    s_nop 1
    v_permlane32_swap_b32 v117, v60
    s_nop 1
Lnorm_1:
    v_rcp_f32 v118, v117
    s_nop 0
    v_mul_f32 v52, v52, v118
    v_mul_f32 v53, v53, v118
    v_mul_f32 v54, v54, v118
    v_mul_f32 v55, v55, v118
    v_mul_f32 v56, v56, v118
    v_mul_f32 v57, v57, v118
    v_mul_f32 v58, v58, v118
    v_mul_f32 v59, v59, v118
    v_cvt_pk_bf16_f32 v68, v52, v53
    v_cvt_pk_bf16_f32 v69, v54, v55
    v_cvt_pk_bf16_f32 v70, v56, v57
    v_cvt_pk_bf16_f32 v71, v58, v59
    v_lshlrev_b32 v116, 4, v114
    s_lshl_b32 s32, s26, 3
    s_add_u32 s32, s32, s24
    s_lshl_b32 s32, s32, 5
    s_add_u32 s32, s32, s25
    s_lshl_b32 s32, s32, 10
    buffer_store_dwordx4 v[68:71], v116, s[20:23], s32 offen
    s_endpgm
k2_role_F2:
    s_sub_u32 s3, s2, 256
    s_load_dwordx2 s[6:7], s[0:1], 48
    s_load_dwordx2 s[8:9], s[0:1], 88
    s_load_dwordx2 s[10:11], s[0:1], 56
    v_lshrrev_b32 v44, 6, v0
    v_and_b32 v41, 63, v0
    s_nop 0
    v_readfirstlane_b32 s28, v44
    v_lshrrev_b32 v42, 5, v41
    v_and_b32 v43, 31, v41
    s_and_b32 s32, s3, 31
    s_lshr_b32 s33, s3, 5
    s_and_b32 s31, s28, 1
    s_lshr_b32 s46, s28, 1
    s_and_b32 s29, s46, 1
    s_lshr_b32 s30, s46, 1
    s_waitcnt lgkmcnt(0)
    s_add_u32 s4, s8, 6291456
    s_addc_u32 s5, s9, 0
    s_mov_b32 s12, s4
    s_mov_b32 s13, s5
    s_mov_b32 s14, 7340032
    s_mov_b32 s15, 0x00020000
    s_mul_i32 s46, s33, 128
    s_add_u32 s46, s46, 0
    s_add_u32 s6, s6, s46
    s_addc_u32 s7, s7, 0
    s_sub_u32 s47, 1835008, s46
    s_mov_b32 s16, s6
    s_mov_b32 s17, s7
    s_mov_b32 s18, s47
    s_mov_b32 s19, 0x00020000
    s_add_u32 s46, s8, 15728640
    s_addc_u32 s47, s9, 0
    s_mov_b32 s20, s46
    s_mov_b32 s21, s47
    s_mov_b32 s22, 2097152
    s_mov_b32 s23, 0x00020000
    s_mov_b32 s24, s10
    s_mov_b32 s25, s11
    s_mov_b32 s26, 1024
    s_mov_b32 s27, 0x00020000
    v_lshrrev_b32 v44, 3, v41
    v_and_b32 v45, 7, v41
    s_mul_i32 s46, s28, 8
    s_mov_b32 s47, 3584
    v_add_u32 v46, s46, v44
    v_lshrrev_b32 v46, 1, v46
    v_and_b32 v46, 7, v46
    v_xor_b32 v46, v46, v45
    v_lshlrev_b32 v46, 4, v46
    v_mul_lo_u32 v47, v44, s47
    v_add_u32 v39, v46, v47
    s_mul_i32 s48, s32, 64
    s_add_u32 s48, s48, s46
    s_add_u32 s49, s48, 0
    s_mul_i32 s34, s49, 3584
    s_mul_i32 s36, s28, 1024
    v_lshrrev_b32 v44, 3, v41
    v_and_b32 v45, 7, v41
    v_lshrrev_b32 v46, 1, v44
    v_and_b32 v46, 1, v46
    v_lshlrev_b32 v46, 2, v46
    v_xor_b32 v45, v45, v46
    v_lshlrev_b32 v45, 4, v45
    s_mov_b32 s47, 1024
    v_mul_lo_u32 v47, v44, s47
    v_add_u32 v40, v45, v47
    s_mul_i32 s48, s28, 8
    s_add_u32 s48, s48, 0
    s_mul_i32 s35, s48, 1024
    s_mul_i32 s37, s28, 1024
    s_add_u32 s37, s37, 8192
    s_mov_b32 s42, 128
    s_mov_b32 s43, 4294963840
    s_mov_b32 s44, 65536
    s_mov_b32 s45, 4293197824
    s_mul_i32 s46, s32, 3
    s_add_u32 s46, s46, s33
    s_lshl_b32 s46, s46, 0
    s_and_b32 s38, s46, 65535
    s_cmp_ge_u32 s38, 28
    s_cselect_b32 s47, 28, 0
    s_sub_u32 s38, s38, s47
    s_cmp_ge_u32 s38, 28
    s_cselect_b32 s47, 28, 0
    s_sub_u32 s38, s38, s47
    s_cmp_ge_u32 s38, 28
    s_cselect_b32 s47, 28, 0
    s_sub_u32 s38, s38, s47
    s_cmp_ge_u32 s38, 28
    s_cselect_b32 s47, 28, 0
    s_sub_u32 s38, s38, s47
    s_mov_b32 s39, s38
    s_mul_i32 s47, s38, 128
    s_add_u32 s34, s34, s47
    s_mul_i32 s47, s38, 65536
    s_add_u32 s35, s35, s47
    v_lshlrev_b32 v48, 3, v42
    s_mul_i32 s50, s33, 128
    s_mul_i32 s51, s30, 64
    s_add_u32 s50, s50, s51
    buffer_load_dwordx2 v[28:29], v48, s[24:27], s50 offen offset:0
    buffer_load_dwordx2 v[30:31], v48, s[24:27], s50 offen offset:16
    buffer_load_dwordx2 v[32:33], v48, s[24:27], s50 offen offset:32
    buffer_load_dwordx2 v[34:35], v48, s[24:27], s50 offen offset:48
    s_add_u32 s38, s38, 1
    s_cmp_eq_u32 s38, 28
    s_cselect_b32 s40, s43, s42
    s_cselect_b32 s38, 0, s38
    s_add_u32 s39, s39, 1
    s_cmp_eq_u32 s39, 28
    s_cselect_b32 s41, s45, s44
    s_cselect_b32 s39, 0, s39
    s_add_u32 m0, s36, 0
    s_nop 0
    buffer_load_dwordx4 v39, s[12:15], s34 offen lds
    s_add_u32 s34, s34, s40
    s_add_u32 m0, s37, 0
    s_nop 0
    buffer_load_dwordx4 v40, s[16:19], s35 offen lds
    s_add_u32 s35, s35, s41
    s_add_u32 s38, s38, 1
    s_cmp_eq_u32 s38, 28
    s_cselect_b32 s40, s43, s42
    s_cselect_b32 s38, 0, s38
    s_add_u32 s39, s39, 1
    s_cmp_eq_u32 s39, 28
    s_cselect_b32 s41, s45, s44
    s_cselect_b32 s39, 0, s39
    s_add_u32 m0, s36, 16384
    s_nop 0
    buffer_load_dwordx4 v39, s[12:15], s34 offen lds
    s_add_u32 s34, s34, s40
    s_add_u32 m0, s37, 16384
    s_nop 0
    buffer_load_dwordx4 v40, s[16:19], s35 offen lds
    s_add_u32 s35, s35, s41
    s_add_u32 s38, s38, 1
    s_cmp_eq_u32 s38, 28
    s_cselect_b32 s40, s43, s42
    s_cselect_b32 s38, 0, s38
    s_add_u32 s39, s39, 1
    s_cmp_eq_u32 s39, 28
    s_cselect_b32 s41, s45, s44
    s_cselect_b32 s39, 0, s39
    s_add_u32 m0, s36, 32768
    s_nop 0
    buffer_load_dwordx4 v39, s[12:15], s34 offen lds
    s_add_u32 s34, s34, s40
    s_add_u32 m0, s37, 32768
    s_nop 0
    buffer_load_dwordx4 v40, s[16:19], s35 offen lds
    s_add_u32 s35, s35, s41
    s_add_u32 s38, s38, 1
    s_cmp_eq_u32 s38, 28
    s_cselect_b32 s40, s43, s42
    s_cselect_b32 s38, 0, s38
    s_add_u32 s39, s39, 1
    s_cmp_eq_u32 s39, 28
    s_cselect_b32 s41, s45, s44
    s_cselect_b32 s39, 0, s39
    s_add_u32 m0, s36, 49152
    s_nop 0
    buffer_load_dwordx4 v39, s[12:15], s34 offen lds
    s_add_u32 s34, s34, s40
    s_add_u32 m0, s37, 49152
    s_nop 0
    buffer_load_dwordx4 v40, s[16:19], s35 offen lds
    s_add_u32 s35, s35, s41
    s_mul_i32 s46, s29, 4096
    v_mul_u32_u24 v44, 128, v43
    v_add_u32 v44, s46, v44
    v_mov_b32 v45, v43
    v_lshrrev_b32 v45, 1, v45
    v_and_b32 v45, 7, v45
    s_lshl_b32 s47, s31, 1
    v_add_u32 v46, s47, v42
    v_add_u32 v47, 0, v46
    v_xor_b32 v47, v47, v45
    v_lshlrev_b32 v47, 4, v47
    v_add_u32 v36, v44, v47
    v_add_u32 v47, 4, v46
    v_xor_b32 v47, v47, v45
    v_lshlrev_b32 v47, 4, v47
    v_add_u32 v37, v44, v47
    v_and_b32 v44, 15, v41
    v_lshrrev_b32 v44, 2, v44
    v_mul_u32_u24 v45, 16, v42
    v_add_u32 v45, v45, v44
    s_mov_b32 s46, 0
    s_cmp_eq_u32 s31, 1
    s_cselect_b32 s46, 4, s46
    v_add_u32 v45, s46, v45
    v_mul_u32_u24 v45, 128, v45
    v_lshrrev_b32 v46, 1, v44
    v_lshlrev_b32 v46, 2, v46
    v_lshrrev_b32 v47, 4, v41
    v_and_b32 v47, 1, v47
    v_lshlrev_b32 v47, 1, v47
    v_and_b32 v48, 3, v41
    v_lshrrev_b32 v49, 1, v48
    v_add_u32 v47, v47, v49
    s_mul_i32 s46, s30, 4
    v_add_u32 v47, s46, v47
    v_and_b32 v48, 1, v48
    v_lshlrev_b32 v48, 3, v48
    v_add_u32 v48, v48, v45
    v_add_u32 v48, 8192, v48
    v_add_u32 v49, 0, v47
    v_xor_b32 v49, v49, v46
    v_lshlrev_b32 v49, 4, v49
    v_add_u32 v38, v48, v49
    s_waitcnt vmcnt(8)
    s_cmp_eq_u32 s31, 0
    s_cbranch_scc1 Lz_3
    v_mov_b32 v28, 0
    v_mov_b32 v29, 0
    v_mov_b32 v30, 0
    v_mov_b32 v31, 0
    v_mov_b32 v32, 0
    v_mov_b32 v33, 0
    v_mov_b32 v34, 0
    v_mov_b32 v35, 0
Lz_3:
    v_lshlrev_b32 v4, 16, v28
    v_and_b32 v5, 0xffff0000, v28
    v_lshlrev_b32 v6, 16, v29
    v_and_b32 v7, 0xffff0000, v29
    v_lshlrev_b32 v8, 16, v30
    v_and_b32 v9, 0xffff0000, v30
    v_lshlrev_b32 v10, 16, v31
    v_and_b32 v11, 0xffff0000, v31
    v_lshlrev_b32 v12, 16, v32
    v_and_b32 v13, 0xffff0000, v32
    v_lshlrev_b32 v14, 16, v33
    v_and_b32 v15, 0xffff0000, v33
    v_lshlrev_b32 v16, 16, v34
    v_and_b32 v17, 0xffff0000, v34
    v_lshlrev_b32 v18, 16, v35
    v_and_b32 v19, 0xffff0000, v35
    s_waitcnt vmcnt(6)
    s_barrier
    ds_read_b128 v[20:23], v36 offset:0
    ds_read_b64_tr_b16 v[28:29], v38 offset:0
    ds_read_b64_tr_b16 v[30:31], v38 offset:1024
    s_waitcnt vmcnt(4)
    s_barrier
    s_add_u32 s38, s38, 1
    s_cmp_eq_u32 s38, 28
    s_cselect_b32 s40, s43, s42
    s_cselect_b32 s38, 0, s38
    s_add_u32 s39, s39, 1
    s_cmp_eq_u32 s39, 28
    s_cselect_b32 s41, s45, s44
    s_cselect_b32 s39, 0, s39
    s_add_u32 m0, s36, 65536
    s_nop 0
    buffer_load_dwordx4 v39, s[12:15], s34 offen lds
    s_add_u32 s34, s34, s40
    s_add_u32 m0, s37, 65536
    s_nop 0
    buffer_load_dwordx4 v40, s[16:19], s35 offen lds
    s_add_u32 s35, s35, s41
    ds_read_b128 v[24:27], v37 offset:0
    ds_read_b64_tr_b16 v[32:33], v38 offset:4096
    ds_read_b64_tr_b16 v[34:35], v38 offset:5120
    s_waitcnt lgkmcnt(3)
    v_mfma_f32_32x32x16_bf16 v[4:19], v[28:31], v[20:23], v[4:19]
    v_add_u32 v36, 16384, v36
    v_add_u32 v37, 16384, v37
    v_add_u32 v38, 16384, v38
    ds_read_b128 v[20:23], v36 offset:0
    ds_read_b64_tr_b16 v[28:29], v38 offset:0
    ds_read_b64_tr_b16 v[30:31], v38 offset:1024
    s_waitcnt lgkmcnt(3)
    v_mfma_f32_32x32x16_bf16 v[4:19], v[32:35], v[24:27], v[4:19]
    s_waitcnt vmcnt(4)
    s_barrier
    s_add_u32 s38, s38, 1
    s_cmp_eq_u32 s38, 28
    s_cselect_b32 s40, s43, s42
    s_cselect_b32 s38, 0, s38
    s_add_u32 s39, s39, 1
    s_cmp_eq_u32 s39, 28
    s_cselect_b32 s41, s45, s44
    s_cselect_b32 s39, 0, s39
    s_add_u32 m0, s36, 0
    s_nop 0
    buffer_load_dwordx4 v39, s[12:15], s34 offen lds
    s_add_u32 s34, s34, s40
    s_add_u32 m0, s37, 0
    s_nop 0
    buffer_load_dwordx4 v40, s[16:19], s35 offen lds
    s_add_u32 s35, s35, s41
    ds_read_b128 v[24:27], v37 offset:0
    ds_read_b64_tr_b16 v[32:33], v38 offset:4096
    ds_read_b64_tr_b16 v[34:35], v38 offset:5120
    s_waitcnt lgkmcnt(3)
    v_mfma_f32_32x32x16_bf16 v[4:19], v[28:31], v[20:23], v[4:19]
    v_add_u32 v36, 16384, v36
    v_add_u32 v37, 16384, v37
    v_add_u32 v38, 16384, v38
    ds_read_b128 v[20:23], v36 offset:0
    ds_read_b64_tr_b16 v[28:29], v38 offset:0
    ds_read_b64_tr_b16 v[30:31], v38 offset:1024
    s_waitcnt lgkmcnt(3)
    v_mfma_f32_32x32x16_bf16 v[4:19], v[32:35], v[24:27], v[4:19]
    s_waitcnt vmcnt(4)
    s_barrier
    s_add_u32 s38, s38, 1
    s_cmp_eq_u32 s38, 28
    s_cselect_b32 s40, s43, s42
    s_cselect_b32 s38, 0, s38
    s_add_u32 s39, s39, 1
    s_cmp_eq_u32 s39, 28
    s_cselect_b32 s41, s45, s44
    s_cselect_b32 s39, 0, s39
    s_add_u32 m0, s36, 16384
    s_nop 0
    buffer_load_dwordx4 v39, s[12:15], s34 offen lds
    s_add_u32 s34, s34, s40
    s_add_u32 m0, s37, 16384
    s_nop 0
    buffer_load_dwordx4 v40, s[16:19], s35 offen lds
    s_add_u32 s35, s35, s41
    ds_read_b128 v[24:27], v37 offset:0
    ds_read_b64_tr_b16 v[32:33], v38 offset:4096
    ds_read_b64_tr_b16 v[34:35], v38 offset:5120
    s_waitcnt lgkmcnt(3)
    v_mfma_f32_32x32x16_bf16 v[4:19], v[28:31], v[20:23], v[4:19]
    v_add_u32 v36, 16384, v36
    v_add_u32 v37, 16384, v37
    v_add_u32 v38, 16384, v38
    ds_read_b128 v[20:23], v36 offset:0
    ds_read_b64_tr_b16 v[28:29], v38 offset:0
    ds_read_b64_tr_b16 v[30:31], v38 offset:1024
    s_waitcnt lgkmcnt(3)
    v_mfma_f32_32x32x16_bf16 v[4:19], v[32:35], v[24:27], v[4:19]
    s_waitcnt vmcnt(4)
    s_barrier
    s_add_u32 s38, s38, 1
    s_cmp_eq_u32 s38, 28
    s_cselect_b32 s40, s43, s42
    s_cselect_b32 s38, 0, s38
    s_add_u32 s39, s39, 1
    s_cmp_eq_u32 s39, 28
    s_cselect_b32 s41, s45, s44
    s_cselect_b32 s39, 0, s39
    s_add_u32 m0, s36, 32768
    s_nop 0
    buffer_load_dwordx4 v39, s[12:15], s34 offen lds
    s_add_u32 s34, s34, s40
    s_add_u32 m0, s37, 32768
    s_nop 0
    buffer_load_dwordx4 v40, s[16:19], s35 offen lds
    s_add_u32 s35, s35, s41
    ds_read_b128 v[24:27], v37 offset:0
    ds_read_b64_tr_b16 v[32:33], v38 offset:4096
    ds_read_b64_tr_b16 v[34:35], v38 offset:5120
    s_waitcnt lgkmcnt(3)
    v_mfma_f32_32x32x16_bf16 v[4:19], v[28:31], v[20:23], v[4:19]
    v_add_u32 v36, 16384, v36
    v_add_u32 v37, 16384, v37
    v_add_u32 v38, 16384, v38
    ds_read_b128 v[20:23], v36 offset:0
    ds_read_b64_tr_b16 v[28:29], v38 offset:0
    ds_read_b64_tr_b16 v[30:31], v38 offset:1024
    s_waitcnt lgkmcnt(3)
    v_mfma_f32_32x32x16_bf16 v[4:19], v[32:35], v[24:27], v[4:19]
    s_waitcnt vmcnt(4)
    s_barrier
    s_add_u32 s38, s38, 1
    s_cmp_eq_u32 s38, 28
    s_cselect_b32 s40, s43, s42
    s_cselect_b32 s38, 0, s38
    s_add_u32 s39, s39, 1
    s_cmp_eq_u32 s39, 28
    s_cselect_b32 s41, s45, s44
    s_cselect_b32 s39, 0, s39
    s_add_u32 m0, s36, 49152
    s_nop 0
    buffer_load_dwordx4 v39, s[12:15], s34 offen lds
    s_add_u32 s34, s34, s40
    s_add_u32 m0, s37, 49152
    s_nop 0
    buffer_load_dwordx4 v40, s[16:19], s35 offen lds
    s_add_u32 s35, s35, s41
    ds_read_b128 v[24:27], v37 offset:0
    ds_read_b64_tr_b16 v[32:33], v38 offset:4096
    ds_read_b64_tr_b16 v[34:35], v38 offset:5120
    s_waitcnt lgkmcnt(3)
    v_mfma_f32_32x32x16_bf16 v[4:19], v[28:31], v[20:23], v[4:19]
    v_subrev_u32 v36, 65536, v36
    v_subrev_u32 v37, 65536, v37
    v_subrev_u32 v38, 65536, v38
    ds_read_b128 v[20:23], v36 offset:0
    ds_read_b64_tr_b16 v[28:29], v38 offset:0
    ds_read_b64_tr_b16 v[30:31], v38 offset:1024
    s_waitcnt lgkmcnt(3)
    v_mfma_f32_32x32x16_bf16 v[4:19], v[32:35], v[24:27], v[4:19]
    s_waitcnt vmcnt(4)
    s_barrier
    s_add_u32 s38, s38, 1
    s_cmp_eq_u32 s38, 28
    s_cselect_b32 s40, s43, s42
    s_cselect_b32 s38, 0, s38
    s_add_u32 s39, s39, 1
    s_cmp_eq_u32 s39, 28
    s_cselect_b32 s41, s45, s44
    s_cselect_b32 s39, 0, s39
    s_add_u32 m0, s36, 65536
    s_nop 0
    buffer_load_dwordx4 v39, s[12:15], s34 offen lds
    s_add_u32 s34, s34, s40
    s_add_u32 m0, s37, 65536
    s_nop 0
    buffer_load_dwordx4 v40, s[16:19], s35 offen lds
    s_add_u32 s35, s35, s41
    ds_read_b128 v[24:27], v37 offset:0
    ds_read_b64_tr_b16 v[32:33], v38 offset:4096
    ds_read_b64_tr_b16 v[34:35], v38 offset:5120
    s_waitcnt lgkmcnt(3)
    v_mfma_f32_32x32x16_bf16 v[4:19], v[28:31], v[20:23], v[4:19]
    v_add_u32 v36, 16384, v36
    v_add_u32 v37, 16384, v37
    v_add_u32 v38, 16384, v38
    ds_read_b128 v[20:23], v36 offset:0
    ds_read_b64_tr_b16 v[28:29], v38 offset:0
    ds_read_b64_tr_b16 v[30:31], v38 offset:1024
    s_waitcnt lgkmcnt(3)
    v_mfma_f32_32x32x16_bf16 v[4:19], v[32:35], v[24:27], v[4:19]
    s_waitcnt vmcnt(4)
    s_barrier
    s_add_u32 s38, s38, 1
    s_cmp_eq_u32 s38, 28
    s_cselect_b32 s40, s43, s42
    s_cselect_b32 s38, 0, s38
    s_add_u32 s39, s39, 1
    s_cmp_eq_u32 s39, 28
    s_cselect_b32 s41, s45, s44
    s_cselect_b32 s39, 0, s39
    s_add_u32 m0, s36, 0
    s_nop 0
    buffer_load_dwordx4 v39, s[12:15], s34 offen lds
    s_add_u32 s34, s34, s40
    s_add_u32 m0, s37, 0
    s_nop 0
    buffer_load_dwordx4 v40, s[16:19], s35 offen lds
    s_add_u32 s35, s35, s41
    ds_read_b128 v[24:27], v37 offset:0
    ds_read_b64_tr_b16 v[32:33], v38 offset:4096
    ds_read_b64_tr_b16 v[34:35], v38 offset:5120
    s_waitcnt lgkmcnt(3)
    v_mfma_f32_32x32x16_bf16 v[4:19], v[28:31], v[20:23], v[4:19]
    v_add_u32 v36, 16384, v36
    v_add_u32 v37, 16384, v37
    v_add_u32 v38, 16384, v38
    ds_read_b128 v[20:23], v36 offset:0
    ds_read_b64_tr_b16 v[28:29], v38 offset:0
    ds_read_b64_tr_b16 v[30:31], v38 offset:1024
    s_waitcnt lgkmcnt(3)
    v_mfma_f32_32x32x16_bf16 v[4:19], v[32:35], v[24:27], v[4:19]
    s_waitcnt vmcnt(4)
    s_barrier
    s_add_u32 s38, s38, 1
    s_cmp_eq_u32 s38, 28
    s_cselect_b32 s40, s43, s42
    s_cselect_b32 s38, 0, s38
    s_add_u32 s39, s39, 1
    s_cmp_eq_u32 s39, 28
    s_cselect_b32 s41, s45, s44
    s_cselect_b32 s39, 0, s39
    s_add_u32 m0, s36, 16384
    s_nop 0
    buffer_load_dwordx4 v39, s[12:15], s34 offen lds
    s_add_u32 s34, s34, s40
    s_add_u32 m0, s37, 16384
    s_nop 0
    buffer_load_dwordx4 v40, s[16:19], s35 offen lds
    s_add_u32 s35, s35, s41
    ds_read_b128 v[24:27], v37 offset:0
    ds_read_b64_tr_b16 v[32:33], v38 offset:4096
    ds_read_b64_tr_b16 v[34:35], v38 offset:5120
    s_waitcnt lgkmcnt(3)
    v_mfma_f32_32x32x16_bf16 v[4:19], v[28:31], v[20:23], v[4:19]
    v_add_u32 v36, 16384, v36
    v_add_u32 v37, 16384, v37
    v_add_u32 v38, 16384, v38
    ds_read_b128 v[20:23], v36 offset:0
    ds_read_b64_tr_b16 v[28:29], v38 offset:0
    ds_read_b64_tr_b16 v[30:31], v38 offset:1024
    s_waitcnt lgkmcnt(3)
    v_mfma_f32_32x32x16_bf16 v[4:19], v[32:35], v[24:27], v[4:19]
    s_waitcnt vmcnt(4)
    s_barrier
    s_add_u32 s38, s38, 1
    s_cmp_eq_u32 s38, 28
    s_cselect_b32 s40, s43, s42
    s_cselect_b32 s38, 0, s38
    s_add_u32 s39, s39, 1
    s_cmp_eq_u32 s39, 28
    s_cselect_b32 s41, s45, s44
    s_cselect_b32 s39, 0, s39
    s_add_u32 m0, s36, 32768
    s_nop 0
    buffer_load_dwordx4 v39, s[12:15], s34 offen lds
    s_add_u32 s34, s34, s40
    s_add_u32 m0, s37, 32768
    s_nop 0
    buffer_load_dwordx4 v40, s[16:19], s35 offen lds
    s_add_u32 s35, s35, s41
    ds_read_b128 v[24:27], v37 offset:0
    ds_read_b64_tr_b16 v[32:33], v38 offset:4096
    ds_read_b64_tr_b16 v[34:35], v38 offset:5120
    s_waitcnt lgkmcnt(3)
    v_mfma_f32_32x32x16_bf16 v[4:19], v[28:31], v[20:23], v[4:19]
    v_add_u32 v36, 16384, v36
    v_add_u32 v37, 16384, v37
    v_add_u32 v38, 16384, v38
    ds_read_b128 v[20:23], v36 offset:0
    ds_read_b64_tr_b16 v[28:29], v38 offset:0
    ds_read_b64_tr_b16 v[30:31], v38 offset:1024
    s_waitcnt lgkmcnt(3)
    v_mfma_f32_32x32x16_bf16 v[4:19], v[32:35], v[24:27], v[4:19]
    s_waitcnt vmcnt(4)
    s_barrier
    s_add_u32 s38, s38, 1
    s_cmp_eq_u32 s38, 28
    s_cselect_b32 s40, s43, s42
    s_cselect_b32 s38, 0, s38
    s_add_u32 s39, s39, 1
    s_cmp_eq_u32 s39, 28
    s_cselect_b32 s41, s45, s44
    s_cselect_b32 s39, 0, s39
    s_add_u32 m0, s36, 49152
    s_nop 0
    buffer_load_dwordx4 v39, s[12:15], s34 offen lds
    s_add_u32 s34, s34, s40
    s_add_u32 m0, s37, 49152
    s_nop 0
    buffer_load_dwordx4 v40, s[16:19], s35 offen lds
    s_add_u32 s35, s35, s41
    ds_read_b128 v[24:27], v37 offset:0
    ds_read_b64_tr_b16 v[32:33], v38 offset:4096
    ds_read_b64_tr_b16 v[34:35], v38 offset:5120
    s_waitcnt lgkmcnt(3)
    v_mfma_f32_32x32x16_bf16 v[4:19], v[28:31], v[20:23], v[4:19]
    v_subrev_u32 v36, 65536, v36
    v_subrev_u32 v37, 65536, v37
    v_subrev_u32 v38, 65536, v38
    ds_read_b128 v[20:23], v36 offset:0
    ds_read_b64_tr_b16 v[28:29], v38 offset:0
    ds_read_b64_tr_b16 v[30:31], v38 offset:1024
    s_waitcnt lgkmcnt(3)
    v_mfma_f32_32x32x16_bf16 v[4:19], v[32:35], v[24:27], v[4:19]
    s_waitcnt vmcnt(4)
    s_barrier
    s_add_u32 s38, s38, 1
    s_cmp_eq_u32 s38, 28
    s_cselect_b32 s40, s43, s42
    s_cselect_b32 s38, 0, s38
    s_add_u32 s39, s39, 1
    s_cmp_eq_u32 s39, 28
    s_cselect_b32 s41, s45, s44
    s_cselect_b32 s39, 0, s39
    s_add_u32 m0, s36, 65536
    s_nop 0
    buffer_load_dwordx4 v39, s[12:15], s34 offen lds
    s_add_u32 s34, s34, s40
    s_add_u32 m0, s37, 65536
    s_nop 0
    buffer_load_dwordx4 v40, s[16:19], s35 offen lds
    s_add_u32 s35, s35, s41
    ds_read_b128 v[24:27], v37 offset:0
    ds_read_b64_tr_b16 v[32:33], v38 offset:4096
    ds_read_b64_tr_b16 v[34:35], v38 offset:5120
    s_waitcnt lgkmcnt(3)
    v_mfma_f32_32x32x16_bf16 v[4:19], v[28:31], v[20:23], v[4:19]
    v_add_u32 v36, 16384, v36
    v_add_u32 v37, 16384, v37
    v_add_u32 v38, 16384, v38
    ds_read_b128 v[20:23], v36 offset:0
    ds_read_b64_tr_b16 v[28:29], v38 offset:0
    ds_read_b64_tr_b16 v[30:31], v38 offset:1024
    s_waitcnt lgkmcnt(3)
    v_mfma_f32_32x32x16_bf16 v[4:19], v[32:35], v[24:27], v[4:19]
    s_waitcnt vmcnt(4)
    s_barrier
    s_add_u32 s38, s38, 1
    s_cmp_eq_u32 s38, 28
    s_cselect_b32 s40, s43, s42
    s_cselect_b32 s38, 0, s38
    s_add_u32 s39, s39, 1
    s_cmp_eq_u32 s39, 28
    s_cselect_b32 s41, s45, s44
    s_cselect_b32 s39, 0, s39
    s_add_u32 m0, s36, 0
    s_nop 0
    buffer_load_dwordx4 v39, s[12:15], s34 offen lds
    s_add_u32 s34, s34, s40
    s_add_u32 m0, s37, 0
    s_nop 0
    buffer_load_dwordx4 v40, s[16:19], s35 offen lds
    s_add_u32 s35, s35, s41
    ds_read_b128 v[24:27], v37 offset:0
    ds_read_b64_tr_b16 v[32:33], v38 offset:4096
    ds_read_b64_tr_b16 v[34:35], v38 offset:5120
    s_waitcnt lgkmcnt(3)
    v_mfma_f32_32x32x16_bf16 v[4:19], v[28:31], v[20:23], v[4:19]
    v_add_u32 v36, 16384, v36
    v_add_u32 v37, 16384, v37
    v_add_u32 v38, 16384, v38
    ds_read_b128 v[20:23], v36 offset:0
    ds_read_b64_tr_b16 v[28:29], v38 offset:0
    ds_read_b64_tr_b16 v[30:31], v38 offset:1024
    s_waitcnt lgkmcnt(3)
    v_mfma_f32_32x32x16_bf16 v[4:19], v[32:35], v[24:27], v[4:19]
    s_waitcnt vmcnt(4)
    s_barrier
    s_add_u32 s38, s38, 1
    s_cmp_eq_u32 s38, 28
    s_cselect_b32 s40, s43, s42
    s_cselect_b32 s38, 0, s38
    s_add_u32 s39, s39, 1
    s_cmp_eq_u32 s39, 28
    s_cselect_b32 s41, s45, s44
    s_cselect_b32 s39, 0, s39
    s_add_u32 m0, s36, 16384
    s_nop 0
    buffer_load_dwordx4 v39, s[12:15], s34 offen lds
    s_add_u32 s34, s34, s40
    s_add_u32 m0, s37, 16384
    s_nop 0
    buffer_load_dwordx4 v40, s[16:19], s35 offen lds
    s_add_u32 s35, s35, s41
    ds_read_b128 v[24:27], v37 offset:0
    ds_read_b64_tr_b16 v[32:33], v38 offset:4096
    ds_read_b64_tr_b16 v[34:35], v38 offset:5120
    s_waitcnt lgkmcnt(3)
    v_mfma_f32_32x32x16_bf16 v[4:19], v[28:31], v[20:23], v[4:19]
    v_add_u32 v36, 16384, v36
    v_add_u32 v37, 16384, v37
    v_add_u32 v38, 16384, v38
    ds_read_b128 v[20:23], v36 offset:0
    ds_read_b64_tr_b16 v[28:29], v38 offset:0
    ds_read_b64_tr_b16 v[30:31], v38 offset:1024
    s_waitcnt lgkmcnt(3)
    v_mfma_f32_32x32x16_bf16 v[4:19], v[32:35], v[24:27], v[4:19]
    s_waitcnt vmcnt(4)
    s_barrier
    s_add_u32 s38, s38, 1
    s_cmp_eq_u32 s38, 28
    s_cselect_b32 s40, s43, s42
    s_cselect_b32 s38, 0, s38
    s_add_u32 s39, s39, 1
    s_cmp_eq_u32 s39, 28
    s_cselect_b32 s41, s45, s44
    s_cselect_b32 s39, 0, s39
    s_add_u32 m0, s36, 32768
    s_nop 0
    buffer_load_dwordx4 v39, s[12:15], s34 offen lds
    s_add_u32 s34, s34, s40
    s_add_u32 m0, s37, 32768
    s_nop 0
    buffer_load_dwordx4 v40, s[16:19], s35 offen lds
    s_add_u32 s35, s35, s41
    ds_read_b128 v[24:27], v37 offset:0
    ds_read_b64_tr_b16 v[32:33], v38 offset:4096
    ds_read_b64_tr_b16 v[34:35], v38 offset:5120
    s_waitcnt lgkmcnt(3)
    v_mfma_f32_32x32x16_bf16 v[4:19], v[28:31], v[20:23], v[4:19]
    v_add_u32 v36, 16384, v36
    v_add_u32 v37, 16384, v37
    v_add_u32 v38, 16384, v38
    ds_read_b128 v[20:23], v36 offset:0
    ds_read_b64_tr_b16 v[28:29], v38 offset:0
    ds_read_b64_tr_b16 v[30:31], v38 offset:1024
    s_waitcnt lgkmcnt(3)
    v_mfma_f32_32x32x16_bf16 v[4:19], v[32:35], v[24:27], v[4:19]
    s_waitcnt vmcnt(4)
    s_barrier
    s_add_u32 s38, s38, 1
    s_cmp_eq_u32 s38, 28
    s_cselect_b32 s40, s43, s42
    s_cselect_b32 s38, 0, s38
    s_add_u32 s39, s39, 1
    s_cmp_eq_u32 s39, 28
    s_cselect_b32 s41, s45, s44
    s_cselect_b32 s39, 0, s39
    s_add_u32 m0, s36, 49152
    s_nop 0
    buffer_load_dwordx4 v39, s[12:15], s34 offen lds
    s_add_u32 s34, s34, s40
    s_add_u32 m0, s37, 49152
    s_nop 0
    buffer_load_dwordx4 v40, s[16:19], s35 offen lds
    s_add_u32 s35, s35, s41
    ds_read_b128 v[24:27], v37 offset:0
    ds_read_b64_tr_b16 v[32:33], v38 offset:4096
    ds_read_b64_tr_b16 v[34:35], v38 offset:5120
    s_waitcnt lgkmcnt(3)
    v_mfma_f32_32x32x16_bf16 v[4:19], v[28:31], v[20:23], v[4:19]
    v_subrev_u32 v36, 65536, v36
    v_subrev_u32 v37, 65536, v37
    v_subrev_u32 v38, 65536, v38
    ds_read_b128 v[20:23], v36 offset:0
    ds_read_b64_tr_b16 v[28:29], v38 offset:0
    ds_read_b64_tr_b16 v[30:31], v38 offset:1024
    s_waitcnt lgkmcnt(3)
    v_mfma_f32_32x32x16_bf16 v[4:19], v[32:35], v[24:27], v[4:19]
    s_waitcnt vmcnt(4)
    s_barrier
    s_add_u32 s38, s38, 1
    s_cmp_eq_u32 s38, 28
    s_cselect_b32 s40, s43, s42
    s_cselect_b32 s38, 0, s38
    s_add_u32 s39, s39, 1
    s_cmp_eq_u32 s39, 28
    s_cselect_b32 s41, s45, s44
    s_cselect_b32 s39, 0, s39
    s_add_u32 m0, s36, 65536
    s_nop 0
    buffer_load_dwordx4 v39, s[12:15], s34 offen lds
    s_add_u32 s34, s34, s40
    s_add_u32 m0, s37, 65536
    s_nop 0
    buffer_load_dwordx4 v40, s[16:19], s35 offen lds
    s_add_u32 s35, s35, s41
    ds_read_b128 v[24:27], v37 offset:0
    ds_read_b64_tr_b16 v[32:33], v38 offset:4096
    ds_read_b64_tr_b16 v[34:35], v38 offset:5120
    s_waitcnt lgkmcnt(3)
    v_mfma_f32_32x32x16_bf16 v[4:19], v[28:31], v[20:23], v[4:19]
    v_add_u32 v36, 16384, v36
    v_add_u32 v37, 16384, v37
    v_add_u32 v38, 16384, v38
    ds_read_b128 v[20:23], v36 offset:0
    ds_read_b64_tr_b16 v[28:29], v38 offset:0
    ds_read_b64_tr_b16 v[30:31], v38 offset:1024
    s_waitcnt lgkmcnt(3)
    v_mfma_f32_32x32x16_bf16 v[4:19], v[32:35], v[24:27], v[4:19]
    s_waitcnt vmcnt(4)
    s_barrier
    s_add_u32 s38, s38, 1
    s_cmp_eq_u32 s38, 28
    s_cselect_b32 s40, s43, s42
    s_cselect_b32 s38, 0, s38
    s_add_u32 s39, s39, 1
    s_cmp_eq_u32 s39, 28
    s_cselect_b32 s41, s45, s44
    s_cselect_b32 s39, 0, s39
    s_add_u32 m0, s36, 0
    s_nop 0
    buffer_load_dwordx4 v39, s[12:15], s34 offen lds
    s_add_u32 s34, s34, s40
    s_add_u32 m0, s37, 0
    s_nop 0
    buffer_load_dwordx4 v40, s[16:19], s35 offen lds
    s_add_u32 s35, s35, s41
    ds_read_b128 v[24:27], v37 offset:0
    ds_read_b64_tr_b16 v[32:33], v38 offset:4096
    ds_read_b64_tr_b16 v[34:35], v38 offset:5120
    s_waitcnt lgkmcnt(3)
    v_mfma_f32_32x32x16_bf16 v[4:19], v[28:31], v[20:23], v[4:19]
    v_add_u32 v36, 16384, v36
    v_add_u32 v37, 16384, v37
    v_add_u32 v38, 16384, v38
    ds_read_b128 v[20:23], v36 offset:0
    ds_read_b64_tr_b16 v[28:29], v38 offset:0
    ds_read_b64_tr_b16 v[30:31], v38 offset:1024
    s_waitcnt lgkmcnt(3)
    v_mfma_f32_32x32x16_bf16 v[4:19], v[32:35], v[24:27], v[4:19]
    s_waitcnt vmcnt(4)
    s_barrier
    s_add_u32 s38, s38, 1
    s_cmp_eq_u32 s38, 28
    s_cselect_b32 s40, s43, s42
    s_cselect_b32 s38, 0, s38
    s_add_u32 s39, s39, 1
    s_cmp_eq_u32 s39, 28
    s_cselect_b32 s41, s45, s44
    s_cselect_b32 s39, 0, s39
    s_add_u32 m0, s36, 16384
    s_nop 0
    buffer_load_dwordx4 v39, s[12:15], s34 offen lds
    s_add_u32 s34, s34, s40
    s_add_u32 m0, s37, 16384
    s_nop 0
    buffer_load_dwordx4 v40, s[16:19], s35 offen lds
    s_add_u32 s35, s35, s41
    ds_read_b128 v[24:27], v37 offset:0
    ds_read_b64_tr_b16 v[32:33], v38 offset:4096
    ds_read_b64_tr_b16 v[34:35], v38 offset:5120
    s_waitcnt lgkmcnt(3)
    v_mfma_f32_32x32x16_bf16 v[4:19], v[28:31], v[20:23], v[4:19]
    v_add_u32 v36, 16384, v36
    v_add_u32 v37, 16384, v37
    v_add_u32 v38, 16384, v38
    ds_read_b128 v[20:23], v36 offset:0
    ds_read_b64_tr_b16 v[28:29], v38 offset:0
    ds_read_b64_tr_b16 v[30:31], v38 offset:1024
    s_waitcnt lgkmcnt(3)
    v_mfma_f32_32x32x16_bf16 v[4:19], v[32:35], v[24:27], v[4:19]
    s_waitcnt vmcnt(4)
    s_barrier
    s_add_u32 s38, s38, 1
    s_cmp_eq_u32 s38, 28
    s_cselect_b32 s40, s43, s42
    s_cselect_b32 s38, 0, s38
    s_add_u32 s39, s39, 1
    s_cmp_eq_u32 s39, 28
    s_cselect_b32 s41, s45, s44
    s_cselect_b32 s39, 0, s39
    s_add_u32 m0, s36, 32768
    s_nop 0
    buffer_load_dwordx4 v39, s[12:15], s34 offen lds
    s_add_u32 s34, s34, s40
    s_add_u32 m0, s37, 32768
    s_nop 0
    buffer_load_dwordx4 v40, s[16:19], s35 offen lds
    s_add_u32 s35, s35, s41
    ds_read_b128 v[24:27], v37 offset:0
    ds_read_b64_tr_b16 v[32:33], v38 offset:4096
    ds_read_b64_tr_b16 v[34:35], v38 offset:5120
    s_waitcnt lgkmcnt(3)
    v_mfma_f32_32x32x16_bf16 v[4:19], v[28:31], v[20:23], v[4:19]
    v_add_u32 v36, 16384, v36
    v_add_u32 v37, 16384, v37
    v_add_u32 v38, 16384, v38
    ds_read_b128 v[20:23], v36 offset:0
    ds_read_b64_tr_b16 v[28:29], v38 offset:0
    ds_read_b64_tr_b16 v[30:31], v38 offset:1024
    s_waitcnt lgkmcnt(3)
    v_mfma_f32_32x32x16_bf16 v[4:19], v[32:35], v[24:27], v[4:19]
    s_waitcnt vmcnt(4)
    s_barrier
    s_add_u32 s38, s38, 1
    s_cmp_eq_u32 s38, 28
    s_cselect_b32 s40, s43, s42
    s_cselect_b32 s38, 0, s38
    s_add_u32 s39, s39, 1
    s_cmp_eq_u32 s39, 28
    s_cselect_b32 s41, s45, s44
    s_cselect_b32 s39, 0, s39
    s_add_u32 m0, s36, 49152
    s_nop 0
    buffer_load_dwordx4 v39, s[12:15], s34 offen lds
    s_add_u32 s34, s34, s40
    s_add_u32 m0, s37, 49152
    s_nop 0
    buffer_load_dwordx4 v40, s[16:19], s35 offen lds
    s_add_u32 s35, s35, s41
    ds_read_b128 v[24:27], v37 offset:0
    ds_read_b64_tr_b16 v[32:33], v38 offset:4096
    ds_read_b64_tr_b16 v[34:35], v38 offset:5120
    s_waitcnt lgkmcnt(3)
    v_mfma_f32_32x32x16_bf16 v[4:19], v[28:31], v[20:23], v[4:19]
    v_subrev_u32 v36, 65536, v36
    v_subrev_u32 v37, 65536, v37
    v_subrev_u32 v38, 65536, v38
    ds_read_b128 v[20:23], v36 offset:0
    ds_read_b64_tr_b16 v[28:29], v38 offset:0
    ds_read_b64_tr_b16 v[30:31], v38 offset:1024
    s_waitcnt lgkmcnt(3)
    v_mfma_f32_32x32x16_bf16 v[4:19], v[32:35], v[24:27], v[4:19]
    s_waitcnt vmcnt(4)
    s_barrier
    s_add_u32 s38, s38, 1
    s_cmp_eq_u32 s38, 28
    s_cselect_b32 s40, s43, s42
    s_cselect_b32 s38, 0, s38
    s_add_u32 s39, s39, 1
    s_cmp_eq_u32 s39, 28
    s_cselect_b32 s41, s45, s44
    s_cselect_b32 s39, 0, s39
    s_add_u32 m0, s36, 65536
    s_nop 0
    buffer_load_dwordx4 v39, s[12:15], s34 offen lds
    s_add_u32 s34, s34, s40
    s_add_u32 m0, s37, 65536
    s_nop 0
    buffer_load_dwordx4 v40, s[16:19], s35 offen lds
    s_add_u32 s35, s35, s41
    ds_read_b128 v[24:27], v37 offset:0
    ds_read_b64_tr_b16 v[32:33], v38 offset:4096
    ds_read_b64_tr_b16 v[34:35], v38 offset:5120
    s_waitcnt lgkmcnt(3)
    v_mfma_f32_32x32x16_bf16 v[4:19], v[28:31], v[20:23], v[4:19]
    v_add_u32 v36, 16384, v36
    v_add_u32 v37, 16384, v37
    v_add_u32 v38, 16384, v38
    ds_read_b128 v[20:23], v36 offset:0
    ds_read_b64_tr_b16 v[28:29], v38 offset:0
    ds_read_b64_tr_b16 v[30:31], v38 offset:1024
    s_waitcnt lgkmcnt(3)
    v_mfma_f32_32x32x16_bf16 v[4:19], v[32:35], v[24:27], v[4:19]
    s_waitcnt vmcnt(4)
    s_barrier
    s_add_u32 s38, s38, 1
    s_cmp_eq_u32 s38, 28
    s_cselect_b32 s40, s43, s42
    s_cselect_b32 s38, 0, s38
    s_add_u32 s39, s39, 1
    s_cmp_eq_u32 s39, 28
    s_cselect_b32 s41, s45, s44
    s_cselect_b32 s39, 0, s39
    s_add_u32 m0, s36, 0
    s_nop 0
    buffer_load_dwordx4 v39, s[12:15], s34 offen lds
    s_add_u32 s34, s34, s40
    s_add_u32 m0, s37, 0
    s_nop 0
    buffer_load_dwordx4 v40, s[16:19], s35 offen lds
    s_add_u32 s35, s35, s41
    ds_read_b128 v[24:27], v37 offset:0
    ds_read_b64_tr_b16 v[32:33], v38 offset:4096
    ds_read_b64_tr_b16 v[34:35], v38 offset:5120
    s_waitcnt lgkmcnt(3)
    v_mfma_f32_32x32x16_bf16 v[4:19], v[28:31], v[20:23], v[4:19]
    v_add_u32 v36, 16384, v36
    v_add_u32 v37, 16384, v37
    v_add_u32 v38, 16384, v38
    ds_read_b128 v[20:23], v36 offset:0
    ds_read_b64_tr_b16 v[28:29], v38 offset:0
    ds_read_b64_tr_b16 v[30:31], v38 offset:1024
    s_waitcnt lgkmcnt(3)
    v_mfma_f32_32x32x16_bf16 v[4:19], v[32:35], v[24:27], v[4:19]
    s_waitcnt vmcnt(4)
    s_barrier
    s_add_u32 s38, s38, 1
    s_cmp_eq_u32 s38, 28
    s_cselect_b32 s40, s43, s42
    s_cselect_b32 s38, 0, s38
    s_add_u32 s39, s39, 1
    s_cmp_eq_u32 s39, 28
    s_cselect_b32 s41, s45, s44
    s_cselect_b32 s39, 0, s39
    s_add_u32 m0, s36, 16384
    s_nop 0
    buffer_load_dwordx4 v39, s[12:15], s34 offen lds
    s_add_u32 s34, s34, s40
    s_add_u32 m0, s37, 16384
    s_nop 0
    buffer_load_dwordx4 v40, s[16:19], s35 offen lds
    s_add_u32 s35, s35, s41
    ds_read_b128 v[24:27], v37 offset:0
    ds_read_b64_tr_b16 v[32:33], v38 offset:4096
    ds_read_b64_tr_b16 v[34:35], v38 offset:5120
    s_waitcnt lgkmcnt(3)
    v_mfma_f32_32x32x16_bf16 v[4:19], v[28:31], v[20:23], v[4:19]
    v_add_u32 v36, 16384, v36
    v_add_u32 v37, 16384, v37
    v_add_u32 v38, 16384, v38
    ds_read_b128 v[20:23], v36 offset:0
    ds_read_b64_tr_b16 v[28:29], v38 offset:0
    ds_read_b64_tr_b16 v[30:31], v38 offset:1024
    s_waitcnt lgkmcnt(3)
    v_mfma_f32_32x32x16_bf16 v[4:19], v[32:35], v[24:27], v[4:19]
    s_waitcnt vmcnt(4)
    s_barrier
    s_add_u32 s38, s38, 1
    s_cmp_eq_u32 s38, 28
    s_cselect_b32 s40, s43, s42
    s_cselect_b32 s38, 0, s38
    s_add_u32 s39, s39, 1
    s_cmp_eq_u32 s39, 28
    s_cselect_b32 s41, s45, s44
    s_cselect_b32 s39, 0, s39
    s_add_u32 m0, s36, 32768
    s_nop 0
    buffer_load_dwordx4 v39, s[12:15], s34 offen lds
    s_add_u32 s34, s34, s40
    s_add_u32 m0, s37, 32768
    s_nop 0
    buffer_load_dwordx4 v40, s[16:19], s35 offen lds
    s_add_u32 s35, s35, s41
    ds_read_b128 v[24:27], v37 offset:0
    ds_read_b64_tr_b16 v[32:33], v38 offset:4096
    ds_read_b64_tr_b16 v[34:35], v38 offset:5120
    s_waitcnt lgkmcnt(3)
    v_mfma_f32_32x32x16_bf16 v[4:19], v[28:31], v[20:23], v[4:19]
    v_add_u32 v36, 16384, v36
    v_add_u32 v37, 16384, v37
    v_add_u32 v38, 16384, v38
    ds_read_b128 v[20:23], v36 offset:0
    ds_read_b64_tr_b16 v[28:29], v38 offset:0
    ds_read_b64_tr_b16 v[30:31], v38 offset:1024
    s_waitcnt lgkmcnt(3)
    v_mfma_f32_32x32x16_bf16 v[4:19], v[32:35], v[24:27], v[4:19]
    s_waitcnt vmcnt(4)
    s_barrier
    ds_read_b128 v[24:27], v37 offset:0
    ds_read_b64_tr_b16 v[32:33], v38 offset:4096
    ds_read_b64_tr_b16 v[34:35], v38 offset:5120
    s_waitcnt lgkmcnt(3)
    v_mfma_f32_32x32x16_bf16 v[4:19], v[28:31], v[20:23], v[4:19]
    v_subrev_u32 v36, 65536, v36
    v_subrev_u32 v37, 65536, v37
    v_subrev_u32 v38, 65536, v38
    ds_read_b128 v[20:23], v36 offset:0
    ds_read_b64_tr_b16 v[28:29], v38 offset:0
    ds_read_b64_tr_b16 v[30:31], v38 offset:1024
    s_waitcnt lgkmcnt(3)
    v_mfma_f32_32x32x16_bf16 v[4:19], v[32:35], v[24:27], v[4:19]
    s_waitcnt vmcnt(2)
    s_barrier
    ds_read_b128 v[24:27], v37 offset:0
    ds_read_b64_tr_b16 v[32:33], v38 offset:4096
    ds_read_b64_tr_b16 v[34:35], v38 offset:5120
    s_waitcnt lgkmcnt(3)
    v_mfma_f32_32x32x16_bf16 v[4:19], v[28:31], v[20:23], v[4:19]
    v_add_u32 v36, 16384, v36
    v_add_u32 v37, 16384, v37
    v_add_u32 v38, 16384, v38
    ds_read_b128 v[20:23], v36 offset:0
    ds_read_b64_tr_b16 v[28:29], v38 offset:0
    ds_read_b64_tr_b16 v[30:31], v38 offset:1024
    s_waitcnt lgkmcnt(3)
    v_mfma_f32_32x32x16_bf16 v[4:19], v[32:35], v[24:27], v[4:19]
    s_waitcnt vmcnt(0)
    s_barrier
    ds_read_b128 v[24:27], v37 offset:0
    ds_read_b64_tr_b16 v[32:33], v38 offset:4096
    ds_read_b64_tr_b16 v[34:35], v38 offset:5120
    s_waitcnt lgkmcnt(3)
    v_mfma_f32_32x32x16_bf16 v[4:19], v[28:31], v[20:23], v[4:19]
    v_add_u32 v36, 16384, v36
    v_add_u32 v37, 16384, v37
    v_add_u32 v38, 16384, v38
    ds_read_b128 v[20:23], v36 offset:0
    ds_read_b64_tr_b16 v[28:29], v38 offset:0
    ds_read_b64_tr_b16 v[30:31], v38 offset:1024
    s_waitcnt lgkmcnt(3)
    v_mfma_f32_32x32x16_bf16 v[4:19], v[32:35], v[24:27], v[4:19]
    ds_read_b128 v[24:27], v37 offset:0
    ds_read_b64_tr_b16 v[32:33], v38 offset:4096
    ds_read_b64_tr_b16 v[34:35], v38 offset:5120
    s_waitcnt lgkmcnt(3)
    v_mfma_f32_32x32x16_bf16 v[4:19], v[28:31], v[20:23], v[4:19]
    s_waitcnt lgkmcnt(0)
    v_mfma_f32_32x32x16_bf16 v[4:19], v[32:35], v[24:27], v[4:19]
    s_nop 15
    s_barrier
    s_lshr_b32 s46, s28, 1
    s_mul_i32 s46, s46, 4096
    v_lshlrev_b32 v44, 4, v41
    v_add_u32 v44, s46, v44
    s_cmp_eq_u32 s31, 0
    s_cbranch_scc1 Lred_4
    s_sub_u32 s47, s31, 1
    s_mul_i32 s47, s47, 4096
    v_add_u32 v44, s47, v44
    ds_write_b128 v44, v[4:7] offset:0
    ds_write_b128 v44, v[8:11] offset:1024
    ds_write_b128 v44, v[12:15] offset:2048
    ds_write_b128 v44, v[16:19] offset:3072
    s_waitcnt lgkmcnt(0)
    s_barrier
    s_endpgm
Lred_4:
    s_barrier
    ds_read_b128 v[20:23], v44 offset:0
    s_waitcnt lgkmcnt(0)
    v_add_f32 v4, v4, v20
    v_add_f32 v5, v5, v21
    v_add_f32 v6, v6, v22
    v_add_f32 v7, v7, v23
    ds_read_b128 v[24:27], v44 offset:1024
    s_waitcnt lgkmcnt(0)
    v_add_f32 v8, v8, v24
    v_add_f32 v9, v9, v25
    v_add_f32 v10, v10, v26
    v_add_f32 v11, v11, v27
    ds_read_b128 v[20:23], v44 offset:2048
    s_waitcnt lgkmcnt(0)
    v_add_f32 v12, v12, v20
    v_add_f32 v13, v13, v21
    v_add_f32 v14, v14, v22
    v_add_f32 v15, v15, v23
    ds_read_b128 v[24:27], v44 offset:3072
    s_waitcnt lgkmcnt(0)
    v_add_f32 v16, v16, v24
    v_add_f32 v17, v17, v25
    v_add_f32 v18, v18, v26
    v_add_f32 v19, v19, v27
    s_mul_i32 s46, s32, 2
    s_mul_i32 s47, s29, 1
    s_add_u32 s46, s46, s47
    s_lshl_b32 s46, s46, 4
    s_mul_i32 s47, s33, 2
    s_add_u32 s46, s46, s47
    s_mul_i32 s47, s30, 1
    s_add_u32 s46, s46, s47
    s_lshl_b32 s46, s46, 11
    v_lshlrev_b32 v44, 5, v41
    v_cvt_pk_bf16_f32 v20, v4, v5
    v_cvt_pk_bf16_f32 v21, v6, v7
    v_cvt_pk_bf16_f32 v22, v8, v9
    v_cvt_pk_bf16_f32 v23, v10, v11
    v_cvt_pk_bf16_f32 v24, v12, v13
    v_cvt_pk_bf16_f32 v25, v14, v15
    v_cvt_pk_bf16_f32 v26, v16, v17
    v_cvt_pk_bf16_f32 v27, v18, v19
    s_add_u32 s47, s46, 0
    buffer_store_dwordx4 v[20:23], v44, s[20:23], s47 offen
    buffer_store_dwordx4 v[24:27], v44, s[20:23], s47 offen offset:16
    s_endpgm
.section .rodata,"a"
.p2align 6
.amdhsa_kernel k2_mix_kernel
  .amdhsa_next_free_vgpr 124
  .amdhsa_next_free_sgpr 58
  .amdhsa_accum_offset 124
  .amdhsa_group_segment_fixed_size 0
  .amdhsa_kernarg_size 96
  .amdhsa_user_sgpr_count 2
  .amdhsa_user_sgpr_kernarg_segment_ptr 1
  .amdhsa_system_sgpr_workgroup_id_x 1
.end_amdhsa_kernel
.text

.text
.globl k4_out_kernel
.p2align 8
.type k4_out_kernel,@function
k4_out_kernel:
    s_cmp_ge_u32 s2, 256
    s_cbranch_scc1 k4_out_kernel_exit
    s_branch k4_out_kernel_role
k4_out_kernel_exit:
    s_endpgm
k4_out_kernel_role:
    s_mov_b32 s3, s2
    s_load_dwordx2 s[6:7], s[0:1], 16
    s_load_dwordx2 s[8:9], s[0:1], 88
    s_load_dwordx2 s[10:11], s[0:1], 72
    v_lshrrev_b32 v44, 6, v0
    v_and_b32 v41, 63, v0
    s_nop 0
    v_readfirstlane_b32 s28, v44
    v_lshrrev_b32 v42, 5, v41
    v_and_b32 v43, 31, v41
    s_and_b32 s32, s3, 31
    s_lshr_b32 s33, s3, 5
    s_and_b32 s31, s28, 1
    s_lshr_b32 s46, s28, 1
    s_and_b32 s29, s46, 1
    s_lshr_b32 s30, s46, 1
    s_waitcnt lgkmcnt(0)
    s_add_u32 s4, s8, 13631488
    s_addc_u32 s5, s9, 0
    s_mov_b32 s12, s4
    s_mov_b32 s13, s5
    s_mov_b32 s14, 2097152
    s_mov_b32 s15, 0x00020000
    s_mul_i32 s46, s33, 128
    s_add_u32 s46, s46, 0
    s_add_u32 s6, s6, s46
    s_addc_u32 s7, s7, 0
    s_sub_u32 s47, 524288, s46
    s_mov_b32 s16, s6
    s_mov_b32 s17, s7
    s_mov_b32 s18, s47
    s_mov_b32 s19, 0x00020000
    s_mov_b32 s20, s10
    s_mov_b32 s21, s11
    s_mov_b32 s22, 2097152
    s_mov_b32 s23, 0x00020000
    v_lshrrev_b32 v44, 3, v41
    v_and_b32 v45, 7, v41
    s_mul_i32 s46, s28, 8
    s_mov_b32 s47, 1024
    v_add_u32 v46, s46, v44
    v_mov_b32 v48, v46
    v_lshrrev_b32 v46, 1, v46
    v_and_b32 v46, 7, v46
    v_xor_b32 v46, v46, v45
    v_lshrrev_b32 v47, 1, v46
    v_lshlrev_b32 v47, 10, v47
    v_and_b32 v46, 1, v46
    v_lshlrev_b32 v46, 9, v46
    v_add_u32 v47, v47, v46
    v_and_b32 v46, 31, v48
    v_lshlrev_b32 v46, 4, v46
    v_add_u32 v47, v47, v46
    v_lshrrev_b32 v46, 5, v48
    v_lshlrev_b32 v46, 15, v46
    v_add_u32 v39, v47, v46
    s_mul_i32 s34, s32, 65536
    s_mul_i32 s36, s28, 1024
    v_lshrrev_b32 v44, 3, v41
    v_and_b32 v45, 7, v41
    v_lshrrev_b32 v46, 1, v44
    v_and_b32 v46, 1, v46
    v_lshlrev_b32 v46, 2, v46
    v_xor_b32 v45, v45, v46
    v_lshlrev_b32 v45, 4, v45
    s_mov_b32 s47, 1024
    v_mul_lo_u32 v47, v44, s47
    v_add_u32 v40, v45, v47
    s_mul_i32 s48, s28, 8
    s_add_u32 s48, s48, 0
    s_mul_i32 s35, s48, 1024
    s_mul_i32 s37, s28, 1024
    s_add_u32 s37, s37, 8192
    s_mov_b32 s42, 4096
    s_mov_b32 s43, 4294938624
    s_mov_b32 s44, 65536
    s_mov_b32 s45, 4294508544
    s_mul_i32 s46, s32, 3
    s_add_u32 s46, s46, s33
    s_lshl_b32 s46, s46, 0
    s_and_b32 s38, s46, 7
    s_mov_b32 s39, s38
    s_mul_i32 s47, s38, 4096
    s_add_u32 s34, s34, s47
    s_mul_i32 s47, s38, 65536
    s_add_u32 s35, s35, s47
    s_add_u32 s46, s8, 15728640
    s_addc_u32 s47, s9, 0
    s_mov_b32 s24, s46
    s_mov_b32 s25, s47
    s_mov_b32 s26, 2105344
    s_mov_b32 s27, 0x00020000
    v_lshlrev_b32 v44, 5, v41
    v_lshlrev_b32 v45, 2, v43
    s_mul_i32 s46, s32, 2
    s_mul_i32 s47, s29, 1
    s_add_u32 s46, s46, s47
    s_mul_i32 s47, s33, 2
    s_mul_i32 s48, s30, 1
    s_add_u32 s47, s47, s48
    s_add_u32 s48, s46, 0
    s_lshl_b32 s49, s48, 4
    s_add_u32 s49, s49, s47
    s_add_u32 s49, s49, 0
    s_lshl_b32 s49, s49, 11
    buffer_load_dwordx4 v[52:55], v44, s[24:27], s49 offen
    buffer_load_dwordx4 v[56:59], v44, s[24:27], s49 offen offset:16
    s_lshl_b32 s50, s48, 7
    s_add_u32 s50, s50, 2097152
    buffer_load_dword v60, v45, s[24:27], s50 offen
    s_add_u32 s38, s38, 1
    s_cmp_eq_u32 s38, 8
    s_cselect_b32 s40, s43, s42
    s_cselect_b32 s38, 0, s38
    s_add_u32 s39, s39, 1
    s_cmp_eq_u32 s39, 8
    s_cselect_b32 s41, s45, s44
    s_cselect_b32 s39, 0, s39
    s_add_u32 m0, s36, 0
    s_nop 0
    buffer_load_dwordx4 v39, s[12:15], s34 offen lds
    s_add_u32 s34, s34, s40
    s_add_u32 m0, s37, 0
    s_nop 0
    buffer_load_dwordx4 v40, s[16:19], s35 offen lds
    s_add_u32 s35, s35, s41
    s_add_u32 s38, s38, 1
    s_cmp_eq_u32 s38, 8
    s_cselect_b32 s40, s43, s42
    s_cselect_b32 s38, 0, s38
    s_add_u32 s39, s39, 1
    s_cmp_eq_u32 s39, 8
    s_cselect_b32 s41, s45, s44
    s_cselect_b32 s39, 0, s39
    s_add_u32 m0, s36, 16384
    s_nop 0
    buffer_load_dwordx4 v39, s[12:15], s34 offen lds
    s_add_u32 s34, s34, s40
    s_add_u32 m0, s37, 16384
    s_nop 0
    buffer_load_dwordx4 v40, s[16:19], s35 offen lds
    s_add_u32 s35, s35, s41
    s_add_u32 s38, s38, 1
    s_cmp_eq_u32 s38, 8
    s_cselect_b32 s40, s43, s42
    s_cselect_b32 s38, 0, s38
    s_add_u32 s39, s39, 1
    s_cmp_eq_u32 s39, 8
    s_cselect_b32 s41, s45, s44
    s_cselect_b32 s39, 0, s39
    s_add_u32 m0, s36, 32768
    s_nop 0
    buffer_load_dwordx4 v39, s[12:15], s34 offen lds
    s_add_u32 s34, s34, s40
    s_add_u32 m0, s37, 32768
    s_nop 0
    buffer_load_dwordx4 v40, s[16:19], s35 offen lds
    s_add_u32 s35, s35, s41
    s_add_u32 s38, s38, 1
    s_cmp_eq_u32 s38, 8
    s_cselect_b32 s40, s43, s42
    s_cselect_b32 s38, 0, s38
    s_add_u32 s39, s39, 1
    s_cmp_eq_u32 s39, 8
    s_cselect_b32 s41, s45, s44
    s_cselect_b32 s39, 0, s39
    s_add_u32 m0, s36, 49152
    s_nop 0
    buffer_load_dwordx4 v39, s[12:15], s34 offen lds
    s_add_u32 s34, s34, s40
    s_add_u32 m0, s37, 49152
    s_nop 0
    buffer_load_dwordx4 v40, s[16:19], s35 offen lds
    s_add_u32 s35, s35, s41
    s_mul_i32 s46, s29, 4096
    v_mul_u32_u24 v44, 128, v43
    v_add_u32 v44, s46, v44
    v_mov_b32 v45, v43
    v_lshrrev_b32 v45, 1, v45
    v_and_b32 v45, 7, v45
    s_lshl_b32 s47, s31, 1
    v_add_u32 v46, s47, v42
    v_add_u32 v47, 0, v46
    v_xor_b32 v47, v47, v45
    v_lshlrev_b32 v47, 4, v47
    v_add_u32 v36, v44, v47
    v_add_u32 v47, 4, v46
    v_xor_b32 v47, v47, v45
    v_lshlrev_b32 v47, 4, v47
    v_add_u32 v37, v44, v47
    v_and_b32 v44, 15, v41
    v_lshrrev_b32 v44, 2, v44
    v_mul_u32_u24 v45, 4, v42
    v_add_u32 v45, v45, v44
    s_mov_b32 s46, 0
    s_cmp_eq_u32 s31, 1
    s_cselect_b32 s46, 16, s46
    v_add_u32 v45, s46, v45
    v_mul_u32_u24 v45, 128, v45
    v_lshrrev_b32 v46, 1, v44
    v_lshlrev_b32 v46, 2, v46
    v_lshrrev_b32 v47, 4, v41
    v_and_b32 v47, 1, v47
    v_lshlrev_b32 v47, 1, v47
    v_and_b32 v48, 3, v41
    v_lshrrev_b32 v49, 1, v48
    v_add_u32 v47, v47, v49
    s_mul_i32 s46, s30, 4
    v_add_u32 v47, s46, v47
    v_and_b32 v48, 1, v48
    v_lshlrev_b32 v48, 3, v48
    v_add_u32 v48, v48, v45
    v_add_u32 v48, 8192, v48
    v_add_u32 v49, 0, v47
    v_xor_b32 v49, v49, v46
    v_lshlrev_b32 v49, 4, v49
    v_add_u32 v38, v48, v49
    v_mov_b32 v4, 0
    v_mov_b32 v5, 0
    v_mov_b32 v6, 0
    v_mov_b32 v7, 0
    v_mov_b32 v8, 0
    v_mov_b32 v9, 0
    v_mov_b32 v10, 0
    v_mov_b32 v11, 0
    v_mov_b32 v12, 0
    v_mov_b32 v13, 0
    v_mov_b32 v14, 0
    v_mov_b32 v15, 0
    v_mov_b32 v16, 0
    v_mov_b32 v17, 0
    v_mov_b32 v18, 0
    v_mov_b32 v19, 0
    s_waitcnt vmcnt(6)
    s_barrier
    ds_read_b128 v[20:23], v36 offset:0
    ds_read_b64_tr_b16 v[28:29], v38 offset:0
    ds_read_b64_tr_b16 v[30:31], v38 offset:1024
    s_waitcnt vmcnt(4)
    s_barrier
    s_add_u32 s38, s38, 1
    s_cmp_eq_u32 s38, 8
    s_cselect_b32 s40, s43, s42
    s_cselect_b32 s38, 0, s38
    s_add_u32 s39, s39, 1
    s_cmp_eq_u32 s39, 8
    s_cselect_b32 s41, s45, s44
    s_cselect_b32 s39, 0, s39
    s_add_u32 m0, s36, 65536
    s_nop 0
    buffer_load_dwordx4 v39, s[12:15], s34 offen lds
    s_add_u32 s34, s34, s40
    s_add_u32 m0, s37, 65536
    s_nop 0
    buffer_load_dwordx4 v40, s[16:19], s35 offen lds
    s_add_u32 s35, s35, s41
    ds_read_b128 v[24:27], v37 offset:0
    ds_read_b64_tr_b16 v[32:33], v38 offset:4096
    ds_read_b64_tr_b16 v[34:35], v38 offset:5120
    s_waitcnt lgkmcnt(3)
    v_mfma_f32_32x32x16_bf16 v[4:19], v[28:31], v[20:23], v[4:19]
    v_add_u32 v36, 16384, v36
    v_add_u32 v37, 16384, v37
    v_add_u32 v38, 16384, v38
    ds_read_b128 v[20:23], v36 offset:0
    ds_read_b64_tr_b16 v[28:29], v38 offset:0
    ds_read_b64_tr_b16 v[30:31], v38 offset:1024
    s_waitcnt lgkmcnt(3)
    v_mfma_f32_32x32x16_bf16 v[4:19], v[32:35], v[24:27], v[4:19]
    s_waitcnt vmcnt(4)
    s_barrier
    s_add_u32 s38, s38, 1
    s_cmp_eq_u32 s38, 8
    s_cselect_b32 s40, s43, s42
    s_cselect_b32 s38, 0, s38
    s_add_u32 s39, s39, 1
    s_cmp_eq_u32 s39, 8
    s_cselect_b32 s41, s45, s44
    s_cselect_b32 s39, 0, s39
    s_add_u32 m0, s36, 0
    s_nop 0
    buffer_load_dwordx4 v39, s[12:15], s34 offen lds
    s_add_u32 s34, s34, s40
    s_add_u32 m0, s37, 0
    s_nop 0
    buffer_load_dwordx4 v40, s[16:19], s35 offen lds
    s_add_u32 s35, s35, s41
    ds_read_b128 v[24:27], v37 offset:0
    ds_read_b64_tr_b16 v[32:33], v38 offset:4096
    ds_read_b64_tr_b16 v[34:35], v38 offset:5120
    s_waitcnt lgkmcnt(3)
    v_mfma_f32_32x32x16_bf16 v[4:19], v[28:31], v[20:23], v[4:19]
    v_add_u32 v36, 16384, v36
    v_add_u32 v37, 16384, v37
    v_add_u32 v38, 16384, v38
    ds_read_b128 v[20:23], v36 offset:0
    ds_read_b64_tr_b16 v[28:29], v38 offset:0
    ds_read_b64_tr_b16 v[30:31], v38 offset:1024
    s_waitcnt lgkmcnt(3)
    v_mfma_f32_32x32x16_bf16 v[4:19], v[32:35], v[24:27], v[4:19]
    s_waitcnt vmcnt(4)
    s_barrier
    s_add_u32 s38, s38, 1
    s_cmp_eq_u32 s38, 8
    s_cselect_b32 s40, s43, s42
    s_cselect_b32 s38, 0, s38
    s_add_u32 s39, s39, 1
    s_cmp_eq_u32 s39, 8
    s_cselect_b32 s41, s45, s44
    s_cselect_b32 s39, 0, s39
    s_add_u32 m0, s36, 16384
    s_nop 0
    buffer_load_dwordx4 v39, s[12:15], s34 offen lds
    s_add_u32 s34, s34, s40
    s_add_u32 m0, s37, 16384
    s_nop 0
    buffer_load_dwordx4 v40, s[16:19], s35 offen lds
    s_add_u32 s35, s35, s41
    ds_read_b128 v[24:27], v37 offset:0
    ds_read_b64_tr_b16 v[32:33], v38 offset:4096
    ds_read_b64_tr_b16 v[34:35], v38 offset:5120
    s_waitcnt lgkmcnt(3)
    v_mfma_f32_32x32x16_bf16 v[4:19], v[28:31], v[20:23], v[4:19]
    v_add_u32 v36, 16384, v36
    v_add_u32 v37, 16384, v37
    v_add_u32 v38, 16384, v38
    ds_read_b128 v[20:23], v36 offset:0
    ds_read_b64_tr_b16 v[28:29], v38 offset:0
    ds_read_b64_tr_b16 v[30:31], v38 offset:1024
    s_waitcnt lgkmcnt(3)
    v_mfma_f32_32x32x16_bf16 v[4:19], v[32:35], v[24:27], v[4:19]
    s_waitcnt vmcnt(4)
    s_barrier
    s_add_u32 s38, s38, 1
    s_cmp_eq_u32 s38, 8
    s_cselect_b32 s40, s43, s42
    s_cselect_b32 s38, 0, s38
    s_add_u32 s39, s39, 1
    s_cmp_eq_u32 s39, 8
    s_cselect_b32 s41, s45, s44
    s_cselect_b32 s39, 0, s39
    s_add_u32 m0, s36, 32768
    s_nop 0
    buffer_load_dwordx4 v39, s[12:15], s34 offen lds
    s_add_u32 s34, s34, s40
    s_add_u32 m0, s37, 32768
    s_nop 0
    buffer_load_dwordx4 v40, s[16:19], s35 offen lds
    s_add_u32 s35, s35, s41
    ds_read_b128 v[24:27], v37 offset:0
    ds_read_b64_tr_b16 v[32:33], v38 offset:4096
    ds_read_b64_tr_b16 v[34:35], v38 offset:5120
    s_waitcnt lgkmcnt(3)
    v_mfma_f32_32x32x16_bf16 v[4:19], v[28:31], v[20:23], v[4:19]
    v_add_u32 v36, 16384, v36
    v_add_u32 v37, 16384, v37
    v_add_u32 v38, 16384, v38
    ds_read_b128 v[20:23], v36 offset:0
    ds_read_b64_tr_b16 v[28:29], v38 offset:0
    ds_read_b64_tr_b16 v[30:31], v38 offset:1024
    s_waitcnt lgkmcnt(3)
    v_mfma_f32_32x32x16_bf16 v[4:19], v[32:35], v[24:27], v[4:19]
    s_waitcnt vmcnt(4)
    s_barrier
    ds_read_b128 v[24:27], v37 offset:0
    ds_read_b64_tr_b16 v[32:33], v38 offset:4096
    ds_read_b64_tr_b16 v[34:35], v38 offset:5120
    s_waitcnt lgkmcnt(3)
    v_mfma_f32_32x32x16_bf16 v[4:19], v[28:31], v[20:23], v[4:19]
    v_subrev_u32 v36, 65536, v36
    v_subrev_u32 v37, 65536, v37
    v_subrev_u32 v38, 65536, v38
    ds_read_b128 v[20:23], v36 offset:0
    ds_read_b64_tr_b16 v[28:29], v38 offset:0
    ds_read_b64_tr_b16 v[30:31], v38 offset:1024
    s_waitcnt lgkmcnt(3)
    v_mfma_f32_32x32x16_bf16 v[4:19], v[32:35], v[24:27], v[4:19]
    s_waitcnt vmcnt(2)
    s_barrier
    ds_read_b128 v[24:27], v37 offset:0
    ds_read_b64_tr_b16 v[32:33], v38 offset:4096
    ds_read_b64_tr_b16 v[34:35], v38 offset:5120
    s_waitcnt lgkmcnt(3)
    v_mfma_f32_32x32x16_bf16 v[4:19], v[28:31], v[20:23], v[4:19]
    v_add_u32 v36, 16384, v36
    v_add_u32 v37, 16384, v37
    v_add_u32 v38, 16384, v38
    ds_read_b128 v[20:23], v36 offset:0
    ds_read_b64_tr_b16 v[28:29], v38 offset:0
    ds_read_b64_tr_b16 v[30:31], v38 offset:1024
    s_waitcnt lgkmcnt(3)
    v_mfma_f32_32x32x16_bf16 v[4:19], v[32:35], v[24:27], v[4:19]
    s_waitcnt vmcnt(0)
    s_barrier
    ds_read_b128 v[24:27], v37 offset:0
    ds_read_b64_tr_b16 v[32:33], v38 offset:4096
    ds_read_b64_tr_b16 v[34:35], v38 offset:5120
    s_waitcnt lgkmcnt(3)
    v_mfma_f32_32x32x16_bf16 v[4:19], v[28:31], v[20:23], v[4:19]
    v_add_u32 v36, 16384, v36
    v_add_u32 v37, 16384, v37
    v_add_u32 v38, 16384, v38
    ds_read_b128 v[20:23], v36 offset:0
    ds_read_b64_tr_b16 v[28:29], v38 offset:0
    ds_read_b64_tr_b16 v[30:31], v38 offset:1024
    s_waitcnt lgkmcnt(3)
    v_mfma_f32_32x32x16_bf16 v[4:19], v[32:35], v[24:27], v[4:19]
    ds_read_b128 v[24:27], v37 offset:0
    ds_read_b64_tr_b16 v[32:33], v38 offset:4096
    ds_read_b64_tr_b16 v[34:35], v38 offset:5120
    s_waitcnt lgkmcnt(3)
    v_mfma_f32_32x32x16_bf16 v[4:19], v[28:31], v[20:23], v[4:19]
    s_waitcnt lgkmcnt(0)
    v_mfma_f32_32x32x16_bf16 v[4:19], v[32:35], v[24:27], v[4:19]
    s_nop 15
    s_barrier
    s_lshr_b32 s46, s28, 1
    s_mul_i32 s46, s46, 4096
    v_lshlrev_b32 v44, 4, v41
    v_add_u32 v44, s46, v44
    s_cmp_eq_u32 s31, 0
    s_cbranch_scc1 Lred_1
    s_sub_u32 s47, s31, 1
    s_mul_i32 s47, s47, 4096
    v_add_u32 v44, s47, v44
    ds_write_b128 v44, v[4:7] offset:0
    ds_write_b128 v44, v[8:11] offset:1024
    ds_write_b128 v44, v[12:15] offset:2048
    ds_write_b128 v44, v[16:19] offset:3072
    s_waitcnt lgkmcnt(0)
    s_barrier
    s_endpgm
Lred_1:
    s_barrier
    ds_read_b128 v[20:23], v44 offset:0
    s_waitcnt lgkmcnt(0)
    v_add_f32 v4, v4, v20
    v_add_f32 v5, v5, v21
    v_add_f32 v6, v6, v22
    v_add_f32 v7, v7, v23
    ds_read_b128 v[24:27], v44 offset:1024
    s_waitcnt lgkmcnt(0)
    v_add_f32 v8, v8, v24
    v_add_f32 v9, v9, v25
    v_add_f32 v10, v10, v26
    v_add_f32 v11, v11, v27
    ds_read_b128 v[20:23], v44 offset:2048
    s_waitcnt lgkmcnt(0)
    v_add_f32 v12, v12, v20
    v_add_f32 v13, v13, v21
    v_add_f32 v14, v14, v22
    v_add_f32 v15, v15, v23
    ds_read_b128 v[24:27], v44 offset:3072
    s_waitcnt lgkmcnt(0)
    v_add_f32 v16, v16, v24
    v_add_f32 v17, v17, v25
    v_add_f32 v18, v18, v26
    v_add_f32 v19, v19, v27
    v_lshlrev_b32 v46, 10, v43
    v_lshlrev_b32 v47, 3, v42
    v_add_u32 v46, v46, v47
    s_mul_i32 s46, s32, 2
    s_mul_i32 s47, s29, 1
    s_add_u32 s46, s46, s47
    s_mul_i32 s47, s33, 2
    s_mul_i32 s48, s30, 1
    s_add_u32 s47, s47, s48
    s_add_u32 s48, s46, 0
    s_lshl_b32 s50, s48, 15
    s_add_u32 s51, s47, 0
    s_lshl_b32 s51, s51, 6
    s_add_u32 s50, s50, s51
    v_sub_f32 v49, 1.0, v60
    v_cvt_pk_bf16_f32 v49, v49, v49
    v_lshlrev_b32 v49, 16, v49
    v_cvt_pk_bf16_f32 v47, v4, v5
    v_lshlrev_b32 v4, 16, v47
    v_and_b32 v5, 0xffff0000, v47
    v_mul_f32 v4, v4, v60
    v_mul_f32 v5, v5, v60
    v_cvt_pk_bf16_f32 v47, v4, v5
    v_lshlrev_b32 v4, 16, v52
    v_and_b32 v5, 0xffff0000, v52
    v_mul_f32 v4, v4, v49
    v_mul_f32 v5, v5, v49
    v_cvt_pk_bf16_f32 v52, v4, v5
    v_lshlrev_b32 v4, 16, v47
    v_and_b32 v5, 0xffff0000, v47
    v_lshlrev_b32 v47, 16, v52
    v_add_f32 v4, v4, v47
    v_and_b32 v47, 0xffff0000, v52
    v_add_f32 v5, v5, v47
    v_cvt_pk_bf16_f32 v28, v4, v5
    v_cvt_pk_bf16_f32 v47, v6, v7
    v_lshlrev_b32 v6, 16, v47
    v_and_b32 v7, 0xffff0000, v47
    v_mul_f32 v6, v6, v60
    v_mul_f32 v7, v7, v60
    v_cvt_pk_bf16_f32 v47, v6, v7
    v_lshlrev_b32 v6, 16, v53
    v_and_b32 v7, 0xffff0000, v53
    v_mul_f32 v6, v6, v49
    v_mul_f32 v7, v7, v49
    v_cvt_pk_bf16_f32 v53, v6, v7
    v_lshlrev_b32 v6, 16, v47
    v_and_b32 v7, 0xffff0000, v47
    v_lshlrev_b32 v47, 16, v53
    v_add_f32 v6, v6, v47
    v_and_b32 v47, 0xffff0000, v53
    v_add_f32 v7, v7, v47
    v_cvt_pk_bf16_f32 v29, v6, v7
    v_cvt_pk_bf16_f32 v47, v8, v9
    v_lshlrev_b32 v8, 16, v47
    v_and_b32 v9, 0xffff0000, v47
    v_mul_f32 v8, v8, v60
    v_mul_f32 v9, v9, v60
    v_cvt_pk_bf16_f32 v47, v8, v9
    v_lshlrev_b32 v8, 16, v54
    v_and_b32 v9, 0xffff0000, v54
    v_mul_f32 v8, v8, v49
    v_mul_f32 v9, v9, v49
    v_cvt_pk_bf16_f32 v54, v8, v9
    v_lshlrev_b32 v8, 16, v47
    v_and_b32 v9, 0xffff0000, v47
    v_lshlrev_b32 v47, 16, v54
    v_add_f32 v8, v8, v47
    v_and_b32 v47, 0xffff0000, v54
    v_add_f32 v9, v9, v47
    v_cvt_pk_bf16_f32 v30, v8, v9
    v_cvt_pk_bf16_f32 v47, v10, v11
    v_lshlrev_b32 v10, 16, v47
    v_and_b32 v11, 0xffff0000, v47
    v_mul_f32 v10, v10, v60
    v_mul_f32 v11, v11, v60
    v_cvt_pk_bf16_f32 v47, v10, v11
    v_lshlrev_b32 v10, 16, v55
    v_and_b32 v11, 0xffff0000, v55
    v_mul_f32 v10, v10, v49
    v_mul_f32 v11, v11, v49
    v_cvt_pk_bf16_f32 v55, v10, v11
    v_lshlrev_b32 v10, 16, v47
    v_and_b32 v11, 0xffff0000, v47
    v_lshlrev_b32 v47, 16, v55
    v_add_f32 v10, v10, v47
    v_and_b32 v47, 0xffff0000, v55
    v_add_f32 v11, v11, v47
    v_cvt_pk_bf16_f32 v31, v10, v11
    v_cvt_pk_bf16_f32 v47, v12, v13
    v_lshlrev_b32 v12, 16, v47
    v_and_b32 v13, 0xffff0000, v47
    v_mul_f32 v12, v12, v60
    v_mul_f32 v13, v13, v60
    v_cvt_pk_bf16_f32 v47, v12, v13
    v_lshlrev_b32 v12, 16, v56
    v_and_b32 v13, 0xffff0000, v56
    v_mul_f32 v12, v12, v49
    v_mul_f32 v13, v13, v49
    v_cvt_pk_bf16_f32 v56, v12, v13
    v_lshlrev_b32 v12, 16, v47
    v_and_b32 v13, 0xffff0000, v47
    v_lshlrev_b32 v47, 16, v56
    v_add_f32 v12, v12, v47
    v_and_b32 v47, 0xffff0000, v56
    v_add_f32 v13, v13, v47
    v_cvt_pk_bf16_f32 v32, v12, v13
    v_cvt_pk_bf16_f32 v47, v14, v15
    v_lshlrev_b32 v14, 16, v47
    v_and_b32 v15, 0xffff0000, v47
    v_mul_f32 v14, v14, v60
    v_mul_f32 v15, v15, v60
    v_cvt_pk_bf16_f32 v47, v14, v15
    v_lshlrev_b32 v14, 16, v57
    v_and_b32 v15, 0xffff0000, v57
    v_mul_f32 v14, v14, v49
    v_mul_f32 v15, v15, v49
    v_cvt_pk_bf16_f32 v57, v14, v15
    v_lshlrev_b32 v14, 16, v47
    v_and_b32 v15, 0xffff0000, v47
    v_lshlrev_b32 v47, 16, v57
    v_add_f32 v14, v14, v47
    v_and_b32 v47, 0xffff0000, v57
    v_add_f32 v15, v15, v47
    v_cvt_pk_bf16_f32 v33, v14, v15
    v_cvt_pk_bf16_f32 v47, v16, v17
    v_lshlrev_b32 v16, 16, v47
    v_and_b32 v17, 0xffff0000, v47
    v_mul_f32 v16, v16, v60
    v_mul_f32 v17, v17, v60
    v_cvt_pk_bf16_f32 v47, v16, v17
    v_lshlrev_b32 v16, 16, v58
    v_and_b32 v17, 0xffff0000, v58
    v_mul_f32 v16, v16, v49
    v_mul_f32 v17, v17, v49
    v_cvt_pk_bf16_f32 v58, v16, v17
    v_lshlrev_b32 v16, 16, v47
    v_and_b32 v17, 0xffff0000, v47
    v_lshlrev_b32 v47, 16, v58
    v_add_f32 v16, v16, v47
    v_and_b32 v47, 0xffff0000, v58
    v_add_f32 v17, v17, v47
    v_cvt_pk_bf16_f32 v34, v16, v17
    v_cvt_pk_bf16_f32 v47, v18, v19
    v_lshlrev_b32 v18, 16, v47
    v_and_b32 v19, 0xffff0000, v47
    v_mul_f32 v18, v18, v60
    v_mul_f32 v19, v19, v60
    v_cvt_pk_bf16_f32 v47, v18, v19
    v_lshlrev_b32 v18, 16, v59
    v_and_b32 v19, 0xffff0000, v59
    v_mul_f32 v18, v18, v49
    v_mul_f32 v19, v19, v49
    v_cvt_pk_bf16_f32 v59, v18, v19
    v_lshlrev_b32 v18, 16, v47
    v_and_b32 v19, 0xffff0000, v47
    v_lshlrev_b32 v47, 16, v59
    v_add_f32 v18, v18, v47
    v_and_b32 v47, 0xffff0000, v59
    v_add_f32 v19, v19, v47
    v_cvt_pk_bf16_f32 v35, v18, v19
    buffer_store_dwordx2 v[28:29], v46, s[20:23], s50 offen offset:0
    buffer_store_dwordx2 v[30:31], v46, s[20:23], s50 offen offset:16
    buffer_store_dwordx2 v[32:33], v46, s[20:23], s50 offen offset:32
    buffer_store_dwordx2 v[34:35], v46, s[20:23], s50 offen offset:48
    s_endpgm
.section .rodata,"a"
.p2align 6
.amdhsa_kernel k4_out_kernel
  .amdhsa_next_free_vgpr 61
  .amdhsa_next_free_sgpr 58
  .amdhsa_accum_offset 64
  .amdhsa_group_segment_fixed_size 0
  .amdhsa_kernarg_size 96
  .amdhsa_user_sgpr_count 2
  .amdhsa_user_sgpr_kernarg_segment_ptr 1
  .amdhsa_system_sgpr_workgroup_id_x 1
.end_amdhsa_kernel
.text
```
